```python
import torch

def _softmax(x, axis=-1):
    return torch.softmax(x, dim=axis)
def _gelu(x):
    return torch.nn.functional.gelu(x, approximate="tanh")
def _silu(x):
    return torch.nn.functional.silu(x)
def _sigmoid(x):
    return torch.sigmoid(x)
def _layernorm(x, axis=-1, eps=1e-5):
    m = x.mean(dim=axis, keepdim=True)
    v = x.var(dim=axis, keepdim=True, unbiased=False)
    return (x - m) / torch.sqrt(v + eps)
def _scatter_add(tgt, idx, src, axis=0):
    return tgt.clone().index_add_(axis, idx, src)
def _segment_sum(src, seg, n):
    out = torch.zeros((n,) + src.shape[1:], dtype=src.dtype)
    return out.index_add_(0, seg, src)
def _pad(x, pw):
    flat = tuple(v for pair in reversed(pw) for v in pair)
    return torch.nn.functional.pad(x, flat)

kernel_name = 'gated_mix__softmax_full_mha__mixer_token_mlp__prompt'

def setup_inputs():

    _w = (lambda a: (lambda t: t.to(torch.bfloat16) if t.is_floating_point() else t)(torch.as_tensor(a)))
    def _A_setup():
        B, S, D = 1, 2048, 576
        return {
            "x": _w((lambda *s: torch.randn(*s, dtype=torch.bfloat16) * 0.05)(B, S, D)),
            "wqkv": _w((lambda *s: torch.randn(*s, dtype=torch.bfloat16) * 0.8)(D, 3 * D)),
            "wo": _w((lambda *s: torch.randn(*s, dtype=torch.bfloat16) * 0.05)(D, D)),
        }
    _A_in = _A_setup()

    def _B_setup():
        B, S, D, F = 1, 2048, 576, 4608
        return {
            "x": _w((lambda *s: torch.randn(*s, dtype=torch.bfloat16) * 0.05)(B, S, D)),
            "w1": _w((lambda *s: torch.randn(*s, dtype=torch.bfloat16) * 0.8)(S, F) * (S ** -0.5)),
            "b1": _w((lambda *s: torch.randn(*s, dtype=torch.bfloat16) * 12.8)(F) * 0.02),
            "w2": _w((lambda *s: torch.randn(*s, dtype=torch.bfloat16) * 0.1)(F, S) * (F ** -0.5)),
            "b2": _w((lambda *s: torch.randn(*s, dtype=torch.bfloat16) * 1.6)(S) * 0.02),
        }
    _B_in = _B_setup()

    return {
        "A_x": _A_in["x"],
        "A_wqkv": _A_in["wqkv"],
        "A_wo": _A_in["wo"],
        "B_x": _B_in["x"],
        "B_w1": _B_in["w1"],
        "B_b1": _B_in["b1"],
        "B_w2": _B_in["w2"],
        "B_b2": _B_in["b2"],
        "gate_w": _w((lambda *s: torch.randn(*s, dtype=torch.bfloat16) * 0.05)(576) * 16.0),
    }

def reference(A_x, A_wqkv, A_wo, B_x, B_w1, B_b1, B_w2, B_b2, gate_w):
    def _A_ref(x, wqkv, wo):
        B, S, D = x.shape
        H = 32; Dh = D // H
        qkv = (lambda x, *d: x.permute(*d))((x @ wqkv).reshape(B, S, 3, H, Dh), 2, 0, 3, 1, 4)
        q, k, v = qkv[0], qkv[1], qkv[2]
        scale = Dh ** -0.5
        scores = torch.einsum("bhqd,bhkd->bhqk", q, k) * scale
        p = _softmax(scores, axis=-1)
        o = torch.einsum("bhqk,bhkd->bhqd", p, v)
        return (lambda x, *d: x.permute(*d))(o, 0, 2, 1, 3).reshape(B, S, D) @ wo

    def _B_ref(x, w1, b1, w2, b2):
        B, S, D = x.shape
        h = _layernorm(x, axis=-1)
        u = torch.einsum("bsd,sf->bdf", h, w1) + b1
        u = _gelu(u)
        y = torch.einsum("bdf,fs->bds", u, w2) + b2
        return (lambda x, *d: x.permute(*d))(y, 0, 2, 1)

    x = A_x
    g = _sigmoid((x * gate_w).sum(-1, keepdims=True))
    a = _A_ref(x, A_wqkv, A_wo)
    b = _B_ref(x, B_w1, B_b1, B_w2, B_b2)
    return g * a + (1 - g) * b
```

```asm
; @launch grid=(512,1,1) block=(256,1,1) lds=81920
.amdgcn_target "amdgcn-amd-amdhsa--gfx950"
.text
.globl gated_mix__softmax_full_mha__mixer_token_mlp__prompt_kernel
.p2align 8
.type gated_mix__softmax_full_mha__mixer_token_mlp__prompt_kernel,@function
gated_mix__softmax_full_mha__mixer_token_mlp__prompt_kernel:
    s_cmp_ge_u32 s2, 512
    s_cbranch_scc1 L_end
    s_load_dwordx16 s[16:31], s[0:1], 0
    s_load_dwordx8 s[32:39], s[0:1], 64
    v_lshrrev_b32 v1, 6, v0
    v_and_b32 v0, 63, v0
    s_nop 0
    v_readfirstlane_b32 s52, v1
    s_waitcnt lgkmcnt(0)
    s_mov_b32 s48, s38
    s_mov_b32 s49, s39
    s_mov_b32 s50, 268435456
    s_mov_b32 s51, 0x00020000
    s_mov_b32 s84, s36
    s_mov_b32 s85, s37
    s_mov_b32 s86, 256
    s_mov_b32 s87, 0x00020000
    s_cmp_ge_u32 s2, 256
    s_cbranch_scc1 L_slotB
    s_setprio 3
    s_cmp_ge_u32 s2, 192
    s_cbranch_scc1 L_ln
    s_mov_b32 s40, s16
    s_mov_b32 s41, s17
    s_mov_b32 s42, 2359296
    s_mov_b32 s43, 0x00020000
    s_mov_b32 s44, s18
    s_mov_b32 s45, s19
    s_mov_b32 s46, 1990656
    s_mov_b32 s47, 0x00020000
    s_and_b32 s53, s2, 7
    s_lshr_b32 s54, s2, 3
    s_lshr_b32 s55, s53, 1
    s_lshl_b32 s55, s55, 2
    s_and_b32 s56, s54, 3
    s_add_u32 s55, s55, s56
    s_and_b32 s56, s53, 1
    s_mul_i32 s56, s56, 6
    s_lshr_b32 s57, s54, 2
    s_add_u32 s56, s56, s57
    s_lshl_b32 s59, s55, 2
    s_add_u32 s60, s59, s52
    v_lshrrev_b32 v2, 2, v0
    s_lshl_b32 s60, s60, 5
    v_add_u32 v2, s60, v2
    v_mul_u32_u24 v2, 1152, v2
    v_lshrrev_b32 v3, 4, v0
    v_xor_b32 v3, v3, v0
    v_and_b32 v3, 3, v3
    v_lshl_add_u32 v2, v3, 4, v2
    v_add_u32 v3, 18432, v2
    s_mul_i32 s65, s56, 288
    s_mul_i32 s60, s52, 27648
    s_add_u32 s65, s65, s60
    v_add_u32 v7, 0, v0
    v_mul_u32_u24 v8, 3641, v7
    v_lshrrev_b32 v8, 16, v8
    v_mul_u32_u24 v9, 18, v8
    v_sub_u32 v7, v7, v9
    v_and_b32 v10, 1, v8
    v_lshrrev_b32 v9, 1, v8
    v_lshl_or_b32 v9, v10, 2, v9
    v_mul_u32_u24 v9, 3456, v9
    v_lshl_add_u32 v9, v7, 4, v9
    v_add_u32 v4, s65, v9
    v_add_u32 v7, 64, v0
    v_mul_u32_u24 v8, 3641, v7
    v_lshrrev_b32 v8, 16, v8
    v_mul_u32_u24 v9, 18, v8
    v_sub_u32 v7, v7, v9
    v_and_b32 v10, 1, v8
    v_lshrrev_b32 v9, 1, v8
    v_lshl_or_b32 v9, v10, 2, v9
    v_mul_u32_u24 v9, 3456, v9
    v_lshl_add_u32 v9, v7, 4, v9
    v_add_u32 v5, s65, v9
    v_add_u32 v7, 128, v0
    v_mul_u32_u24 v8, 3641, v7
    v_lshrrev_b32 v8, 16, v8
    v_mul_u32_u24 v9, 18, v8
    v_sub_u32 v7, v7, v9
    v_and_b32 v10, 1, v8
    v_lshrrev_b32 v9, 1, v8
    v_lshl_or_b32 v9, v10, 2, v9
    v_mul_u32_u24 v9, 3456, v9
    v_lshl_add_u32 v9, v7, 4, v9
    v_add_u32 v6, s65, v9
    s_lshl_b32 s61, s52, 11
    s_mul_i32 s62, s52, 2304
    s_add_u32 s62, s62, 8192
    s_mov_b32 s63, 0
    s_mov_b32 s64, 0
    s_mov_b32 s71, 110592
    s_mov_b64 s[72:73], 0xffff
    s_add_u32 m0, s61, 0
    s_nop 0
    buffer_load_dwordx4 v2, s[40:43], s63 offen lds
    s_add_u32 m0, s61, 1024
    s_nop 0
    buffer_load_dwordx4 v3, s[40:43], s63 offen lds
    s_add_u32 s63, s63, 64
    s_add_u32 m0, s62, 0
    s_nop 0
    buffer_load_dwordx4 v4, s[44:47], s64 offen lds
    s_add_u32 m0, s62, 1024
    s_nop 0
    buffer_load_dwordx4 v5, s[44:47], s64 offen lds
    s_add_u32 m0, s62, 2048
    s_nop 0
    s_mov_b64 exec, s[72:73]
    buffer_load_dwordx4 v6, s[44:47], s64 offen lds
    s_mov_b64 exec, -1
    s_add_u32 s64, s64, s71
    s_add_u32 m0, s61, 17408
    s_nop 0
    buffer_load_dwordx4 v2, s[40:43], s63 offen lds
    s_add_u32 m0, s61, 18432
    s_nop 0
    buffer_load_dwordx4 v3, s[40:43], s63 offen lds
    s_add_u32 s63, s63, 64
    s_add_u32 m0, s62, 17408
    s_nop 0
    buffer_load_dwordx4 v4, s[44:47], s64 offen lds
    s_add_u32 m0, s62, 18432
    s_nop 0
    buffer_load_dwordx4 v5, s[44:47], s64 offen lds
    s_add_u32 m0, s62, 19456
    s_nop 0
    s_mov_b64 exec, s[72:73]
    buffer_load_dwordx4 v6, s[44:47], s64 offen lds
    s_mov_b64 exec, -1
    s_add_u32 s64, s64, s71
    s_and_b32 s57, s52, 1
    s_lshr_b32 s58, s52, 1
    s_lshl_b32 s60, s57, 1
    s_add_u32 s60, s60, s58
    s_add_u32 s59, s59, s60
    v_and_b32 v10, 31, v0
    v_lshrrev_b32 v11, 5, v0
    v_bfe_u32 v12, v10, 2, 2
    v_xor_b32 v12, v12, v11
    v_lshlrev_b32 v13, 6, v10
    v_lshl_add_u32 v16, v12, 4, v13
    s_lshl_b32 s60, s60, 11
    v_add_u32 v16, s60, v16
    v_xor_b32 v17, 32, v16
    v_xor_b32 v18, 0x800, v16
    v_xor_b32 v19, 0x800, v17
    v_bfe_u32 v12, v0, 2, 2
    v_lshlrev_b32 v12, 1, v12
    v_lshl_add_u32 v12, v11, 3, v12
    v_mul_u32_u24 v12, 288, v12
    v_add_u32 v12, 0x2000, v12
    v_bfe_u32 v13, v0, 4, 1
    v_and_b32 v14, 3, v0
    v_lshl_add_u32 v15, v14, 3, v12
    v_lshl_add_u32 v20, v13, 5, v15
    s_and_b32 s69, s56, 3
    s_lshl_b32 s69, s69, 9
    s_cmp_ge_u32 s56, 8
    s_cbranch_scc1 L_qkv_v
    s_mul_i32 s60, s58, 144
    s_add_u32 s60, s60, 40
    v_add_u32 v21, 112, v20
    v_add_u32 v20, s60, v20
    v_lshl_add_u32 v23, v13, 8, v15
    s_cmp_lg_u32 s58, 0
    s_cselect_b64 vcc, -1, 0
    v_cndmask_b32 v21, v21, v23, vcc
    v_mul_u32_u24 v22, 72, v14
    v_add3_u32 v22, v22, v12, 32
    s_cmp_ge_u32 s56, 4
    s_mov_b32 s66, 7667712
    s_mov_b32 s67, 1152
    s_mov_b32 s68, 1051597459
    s_cselect_b32 s66, 10027008, s66
    s_cselect_b32 s67, 2304, s67
    s_cselect_b32 s68, 1.0, s68
    s_xor_b32 s65, s59, 1
    s_add_u32 s65, s65, s69
    s_add_u32 s69, s59, s69
    s_mul_i32 s69, s69, s67
    s_add_u32 s69, s69, s66
    s_mul_i32 s65, s65, s67
    s_add_u32 s65, s65, s66
    s_lshl_b32 s70, s67, 6
    s_lshl_b32 s60, s58, 2
    s_add_u32 s78, s60, 1
    s_add_u32 s79, s60, 2
    s_cmp_lg_u32 s58, 0
    s_cselect_b32 s53, 0, 3
    s_cselect_b32 s54, 7, 4
    s_mul_i32 s78, s78, s70
    s_mul_i32 s79, s79, s70
    s_mul_i32 s53, s53, s70
    s_mul_i32 s54, s54, s70
    s_add_u32 m0, s61, 34816
    s_nop 0
    buffer_load_dwordx4 v2, s[40:43], s63 offen lds
    s_add_u32 m0, s61, 35840
    s_nop 0
    buffer_load_dwordx4 v3, s[40:43], s63 offen lds
    s_add_u32 s63, s63, 64
    s_add_u32 m0, s62, 34816
    s_nop 0
    buffer_load_dwordx4 v4, s[44:47], s64 offen lds
    s_add_u32 m0, s62, 35840
    s_nop 0
    buffer_load_dwordx4 v5, s[44:47], s64 offen lds
    s_add_u32 m0, s62, 36864
    s_nop 0
    s_mov_b64 exec, s[72:73]
    buffer_load_dwordx4 v6, s[44:47], s64 offen lds
    s_mov_b64 exec, -1
    s_add_u32 s64, s64, s71
    s_add_u32 m0, s61, 52224
    s_nop 0
    buffer_load_dwordx4 v2, s[40:43], s63 offen lds
    s_add_u32 m0, s61, 53248
    s_nop 0
    buffer_load_dwordx4 v3, s[40:43], s63 offen lds
    s_add_u32 s63, s63, 64
    s_waitcnt vmcnt(12)
    s_barrier
    ds_read_b128 v[32:35], v16 offset:0
    ds_read_b64_tr_b16 v[40:41], v20 offset:0
    ds_read_b64_tr_b16 v[42:43], v20 offset:288
    ds_read_b128 v[36:39], v18 offset:0
    ds_read_b64_tr_b16 v[44:45], v21 offset:0
    ds_read_b64_tr_b16 v[46:47], v21 offset:288
    ds_read_b64_tr_b16 v[48:49], v22 offset:0
    ds_read_b64_tr_b16 v[50:51], v22 offset:288
    s_waitcnt lgkmcnt(2)
    v_mfma_f32_32x32x16_bf16 v[96:111], v[40:43], v[32:35], 0
    s_add_u32 m0, s62, 52224
    ds_read_b128 v[52:55], v17 offset:0
    ds_read_b64_tr_b16 v[60:61], v20 offset:4608
    ds_read_b64_tr_b16 v[62:63], v20 offset:4896
    buffer_load_dwordx4 v4, s[44:47], s64 offen lds
    v_mfma_f32_32x32x16_bf16 v[112:127], v[40:43], v[36:39], 0
    ds_read_b128 v[56:59], v19 offset:0
    ds_read_b64_tr_b16 v[64:65], v21 offset:4608
    ds_read_b64_tr_b16 v[66:67], v21 offset:4896
    ds_read_b64_tr_b16 v[68:69], v22 offset:4608
    v_mfma_f32_32x32x16_bf16 v[128:143], v[44:47], v[32:35], 0
    s_add_u32 m0, s62, 53248
    ds_read_b64_tr_b16 v[70:71], v22 offset:4896
    buffer_load_dwordx4 v5, s[44:47], s64 offen lds
    v_mfma_f32_32x32x16_bf16 v[144:159], v[44:47], v[36:39], 0
    s_add_u32 m0, s62, 54272
    s_mov_b64 exec, s[72:73]
    buffer_load_dwordx4 v6, s[44:47], s64 offen lds
    s_mov_b64 exec, -1
    s_add_u32 s64, s64, s71
    s_waitcnt lgkmcnt(8)
    v_mfma_f32_32x32x16_bf16 v[160:175], v[48:51], v[32:35], 0
    s_waitcnt lgkmcnt(0)
    v_mfma_f32_32x32x16_bf16 v[96:111], v[60:63], v[52:55], v[96:111]
    s_waitcnt vmcnt(10)
    s_barrier
    ds_read_b128 v[32:35], v16 offset:17408
    ds_read_b64_tr_b16 v[40:41], v20 offset:17408
    ds_read_b64_tr_b16 v[42:43], v20 offset:17696
    v_mfma_f32_32x32x16_bf16 v[112:127], v[60:63], v[56:59], v[112:127]
    ds_read_b128 v[36:39], v18 offset:17408
    ds_read_b64_tr_b16 v[44:45], v21 offset:17408
    ds_read_b64_tr_b16 v[46:47], v21 offset:17696
    ds_read_b64_tr_b16 v[48:49], v22 offset:17408
    v_mfma_f32_32x32x16_bf16 v[128:143], v[64:67], v[52:55], v[128:143]
    s_add_u32 m0, s61, 0
    ds_read_b64_tr_b16 v[50:51], v22 offset:17696
    buffer_load_dwordx4 v2, s[40:43], s63 offen lds
    v_mfma_f32_32x32x16_bf16 v[144:159], v[64:67], v[56:59], v[144:159]
    s_add_u32 m0, s61, 1024
    v_mfma_f32_32x32x16_bf16 v[160:175], v[68:71], v[52:55], v[160:175]
    buffer_load_dwordx4 v3, s[40:43], s63 offen lds
    s_add_u32 s63, s63, 64
    s_mov_b32 s60, 4
.p2align 6
L_qkv_1:
    s_waitcnt lgkmcnt(2)
    v_mfma_f32_32x32x16_bf16 v[96:111], v[40:43], v[32:35], v[96:111]
    s_add_u32 m0, s62, 0
    ds_read_b128 v[52:55], v17 offset:17408
    ds_read_b64_tr_b16 v[60:61], v20 offset:22016
    ds_read_b64_tr_b16 v[62:63], v20 offset:22304
    buffer_load_dwordx4 v4, s[44:47], s64 offen lds
    v_mfma_f32_32x32x16_bf16 v[112:127], v[40:43], v[36:39], v[112:127]
    ds_read_b128 v[56:59], v19 offset:17408
    ds_read_b64_tr_b16 v[64:65], v21 offset:22016
    ds_read_b64_tr_b16 v[66:67], v21 offset:22304
    ds_read_b64_tr_b16 v[68:69], v22 offset:22016
    v_mfma_f32_32x32x16_bf16 v[128:143], v[44:47], v[32:35], v[128:143]
    s_add_u32 m0, s62, 1024
    ds_read_b64_tr_b16 v[70:71], v22 offset:22304
    buffer_load_dwordx4 v5, s[44:47], s64 offen lds
    v_mfma_f32_32x32x16_bf16 v[144:159], v[44:47], v[36:39], v[144:159]
    s_add_u32 m0, s62, 2048
    s_mov_b64 exec, s[72:73]
    buffer_load_dwordx4 v6, s[44:47], s64 offen lds
    s_mov_b64 exec, -1
    s_add_u32 s64, s64, s71
    s_waitcnt lgkmcnt(8)
    v_mfma_f32_32x32x16_bf16 v[160:175], v[48:51], v[32:35], v[160:175]
    s_waitcnt lgkmcnt(0)
    v_mfma_f32_32x32x16_bf16 v[96:111], v[60:63], v[52:55], v[96:111]
    s_waitcnt vmcnt(10)
    s_barrier
    ds_read_b128 v[32:35], v16 offset:34816
    ds_read_b64_tr_b16 v[40:41], v20 offset:34816
    ds_read_b64_tr_b16 v[42:43], v20 offset:35104
    v_mfma_f32_32x32x16_bf16 v[112:127], v[60:63], v[56:59], v[112:127]
    ds_read_b128 v[36:39], v18 offset:34816
    ds_read_b64_tr_b16 v[44:45], v21 offset:34816
    ds_read_b64_tr_b16 v[46:47], v21 offset:35104
    ds_read_b64_tr_b16 v[48:49], v22 offset:34816
    v_mfma_f32_32x32x16_bf16 v[128:143], v[64:67], v[52:55], v[128:143]
    s_add_u32 m0, s61, 17408
    ds_read_b64_tr_b16 v[50:51], v22 offset:35104
    buffer_load_dwordx4 v2, s[40:43], s63 offen lds
    v_mfma_f32_32x32x16_bf16 v[144:159], v[64:67], v[56:59], v[144:159]
    s_add_u32 m0, s61, 18432
    v_mfma_f32_32x32x16_bf16 v[160:175], v[68:71], v[52:55], v[160:175]
    buffer_load_dwordx4 v3, s[40:43], s63 offen lds
    s_add_u32 s63, s63, 64
    s_waitcnt lgkmcnt(2)
    v_mfma_f32_32x32x16_bf16 v[96:111], v[40:43], v[32:35], v[96:111]
    s_add_u32 m0, s62, 17408
    ds_read_b128 v[52:55], v17 offset:34816
    ds_read_b64_tr_b16 v[60:61], v20 offset:39424
    ds_read_b64_tr_b16 v[62:63], v20 offset:39712
    buffer_load_dwordx4 v4, s[44:47], s64 offen lds
    v_mfma_f32_32x32x16_bf16 v[112:127], v[40:43], v[36:39], v[112:127]
    ds_read_b128 v[56:59], v19 offset:34816
    ds_read_b64_tr_b16 v[64:65], v21 offset:39424
    ds_read_b64_tr_b16 v[66:67], v21 offset:39712
    ds_read_b64_tr_b16 v[68:69], v22 offset:39424
    v_mfma_f32_32x32x16_bf16 v[128:143], v[44:47], v[32:35], v[128:143]
    s_add_u32 m0, s62, 18432
    ds_read_b64_tr_b16 v[70:71], v22 offset:39712
    buffer_load_dwordx4 v5, s[44:47], s64 offen lds
    v_mfma_f32_32x32x16_bf16 v[144:159], v[44:47], v[36:39], v[144:159]
    s_add_u32 m0, s62, 19456
    s_mov_b64 exec, s[72:73]
    buffer_load_dwordx4 v6, s[44:47], s64 offen lds
    s_mov_b64 exec, -1
    s_add_u32 s64, s64, s71
    s_waitcnt lgkmcnt(8)
    v_mfma_f32_32x32x16_bf16 v[160:175], v[48:51], v[32:35], v[160:175]
    s_cmp_gt_u32 s60, 1
    s_cselect_b32 s42, s42, 0
    s_cselect_b32 s46, s46, 0
    s_waitcnt lgkmcnt(0)
    v_mfma_f32_32x32x16_bf16 v[96:111], v[60:63], v[52:55], v[96:111]
    s_waitcnt vmcnt(10)
    s_barrier
    ds_read_b128 v[32:35], v16 offset:52224
    ds_read_b64_tr_b16 v[40:41], v20 offset:52224
    ds_read_b64_tr_b16 v[42:43], v20 offset:52512
    v_mfma_f32_32x32x16_bf16 v[112:127], v[60:63], v[56:59], v[112:127]
    ds_read_b128 v[36:39], v18 offset:52224
    ds_read_b64_tr_b16 v[44:45], v21 offset:52224
    ds_read_b64_tr_b16 v[46:47], v21 offset:52512
    ds_read_b64_tr_b16 v[48:49], v22 offset:52224
    v_mfma_f32_32x32x16_bf16 v[128:143], v[64:67], v[52:55], v[128:143]
    s_add_u32 m0, s61, 34816
    ds_read_b64_tr_b16 v[50:51], v22 offset:52512
    buffer_load_dwordx4 v2, s[40:43], s63 offen lds
    v_mfma_f32_32x32x16_bf16 v[144:159], v[64:67], v[56:59], v[144:159]
    s_add_u32 m0, s61, 35840
    v_mfma_f32_32x32x16_bf16 v[160:175], v[68:71], v[52:55], v[160:175]
    buffer_load_dwordx4 v3, s[40:43], s63 offen lds
    s_add_u32 s63, s63, 64
    s_waitcnt lgkmcnt(2)
    v_mfma_f32_32x32x16_bf16 v[96:111], v[40:43], v[32:35], v[96:111]
    s_add_u32 m0, s62, 34816
    ds_read_b128 v[52:55], v17 offset:52224
    ds_read_b64_tr_b16 v[60:61], v20 offset:56832
    ds_read_b64_tr_b16 v[62:63], v20 offset:57120
    buffer_load_dwordx4 v4, s[44:47], s64 offen lds
    v_mfma_f32_32x32x16_bf16 v[112:127], v[40:43], v[36:39], v[112:127]
    ds_read_b128 v[56:59], v19 offset:52224
    ds_read_b64_tr_b16 v[64:65], v21 offset:56832
    ds_read_b64_tr_b16 v[66:67], v21 offset:57120
    ds_read_b64_tr_b16 v[68:69], v22 offset:56832
    v_mfma_f32_32x32x16_bf16 v[128:143], v[44:47], v[32:35], v[128:143]
    s_add_u32 m0, s62, 35840
    ds_read_b64_tr_b16 v[70:71], v22 offset:57120
    buffer_load_dwordx4 v5, s[44:47], s64 offen lds
    v_mfma_f32_32x32x16_bf16 v[144:159], v[44:47], v[36:39], v[144:159]
    s_add_u32 m0, s62, 36864
    s_mov_b64 exec, s[72:73]
    buffer_load_dwordx4 v6, s[44:47], s64 offen lds
    s_mov_b64 exec, -1
    s_add_u32 s64, s64, s71
    s_waitcnt lgkmcnt(8)
    v_mfma_f32_32x32x16_bf16 v[160:175], v[48:51], v[32:35], v[160:175]
    s_waitcnt lgkmcnt(0)
    v_mfma_f32_32x32x16_bf16 v[96:111], v[60:63], v[52:55], v[96:111]
    s_waitcnt vmcnt(10)
    s_barrier
    ds_read_b128 v[32:35], v16 offset:0
    ds_read_b64_tr_b16 v[40:41], v20 offset:0
    ds_read_b64_tr_b16 v[42:43], v20 offset:288
    v_mfma_f32_32x32x16_bf16 v[112:127], v[60:63], v[56:59], v[112:127]
    ds_read_b128 v[36:39], v18 offset:0
    ds_read_b64_tr_b16 v[44:45], v21 offset:0
    ds_read_b64_tr_b16 v[46:47], v21 offset:288
    ds_read_b64_tr_b16 v[48:49], v22 offset:0
    v_mfma_f32_32x32x16_bf16 v[128:143], v[64:67], v[52:55], v[128:143]
    s_add_u32 m0, s61, 52224
    ds_read_b64_tr_b16 v[50:51], v22 offset:288
    buffer_load_dwordx4 v2, s[40:43], s63 offen lds
    v_mfma_f32_32x32x16_bf16 v[144:159], v[64:67], v[56:59], v[144:159]
    s_add_u32 m0, s61, 53248
    v_mfma_f32_32x32x16_bf16 v[160:175], v[68:71], v[52:55], v[160:175]
    buffer_load_dwordx4 v3, s[40:43], s63 offen lds
    s_add_u32 s63, s63, 64
    s_waitcnt lgkmcnt(2)
    v_mfma_f32_32x32x16_bf16 v[96:111], v[40:43], v[32:35], v[96:111]
    s_add_u32 m0, s62, 52224
    ds_read_b128 v[52:55], v17 offset:0
    ds_read_b64_tr_b16 v[60:61], v20 offset:4608
    ds_read_b64_tr_b16 v[62:63], v20 offset:4896
    buffer_load_dwordx4 v4, s[44:47], s64 offen lds
    v_mfma_f32_32x32x16_bf16 v[112:127], v[40:43], v[36:39], v[112:127]
    ds_read_b128 v[56:59], v19 offset:0
    ds_read_b64_tr_b16 v[64:65], v21 offset:4608
    ds_read_b64_tr_b16 v[66:67], v21 offset:4896
    ds_read_b64_tr_b16 v[68:69], v22 offset:4608
    v_mfma_f32_32x32x16_bf16 v[128:143], v[44:47], v[32:35], v[128:143]
    s_add_u32 m0, s62, 53248
    ds_read_b64_tr_b16 v[70:71], v22 offset:4896
    buffer_load_dwordx4 v5, s[44:47], s64 offen lds
    v_mfma_f32_32x32x16_bf16 v[144:159], v[44:47], v[36:39], v[144:159]
    s_add_u32 m0, s62, 54272
    s_mov_b64 exec, s[72:73]
    buffer_load_dwordx4 v6, s[44:47], s64 offen lds
    s_mov_b64 exec, -1
    s_add_u32 s64, s64, s71
    s_waitcnt lgkmcnt(8)
    v_mfma_f32_32x32x16_bf16 v[160:175], v[48:51], v[32:35], v[160:175]
    s_waitcnt lgkmcnt(0)
    v_mfma_f32_32x32x16_bf16 v[96:111], v[60:63], v[52:55], v[96:111]
    s_waitcnt vmcnt(10)
    s_barrier
    ds_read_b128 v[32:35], v16 offset:17408
    ds_read_b64_tr_b16 v[40:41], v20 offset:17408
    ds_read_b64_tr_b16 v[42:43], v20 offset:17696
    v_mfma_f32_32x32x16_bf16 v[112:127], v[60:63], v[56:59], v[112:127]
    ds_read_b128 v[36:39], v18 offset:17408
    ds_read_b64_tr_b16 v[44:45], v21 offset:17408
    ds_read_b64_tr_b16 v[46:47], v21 offset:17696
    ds_read_b64_tr_b16 v[48:49], v22 offset:17408
    v_mfma_f32_32x32x16_bf16 v[128:143], v[64:67], v[52:55], v[128:143]
    s_add_u32 m0, s61, 0
    ds_read_b64_tr_b16 v[50:51], v22 offset:17696
    buffer_load_dwordx4 v2, s[40:43], s63 offen lds
    v_mfma_f32_32x32x16_bf16 v[144:159], v[64:67], v[56:59], v[144:159]
    s_add_u32 m0, s61, 1024
    v_mfma_f32_32x32x16_bf16 v[160:175], v[68:71], v[52:55], v[160:175]
    buffer_load_dwordx4 v3, s[40:43], s63 offen lds
    s_add_u32 s63, s63, 64
    s_lshl_b32 s76, s52, 3
    s_add_u32 s76, s76, s60
    s_cmp_lg_u32 s76, 3
    s_cbranch_scc1 L_hint_2
    s_lshl_b32 s76, s2, 8
    s_add_u32 s76, s76, 29802496
    v_mov_b32 v8, 0
    v_mov_b32 v9, 1
    s_mov_b64 exec, 1
    buffer_store_dword v9, v8, s[48:51], s76 offen sc1
    s_mov_b64 exec, -1
L_hint_2:
    s_sub_u32 s60, s60, 1
    s_cmp_lg_u32 s60, 0
    s_cbranch_scc1 L_qkv_1
    s_waitcnt lgkmcnt(2)
    v_mfma_f32_32x32x16_bf16 v[96:111], v[40:43], v[32:35], v[96:111]
    ds_read_b128 v[52:55], v17 offset:17408
    ds_read_b64_tr_b16 v[60:61], v20 offset:22016
    ds_read_b64_tr_b16 v[62:63], v20 offset:22304
    v_mfma_f32_32x32x16_bf16 v[112:127], v[40:43], v[36:39], v[112:127]
    ds_read_b128 v[56:59], v19 offset:17408
    ds_read_b64_tr_b16 v[64:65], v21 offset:22016
    ds_read_b64_tr_b16 v[66:67], v21 offset:22304
    ds_read_b64_tr_b16 v[68:69], v22 offset:22016
    v_mfma_f32_32x32x16_bf16 v[128:143], v[44:47], v[32:35], v[128:143]
    ds_read_b64_tr_b16 v[70:71], v22 offset:22304
    v_mfma_f32_32x32x16_bf16 v[144:159], v[44:47], v[36:39], v[144:159]
    s_waitcnt lgkmcnt(8)
    v_mfma_f32_32x32x16_bf16 v[160:175], v[48:51], v[32:35], v[160:175]
    s_waitcnt lgkmcnt(0)
    v_mfma_f32_32x32x16_bf16 v[96:111], v[60:63], v[52:55], v[96:111]
    v_mfma_f32_32x32x16_bf16 v[112:127], v[60:63], v[56:59], v[112:127]
    v_mfma_f32_32x32x16_bf16 v[128:143], v[64:67], v[52:55], v[128:143]
    v_mfma_f32_32x32x16_bf16 v[144:159], v[64:67], v[56:59], v[144:159]
    v_mfma_f32_32x32x16_bf16 v[160:175], v[68:71], v[52:55], v[160:175]
    v_lshlrev_b32 v2, 4, v0
    s_nop 7
    v_mul_f32 v96, s68, v96
    v_mul_f32 v97, s68, v97
    v_mul_f32 v98, s68, v98
    v_mul_f32 v99, s68, v99
    v_mul_f32 v100, s68, v100
    v_mul_f32 v101, s68, v101
    v_mul_f32 v102, s68, v102
    v_mul_f32 v103, s68, v103
    v_mul_f32 v104, s68, v104
    v_mul_f32 v105, s68, v105
    v_mul_f32 v106, s68, v106
    v_mul_f32 v107, s68, v107
    v_mul_f32 v108, s68, v108
    v_mul_f32 v109, s68, v109
    v_mul_f32 v110, s68, v110
    v_mul_f32 v111, s68, v111
    v_cvt_pk_bf16_f32 v96, v96, v97
    v_cvt_pk_bf16_f32 v97, v98, v99
    v_cvt_pk_bf16_f32 v98, v100, v101
    v_cvt_pk_bf16_f32 v99, v102, v103
    v_cvt_pk_bf16_f32 v100, v104, v105
    v_cvt_pk_bf16_f32 v101, v106, v107
    v_cvt_pk_bf16_f32 v102, v108, v109
    v_cvt_pk_bf16_f32 v103, v110, v111
    s_add_u32 s60, s78, s69
    buffer_store_dwordx4 v[96:99], v2, s[48:51], s60 offen sc1
    s_add_u32 s60, s79, s69
    buffer_store_dwordx4 v[100:103], v2, s[48:51], s60 offen sc1
    v_mul_f32 v112, s68, v112
    v_mul_f32 v113, s68, v113
    v_mul_f32 v114, s68, v114
    v_mul_f32 v115, s68, v115
    v_mul_f32 v116, s68, v116
    v_mul_f32 v117, s68, v117
    v_mul_f32 v118, s68, v118
    v_mul_f32 v119, s68, v119
    v_mul_f32 v120, s68, v120
    v_mul_f32 v121, s68, v121
    v_mul_f32 v122, s68, v122
    v_mul_f32 v123, s68, v123
    v_mul_f32 v124, s68, v124
    v_mul_f32 v125, s68, v125
    v_mul_f32 v126, s68, v126
    v_mul_f32 v127, s68, v127
    v_cvt_pk_bf16_f32 v112, v112, v113
    v_cvt_pk_bf16_f32 v113, v114, v115
    v_cvt_pk_bf16_f32 v114, v116, v117
    v_cvt_pk_bf16_f32 v115, v118, v119
    v_cvt_pk_bf16_f32 v116, v120, v121
    v_cvt_pk_bf16_f32 v117, v122, v123
    v_cvt_pk_bf16_f32 v118, v124, v125
    v_cvt_pk_bf16_f32 v119, v126, v127
    s_add_u32 s60, s78, s65
    buffer_store_dwordx4 v[112:115], v2, s[48:51], s60 offen sc1
    s_add_u32 s60, s79, s65
    buffer_store_dwordx4 v[116:119], v2, s[48:51], s60 offen sc1
    v_mul_f32 v128, s68, v128
    v_mul_f32 v129, s68, v129
    v_mul_f32 v130, s68, v130
    v_mul_f32 v131, s68, v131
    v_mul_f32 v132, s68, v132
    v_mul_f32 v133, s68, v133
    v_mul_f32 v134, s68, v134
    v_mul_f32 v135, s68, v135
    v_mul_f32 v136, s68, v136
    v_mul_f32 v137, s68, v137
    v_mul_f32 v138, s68, v138
    v_mul_f32 v139, s68, v139
    v_mul_f32 v140, s68, v140
    v_mul_f32 v141, s68, v141
    v_mul_f32 v142, s68, v142
    v_mul_f32 v143, s68, v143
    v_cvt_pk_bf16_f32 v128, v128, v129
    v_cvt_pk_bf16_f32 v129, v130, v131
    v_cvt_pk_bf16_f32 v130, v132, v133
    v_cvt_pk_bf16_f32 v131, v134, v135
    v_cvt_pk_bf16_f32 v132, v136, v137
    v_cvt_pk_bf16_f32 v133, v138, v139
    v_cvt_pk_bf16_f32 v134, v140, v141
    v_cvt_pk_bf16_f32 v135, v142, v143
    s_add_u32 s60, s53, s69
    buffer_store_dwordx4 v[128:131], v2, s[48:51], s60 offen sc1
    s_add_u32 s60, s54, s69
    buffer_store_dwordx4 v[132:135], v2, s[48:51], s60 offen sc1
    v_mul_f32 v144, s68, v144
    v_mul_f32 v145, s68, v145
    v_mul_f32 v146, s68, v146
    v_mul_f32 v147, s68, v147
    v_mul_f32 v148, s68, v148
    v_mul_f32 v149, s68, v149
    v_mul_f32 v150, s68, v150
    v_mul_f32 v151, s68, v151
    v_mul_f32 v152, s68, v152
    v_mul_f32 v153, s68, v153
    v_mul_f32 v154, s68, v154
    v_mul_f32 v155, s68, v155
    v_mul_f32 v156, s68, v156
    v_mul_f32 v157, s68, v157
    v_mul_f32 v158, s68, v158
    v_mul_f32 v159, s68, v159
    v_cvt_pk_bf16_f32 v144, v144, v145
    v_cvt_pk_bf16_f32 v145, v146, v147
    v_cvt_pk_bf16_f32 v146, v148, v149
    v_cvt_pk_bf16_f32 v147, v150, v151
    v_cvt_pk_bf16_f32 v148, v152, v153
    v_cvt_pk_bf16_f32 v149, v154, v155
    v_cvt_pk_bf16_f32 v150, v156, v157
    v_cvt_pk_bf16_f32 v151, v158, v159
    s_add_u32 s60, s53, s65
    buffer_store_dwordx4 v[144:147], v2, s[48:51], s60 offen sc1
    s_add_u32 s60, s54, s65
    buffer_store_dwordx4 v[148:151], v2, s[48:51], s60 offen sc1
    v_mul_f32 v160, s68, v160
    v_mul_f32 v161, s68, v161
    v_mul_f32 v162, s68, v162
    v_mul_f32 v163, s68, v163
    v_mul_f32 v164, s68, v164
    v_mul_f32 v165, s68, v165
    v_mul_f32 v166, s68, v166
    v_mul_f32 v167, s68, v167
    v_cvt_pk_bf16_f32 v160, v160, v161
    v_cvt_pk_bf16_f32 v161, v162, v163
    v_cvt_pk_bf16_f32 v162, v164, v165
    v_cvt_pk_bf16_f32 v163, v166, v167
    s_lshl_b32 s60, s70, 1
    v_mul_lo_u32 v3, v11, s60
    v_lshl_add_u32 v3, v10, 2, v3
    s_mul_i32 s60, s70, 0
    s_add_u32 s60, s60, s69
    buffer_store_dword v160, v3, s[48:51], s60 offen offset:1024 sc1
    s_mul_i32 s60, s70, 1
    s_add_u32 s60, s60, s69
    buffer_store_dword v161, v3, s[48:51], s60 offen offset:1024 sc1
    s_mul_i32 s60, s70, 4
    s_add_u32 s60, s60, s69
    buffer_store_dword v162, v3, s[48:51], s60 offen offset:1024 sc1
    s_mul_i32 s60, s70, 5
    s_add_u32 s60, s60, s69
    buffer_store_dword v163, v3, s[48:51], s60 offen offset:1024 sc1
    s_branch L_qkv_done
L_qkv_v:
    s_lshl_b32 s60, s58, 7
    v_add_u32 v20, s60, v20
    v_add_u32 v21, 64, v20
    v_add_u32 v22, 256, v15
    s_and_b32 s66, s59, 3
    s_mul_i32 s67, s66, 1152
    s_xor_b32 s66, s66, 1
    s_mul_i32 s66, s66, 1152
    s_lshl_b32 s60, s58, 6
    v_add_u32 v12, s60, v10
    v_mul_u32_u24 v8, 3641, v12
    v_lshrrev_b32 v8, 16, v8
    v_mul_u32_u24 v9, 18, v8
    v_sub_u32 v7, v12, v9
    v_mul_u32_u24 v8, 4608, v8
    v_lshl_add_u32 v7, v7, 4, v8
    v_lshl_add_u32 v7, v11, 3, v7
    v_add_u32 v176, s67, v7
    v_add_u32 v177, s66, v7
    v_add_u32 v12, 32, v12
    v_mul_u32_u24 v8, 3641, v12
    v_lshrrev_b32 v8, 16, v8
    v_mul_u32_u24 v9, 18, v8
    v_sub_u32 v7, v12, v9
    v_mul_u32_u24 v8, 4608, v8
    v_lshl_add_u32 v7, v7, 4, v8
    v_lshl_add_u32 v7, v11, 3, v7
    v_add_u32 v178, s67, v7
    v_add_u32 v179, s66, v7
    v_add_u32 v12, 128, v10
    v_mul_u32_u24 v8, 3641, v12
    v_lshrrev_b32 v8, 16, v8
    v_mul_u32_u24 v9, 18, v8
    v_sub_u32 v7, v12, v9
    v_mul_u32_u24 v8, 4608, v8
    v_lshl_add_u32 v7, v7, 4, v8
    v_lshl_add_u32 v7, v11, 3, v7
    v_add_u32 v180, s67, v7
    s_lshl_b32 s60, s52, 7
    s_add_u32 s69, s69, s60
    s_and_b32 s60, s59, 60
    s_add_u32 s69, s69, s60
    s_mul_i32 s69, s69, 2304
    s_add_u32 s69, s69, 10028160
    v_add_u32 v7, 0, v0
    v_mul_u32_u24 v8, 911, v7
    v_lshrrev_b32 v8, 16, v8
    v_lshrrev_b32 v9, 2, v8
    v_mul_u32_u24 v9, 8640, v9
    v_mul_u32_u24 v8, 72, v8
    v_add3_u32 v7, v7, v8, v9
    v_lshlrev_b32 v184, 4, v7
    v_add_u32 v7, 64, v0
    v_mul_u32_u24 v8, 911, v7
    v_lshrrev_b32 v8, 16, v8
    v_lshrrev_b32 v9, 2, v8
    v_mul_u32_u24 v9, 8640, v9
    v_mul_u32_u24 v8, 72, v8
    v_add3_u32 v7, v7, v8, v9
    v_lshlrev_b32 v185, 4, v7
    v_add_u32 v7, 128, v0
    v_mul_u32_u24 v8, 911, v7
    v_lshrrev_b32 v8, 16, v8
    v_lshrrev_b32 v9, 2, v8
    v_mul_u32_u24 v9, 8640, v9
    v_mul_u32_u24 v8, 72, v8
    v_add3_u32 v7, v7, v8, v9
    v_lshlrev_b32 v186, 4, v7
    v_add_u32 v7, 192, v0
    v_mul_u32_u24 v8, 911, v7
    v_lshrrev_b32 v8, 16, v8
    v_lshrrev_b32 v9, 2, v8
    v_mul_u32_u24 v9, 8640, v9
    v_mul_u32_u24 v8, 72, v8
    v_add3_u32 v7, v7, v8, v9
    v_lshlrev_b32 v187, 4, v7
    v_add_u32 v7, 256, v0
    v_mul_u32_u24 v8, 911, v7
    v_lshrrev_b32 v8, 16, v8
    v_lshrrev_b32 v9, 2, v8
    v_mul_u32_u24 v9, 8640, v9
    v_mul_u32_u24 v8, 72, v8
    v_add3_u32 v7, v7, v8, v9
    v_lshlrev_b32 v188, 4, v7
    v_add_u32 v7, 320, v0
    v_mul_u32_u24 v8, 911, v7
    v_lshrrev_b32 v8, 16, v8
    v_lshrrev_b32 v9, 2, v8
    v_mul_u32_u24 v9, 8640, v9
    v_mul_u32_u24 v8, 72, v8
    v_add3_u32 v7, v7, v8, v9
    v_lshlrev_b32 v189, 4, v7
    v_add_u32 v7, 384, v0
    v_mul_u32_u24 v8, 911, v7
    v_lshrrev_b32 v8, 16, v8
    v_lshrrev_b32 v9, 2, v8
    v_mul_u32_u24 v9, 8640, v9
    v_mul_u32_u24 v8, 72, v8
    v_add3_u32 v7, v7, v8, v9
    v_lshlrev_b32 v190, 4, v7
    v_add_u32 v7, 448, v0
    v_mul_u32_u24 v8, 911, v7
    v_lshrrev_b32 v8, 16, v8
    v_lshrrev_b32 v9, 2, v8
    v_mul_u32_u24 v9, 8640, v9
    v_mul_u32_u24 v8, 72, v8
    v_add3_u32 v7, v7, v8, v9
    v_lshlrev_b32 v191, 4, v7
    v_add_u32 v7, 512, v0
    v_mul_u32_u24 v8, 911, v7
    v_lshrrev_b32 v8, 16, v8
    v_lshrrev_b32 v9, 2, v8
    v_mul_u32_u24 v9, 8640, v9
    v_mul_u32_u24 v8, 72, v8
    v_add3_u32 v7, v7, v8, v9
    v_lshlrev_b32 v192, 4, v7
    s_add_u32 m0, s61, 34816
    s_nop 0
    buffer_load_dwordx4 v2, s[40:43], s63 offen lds
    s_add_u32 m0, s61, 35840
    s_nop 0
    buffer_load_dwordx4 v3, s[40:43], s63 offen lds
    s_add_u32 s63, s63, 64
    s_add_u32 m0, s62, 34816
    s_nop 0
    buffer_load_dwordx4 v4, s[44:47], s64 offen lds
    s_add_u32 m0, s62, 35840
    s_nop 0
    buffer_load_dwordx4 v5, s[44:47], s64 offen lds
    s_add_u32 m0, s62, 36864
    s_nop 0
    s_mov_b64 exec, s[72:73]
    buffer_load_dwordx4 v6, s[44:47], s64 offen lds
    s_mov_b64 exec, -1
    s_add_u32 s64, s64, s71
    s_add_u32 m0, s61, 52224
    s_nop 0
    buffer_load_dwordx4 v2, s[40:43], s63 offen lds
    s_add_u32 m0, s61, 53248
    s_nop 0
    buffer_load_dwordx4 v3, s[40:43], s63 offen lds
    s_add_u32 s63, s63, 64
    s_waitcnt vmcnt(12)
    s_barrier
    ds_read_b128 v[32:35], v16 offset:0
    ds_read_b64_tr_b16 v[40:41], v20 offset:0
    ds_read_b64_tr_b16 v[42:43], v20 offset:288
    ds_read_b128 v[36:39], v18 offset:0
    ds_read_b64_tr_b16 v[44:45], v21 offset:0
    ds_read_b64_tr_b16 v[46:47], v21 offset:288
    ds_read_b64_tr_b16 v[48:49], v22 offset:0
    ds_read_b64_tr_b16 v[50:51], v22 offset:288
    s_waitcnt lgkmcnt(2)
    v_mfma_f32_32x32x16_bf16 v[96:111], v[32:35], v[40:43], 0
    s_add_u32 m0, s62, 52224
    ds_read_b128 v[52:55], v17 offset:0
    ds_read_b64_tr_b16 v[60:61], v20 offset:4608
    ds_read_b64_tr_b16 v[62:63], v20 offset:4896
    buffer_load_dwordx4 v4, s[44:47], s64 offen lds
    v_mfma_f32_32x32x16_bf16 v[112:127], v[36:39], v[40:43], 0
    ds_read_b128 v[56:59], v19 offset:0
    ds_read_b64_tr_b16 v[64:65], v21 offset:4608
    ds_read_b64_tr_b16 v[66:67], v21 offset:4896
    ds_read_b64_tr_b16 v[68:69], v22 offset:4608
    v_mfma_f32_32x32x16_bf16 v[128:143], v[32:35], v[44:47], 0
    s_add_u32 m0, s62, 53248
    ds_read_b64_tr_b16 v[70:71], v22 offset:4896
    buffer_load_dwordx4 v5, s[44:47], s64 offen lds
    v_mfma_f32_32x32x16_bf16 v[144:159], v[36:39], v[44:47], 0
    s_add_u32 m0, s62, 54272
    s_mov_b64 exec, s[72:73]
    buffer_load_dwordx4 v6, s[44:47], s64 offen lds
    s_mov_b64 exec, -1
    s_add_u32 s64, s64, s71
    s_waitcnt lgkmcnt(8)
    v_mfma_f32_32x32x16_bf16 v[160:175], v[32:35], v[48:51], 0
    s_waitcnt lgkmcnt(0)
    v_mfma_f32_32x32x16_bf16 v[96:111], v[52:55], v[60:63], v[96:111]
    s_waitcnt vmcnt(10)
    s_barrier
    ds_read_b128 v[32:35], v16 offset:17408
    ds_read_b64_tr_b16 v[40:41], v20 offset:17408
    ds_read_b64_tr_b16 v[42:43], v20 offset:17696
    v_mfma_f32_32x32x16_bf16 v[112:127], v[56:59], v[60:63], v[112:127]
    ds_read_b128 v[36:39], v18 offset:17408
    ds_read_b64_tr_b16 v[44:45], v21 offset:17408
    ds_read_b64_tr_b16 v[46:47], v21 offset:17696
    ds_read_b64_tr_b16 v[48:49], v22 offset:17408
    v_mfma_f32_32x32x16_bf16 v[128:143], v[52:55], v[64:67], v[128:143]
    s_add_u32 m0, s61, 0
    ds_read_b64_tr_b16 v[50:51], v22 offset:17696
    buffer_load_dwordx4 v2, s[40:43], s63 offen lds
    v_mfma_f32_32x32x16_bf16 v[144:159], v[56:59], v[64:67], v[144:159]
    s_add_u32 m0, s61, 1024
    v_mfma_f32_32x32x16_bf16 v[160:175], v[52:55], v[68:71], v[160:175]
    buffer_load_dwordx4 v3, s[40:43], s63 offen lds
    s_add_u32 s63, s63, 64
    s_mov_b32 s60, 4
.p2align 6
L_qkv_3:
    s_waitcnt lgkmcnt(2)
    v_mfma_f32_32x32x16_bf16 v[96:111], v[32:35], v[40:43], v[96:111]
    s_add_u32 m0, s62, 0
    ds_read_b128 v[52:55], v17 offset:17408
    ds_read_b64_tr_b16 v[60:61], v20 offset:22016
    ds_read_b64_tr_b16 v[62:63], v20 offset:22304
    buffer_load_dwordx4 v4, s[44:47], s64 offen lds
    v_mfma_f32_32x32x16_bf16 v[112:127], v[36:39], v[40:43], v[112:127]
    ds_read_b128 v[56:59], v19 offset:17408
    ds_read_b64_tr_b16 v[64:65], v21 offset:22016
    ds_read_b64_tr_b16 v[66:67], v21 offset:22304
    ds_read_b64_tr_b16 v[68:69], v22 offset:22016
    v_mfma_f32_32x32x16_bf16 v[128:143], v[32:35], v[44:47], v[128:143]
    s_add_u32 m0, s62, 1024
    ds_read_b64_tr_b16 v[70:71], v22 offset:22304
    buffer_load_dwordx4 v5, s[44:47], s64 offen lds
    v_mfma_f32_32x32x16_bf16 v[144:159], v[36:39], v[44:47], v[144:159]
    s_add_u32 m0, s62, 2048
    s_mov_b64 exec, s[72:73]
    buffer_load_dwordx4 v6, s[44:47], s64 offen lds
    s_mov_b64 exec, -1
    s_add_u32 s64, s64, s71
    s_waitcnt lgkmcnt(8)
    v_mfma_f32_32x32x16_bf16 v[160:175], v[32:35], v[48:51], v[160:175]
    s_waitcnt lgkmcnt(0)
    v_mfma_f32_32x32x16_bf16 v[96:111], v[52:55], v[60:63], v[96:111]
    s_waitcnt vmcnt(10)
    s_barrier
    ds_read_b128 v[32:35], v16 offset:34816
    ds_read_b64_tr_b16 v[40:41], v20 offset:34816
    ds_read_b64_tr_b16 v[42:43], v20 offset:35104
    v_mfma_f32_32x32x16_bf16 v[112:127], v[56:59], v[60:63], v[112:127]
    ds_read_b128 v[36:39], v18 offset:34816
    ds_read_b64_tr_b16 v[44:45], v21 offset:34816
    ds_read_b64_tr_b16 v[46:47], v21 offset:35104
    ds_read_b64_tr_b16 v[48:49], v22 offset:34816
    v_mfma_f32_32x32x16_bf16 v[128:143], v[52:55], v[64:67], v[128:143]
    s_add_u32 m0, s61, 17408
    ds_read_b64_tr_b16 v[50:51], v22 offset:35104
    buffer_load_dwordx4 v2, s[40:43], s63 offen lds
    v_mfma_f32_32x32x16_bf16 v[144:159], v[56:59], v[64:67], v[144:159]
    s_add_u32 m0, s61, 18432
    v_mfma_f32_32x32x16_bf16 v[160:175], v[52:55], v[68:71], v[160:175]
    buffer_load_dwordx4 v3, s[40:43], s63 offen lds
    s_add_u32 s63, s63, 64
    s_waitcnt lgkmcnt(2)
    v_mfma_f32_32x32x16_bf16 v[96:111], v[32:35], v[40:43], v[96:111]
    s_add_u32 m0, s62, 17408
    ds_read_b128 v[52:55], v17 offset:34816
    ds_read_b64_tr_b16 v[60:61], v20 offset:39424
    ds_read_b64_tr_b16 v[62:63], v20 offset:39712
    buffer_load_dwordx4 v4, s[44:47], s64 offen lds
    v_mfma_f32_32x32x16_bf16 v[112:127], v[36:39], v[40:43], v[112:127]
    ds_read_b128 v[56:59], v19 offset:34816
    ds_read_b64_tr_b16 v[64:65], v21 offset:39424
    ds_read_b64_tr_b16 v[66:67], v21 offset:39712
    ds_read_b64_tr_b16 v[68:69], v22 offset:39424
    v_mfma_f32_32x32x16_bf16 v[128:143], v[32:35], v[44:47], v[128:143]
    s_add_u32 m0, s62, 18432
    ds_read_b64_tr_b16 v[70:71], v22 offset:39712
    buffer_load_dwordx4 v5, s[44:47], s64 offen lds
    v_mfma_f32_32x32x16_bf16 v[144:159], v[36:39], v[44:47], v[144:159]
    s_add_u32 m0, s62, 19456
    s_mov_b64 exec, s[72:73]
    buffer_load_dwordx4 v6, s[44:47], s64 offen lds
    s_mov_b64 exec, -1
    s_add_u32 s64, s64, s71
    s_waitcnt lgkmcnt(8)
    v_mfma_f32_32x32x16_bf16 v[160:175], v[32:35], v[48:51], v[160:175]
    s_cmp_gt_u32 s60, 1
    s_cselect_b32 s42, s42, 0
    s_cselect_b32 s46, s46, 0
    s_waitcnt lgkmcnt(0)
    v_mfma_f32_32x32x16_bf16 v[96:111], v[52:55], v[60:63], v[96:111]
    s_waitcnt vmcnt(10)
    s_barrier
    ds_read_b128 v[32:35], v16 offset:52224
    ds_read_b64_tr_b16 v[40:41], v20 offset:52224
    ds_read_b64_tr_b16 v[42:43], v20 offset:52512
    v_mfma_f32_32x32x16_bf16 v[112:127], v[56:59], v[60:63], v[112:127]
    ds_read_b128 v[36:39], v18 offset:52224
    ds_read_b64_tr_b16 v[44:45], v21 offset:52224
    ds_read_b64_tr_b16 v[46:47], v21 offset:52512
    ds_read_b64_tr_b16 v[48:49], v22 offset:52224
    v_mfma_f32_32x32x16_bf16 v[128:143], v[52:55], v[64:67], v[128:143]
    s_add_u32 m0, s61, 34816
    ds_read_b64_tr_b16 v[50:51], v22 offset:52512
    buffer_load_dwordx4 v2, s[40:43], s63 offen lds
    v_mfma_f32_32x32x16_bf16 v[144:159], v[56:59], v[64:67], v[144:159]
    s_add_u32 m0, s61, 35840
    v_mfma_f32_32x32x16_bf16 v[160:175], v[52:55], v[68:71], v[160:175]
    buffer_load_dwordx4 v3, s[40:43], s63 offen lds
    s_add_u32 s63, s63, 64
    s_waitcnt lgkmcnt(2)
    v_mfma_f32_32x32x16_bf16 v[96:111], v[32:35], v[40:43], v[96:111]
    s_add_u32 m0, s62, 34816
    ds_read_b128 v[52:55], v17 offset:52224
    ds_read_b64_tr_b16 v[60:61], v20 offset:56832
    ds_read_b64_tr_b16 v[62:63], v20 offset:57120
    buffer_load_dwordx4 v4, s[44:47], s64 offen lds
    v_mfma_f32_32x32x16_bf16 v[112:127], v[36:39], v[40:43], v[112:127]
    ds_read_b128 v[56:59], v19 offset:52224
    ds_read_b64_tr_b16 v[64:65], v21 offset:56832
    ds_read_b64_tr_b16 v[66:67], v21 offset:57120
    ds_read_b64_tr_b16 v[68:69], v22 offset:56832
    v_mfma_f32_32x32x16_bf16 v[128:143], v[32:35], v[44:47], v[128:143]
    s_add_u32 m0, s62, 35840
    ds_read_b64_tr_b16 v[70:71], v22 offset:57120
    buffer_load_dwordx4 v5, s[44:47], s64 offen lds
    v_mfma_f32_32x32x16_bf16 v[144:159], v[36:39], v[44:47], v[144:159]
    s_add_u32 m0, s62, 36864
    s_mov_b64 exec, s[72:73]
    buffer_load_dwordx4 v6, s[44:47], s64 offen lds
    s_mov_b64 exec, -1
    s_add_u32 s64, s64, s71
    s_waitcnt lgkmcnt(8)
    v_mfma_f32_32x32x16_bf16 v[160:175], v[32:35], v[48:51], v[160:175]
    s_waitcnt lgkmcnt(0)
    v_mfma_f32_32x32x16_bf16 v[96:111], v[52:55], v[60:63], v[96:111]
    s_waitcnt vmcnt(10)
    s_barrier
    ds_read_b128 v[32:35], v16 offset:0
    ds_read_b64_tr_b16 v[40:41], v20 offset:0
    ds_read_b64_tr_b16 v[42:43], v20 offset:288
    v_mfma_f32_32x32x16_bf16 v[112:127], v[56:59], v[60:63], v[112:127]
    ds_read_b128 v[36:39], v18 offset:0
    ds_read_b64_tr_b16 v[44:45], v21 offset:0
    ds_read_b64_tr_b16 v[46:47], v21 offset:288
    ds_read_b64_tr_b16 v[48:49], v22 offset:0
    v_mfma_f32_32x32x16_bf16 v[128:143], v[52:55], v[64:67], v[128:143]
    s_add_u32 m0, s61, 52224
    ds_read_b64_tr_b16 v[50:51], v22 offset:288
    buffer_load_dwordx4 v2, s[40:43], s63 offen lds
    v_mfma_f32_32x32x16_bf16 v[144:159], v[56:59], v[64:67], v[144:159]
    s_add_u32 m0, s61, 53248
    v_mfma_f32_32x32x16_bf16 v[160:175], v[52:55], v[68:71], v[160:175]
    buffer_load_dwordx4 v3, s[40:43], s63 offen lds
    s_add_u32 s63, s63, 64
    s_waitcnt lgkmcnt(2)
    v_mfma_f32_32x32x16_bf16 v[96:111], v[32:35], v[40:43], v[96:111]
    s_add_u32 m0, s62, 52224
    ds_read_b128 v[52:55], v17 offset:0
    ds_read_b64_tr_b16 v[60:61], v20 offset:4608
    ds_read_b64_tr_b16 v[62:63], v20 offset:4896
    buffer_load_dwordx4 v4, s[44:47], s64 offen lds
    v_mfma_f32_32x32x16_bf16 v[112:127], v[36:39], v[40:43], v[112:127]
    ds_read_b128 v[56:59], v19 offset:0
    ds_read_b64_tr_b16 v[64:65], v21 offset:4608
    ds_read_b64_tr_b16 v[66:67], v21 offset:4896
    ds_read_b64_tr_b16 v[68:69], v22 offset:4608
    v_mfma_f32_32x32x16_bf16 v[128:143], v[32:35], v[44:47], v[128:143]
    s_add_u32 m0, s62, 53248
    ds_read_b64_tr_b16 v[70:71], v22 offset:4896
    buffer_load_dwordx4 v5, s[44:47], s64 offen lds
    v_mfma_f32_32x32x16_bf16 v[144:159], v[36:39], v[44:47], v[144:159]
    s_add_u32 m0, s62, 54272
    s_mov_b64 exec, s[72:73]
    buffer_load_dwordx4 v6, s[44:47], s64 offen lds
    s_mov_b64 exec, -1
    s_add_u32 s64, s64, s71
    s_waitcnt lgkmcnt(8)
    v_mfma_f32_32x32x16_bf16 v[160:175], v[32:35], v[48:51], v[160:175]
    s_waitcnt lgkmcnt(0)
    v_mfma_f32_32x32x16_bf16 v[96:111], v[52:55], v[60:63], v[96:111]
    s_waitcnt vmcnt(10)
    s_barrier
    ds_read_b128 v[32:35], v16 offset:17408
    ds_read_b64_tr_b16 v[40:41], v20 offset:17408
    ds_read_b64_tr_b16 v[42:43], v20 offset:17696
    v_mfma_f32_32x32x16_bf16 v[112:127], v[56:59], v[60:63], v[112:127]
    ds_read_b128 v[36:39], v18 offset:17408
    ds_read_b64_tr_b16 v[44:45], v21 offset:17408
    ds_read_b64_tr_b16 v[46:47], v21 offset:17696
    ds_read_b64_tr_b16 v[48:49], v22 offset:17408
    v_mfma_f32_32x32x16_bf16 v[128:143], v[52:55], v[64:67], v[128:143]
    s_add_u32 m0, s61, 0
    ds_read_b64_tr_b16 v[50:51], v22 offset:17696
    buffer_load_dwordx4 v2, s[40:43], s63 offen lds
    v_mfma_f32_32x32x16_bf16 v[144:159], v[56:59], v[64:67], v[144:159]
    s_add_u32 m0, s61, 1024
    v_mfma_f32_32x32x16_bf16 v[160:175], v[52:55], v[68:71], v[160:175]
    buffer_load_dwordx4 v3, s[40:43], s63 offen lds
    s_add_u32 s63, s63, 64
    s_lshl_b32 s76, s52, 3
    s_add_u32 s76, s76, s60
    s_cmp_lg_u32 s76, 3
    s_cbranch_scc1 L_hint_4
    s_lshl_b32 s76, s2, 8
    s_add_u32 s76, s76, 29802496
    v_mov_b32 v8, 0
    v_mov_b32 v9, 1
    s_mov_b64 exec, 1
    buffer_store_dword v9, v8, s[48:51], s76 offen sc1
    s_mov_b64 exec, -1
L_hint_4:
    s_sub_u32 s60, s60, 1
    s_cmp_lg_u32 s60, 0
    s_cbranch_scc1 L_qkv_3
    s_waitcnt lgkmcnt(2)
    v_mfma_f32_32x32x16_bf16 v[96:111], v[32:35], v[40:43], v[96:111]
    ds_read_b128 v[52:55], v17 offset:17408
    ds_read_b64_tr_b16 v[60:61], v20 offset:22016
    ds_read_b64_tr_b16 v[62:63], v20 offset:22304
    v_mfma_f32_32x32x16_bf16 v[112:127], v[36:39], v[40:43], v[112:127]
    ds_read_b128 v[56:59], v19 offset:17408
    ds_read_b64_tr_b16 v[64:65], v21 offset:22016
    ds_read_b64_tr_b16 v[66:67], v21 offset:22304
    ds_read_b64_tr_b16 v[68:69], v22 offset:22016
    v_mfma_f32_32x32x16_bf16 v[128:143], v[32:35], v[44:47], v[128:143]
    ds_read_b64_tr_b16 v[70:71], v22 offset:22304
    v_mfma_f32_32x32x16_bf16 v[144:159], v[36:39], v[44:47], v[144:159]
    s_waitcnt lgkmcnt(8)
    v_mfma_f32_32x32x16_bf16 v[160:175], v[32:35], v[48:51], v[160:175]
    s_waitcnt lgkmcnt(0)
    v_mfma_f32_32x32x16_bf16 v[96:111], v[52:55], v[60:63], v[96:111]
    v_mfma_f32_32x32x16_bf16 v[112:127], v[56:59], v[60:63], v[112:127]
    v_mfma_f32_32x32x16_bf16 v[128:143], v[52:55], v[64:67], v[128:143]
    v_mfma_f32_32x32x16_bf16 v[144:159], v[56:59], v[64:67], v[144:159]
    v_mfma_f32_32x32x16_bf16 v[160:175], v[52:55], v[68:71], v[160:175]
    v_lshlrev_b32 v2, 4, v0
    s_mul_i32 s60, s52, 9216
    v_add_u32 v3, s60, v2
    s_waitcnt vmcnt(0)
    s_barrier
    s_nop 3
    v_cvt_pk_bf16_f32 v32, v96, v97
    v_cvt_pk_bf16_f32 v34, v98, v99
    v_cvt_pk_bf16_f32 v33, v100, v101
    v_cvt_pk_bf16_f32 v35, v102, v103
    v_cvt_pk_bf16_f32 v36, v104, v105
    v_cvt_pk_bf16_f32 v38, v106, v107
    v_cvt_pk_bf16_f32 v37, v108, v109
    v_cvt_pk_bf16_f32 v39, v110, v111
    ds_write_b64 v176, v[32:33] offset:0
    ds_write_b64 v176, v[34:35] offset:288
    ds_write_b64 v176, v[36:37] offset:576
    ds_write_b64 v176, v[38:39] offset:864
    v_cvt_pk_bf16_f32 v40, v112, v113
    v_cvt_pk_bf16_f32 v42, v114, v115
    v_cvt_pk_bf16_f32 v41, v116, v117
    v_cvt_pk_bf16_f32 v43, v118, v119
    v_cvt_pk_bf16_f32 v44, v120, v121
    v_cvt_pk_bf16_f32 v46, v122, v123
    v_cvt_pk_bf16_f32 v45, v124, v125
    v_cvt_pk_bf16_f32 v47, v126, v127
    ds_write_b64 v177, v[40:41] offset:0
    ds_write_b64 v177, v[42:43] offset:288
    ds_write_b64 v177, v[44:45] offset:576
    ds_write_b64 v177, v[46:47] offset:864
    v_cvt_pk_bf16_f32 v48, v128, v129
    v_cvt_pk_bf16_f32 v50, v130, v131
    v_cvt_pk_bf16_f32 v49, v132, v133
    v_cvt_pk_bf16_f32 v51, v134, v135
    v_cvt_pk_bf16_f32 v52, v136, v137
    v_cvt_pk_bf16_f32 v54, v138, v139
    v_cvt_pk_bf16_f32 v53, v140, v141
    v_cvt_pk_bf16_f32 v55, v142, v143
    ds_write_b64 v178, v[48:49] offset:0
    ds_write_b64 v178, v[50:51] offset:288
    ds_write_b64 v178, v[52:53] offset:576
    ds_write_b64 v178, v[54:55] offset:864
    v_cvt_pk_bf16_f32 v56, v144, v145
    v_cvt_pk_bf16_f32 v58, v146, v147
    v_cvt_pk_bf16_f32 v57, v148, v149
    v_cvt_pk_bf16_f32 v59, v150, v151
    v_cvt_pk_bf16_f32 v60, v152, v153
    v_cvt_pk_bf16_f32 v62, v154, v155
    v_cvt_pk_bf16_f32 v61, v156, v157
    v_cvt_pk_bf16_f32 v63, v158, v159
    ds_write_b64 v179, v[56:57] offset:0
    ds_write_b64 v179, v[58:59] offset:288
    ds_write_b64 v179, v[60:61] offset:576
    ds_write_b64 v179, v[62:63] offset:864
    v_cvt_pk_bf16_f32 v64, v160, v161
    v_cvt_pk_bf16_f32 v66, v162, v163
    v_cvt_pk_bf16_f32 v65, v164, v165
    v_cvt_pk_bf16_f32 v67, v166, v167
    v_cvt_pk_bf16_f32 v68, v168, v169
    v_cvt_pk_bf16_f32 v70, v170, v171
    v_cvt_pk_bf16_f32 v69, v172, v173
    v_cvt_pk_bf16_f32 v71, v174, v175
    s_mov_b32 exec_lo, 0xffff
    s_mov_b32 exec_hi, 0xffff
    ds_write_b64 v180, v[64:65] offset:0
    ds_write_b64 v180, v[66:67] offset:288
    ds_write_b64 v180, v[68:69] offset:576
    ds_write_b64 v180, v[70:71] offset:864
    s_mov_b64 exec, -1
    s_waitcnt lgkmcnt(0)
    s_barrier
    ds_read_b128 v[32:35], v3 offset:0
    ds_read_b128 v[36:39], v3 offset:1024
    ds_read_b128 v[40:43], v3 offset:2048
    ds_read_b128 v[44:47], v3 offset:3072
    ds_read_b128 v[48:51], v3 offset:4096
    ds_read_b128 v[52:55], v3 offset:5120
    ds_read_b128 v[56:59], v3 offset:6144
    ds_read_b128 v[60:63], v3 offset:7168
    ds_read_b128 v[64:67], v3 offset:8192
    s_waitcnt lgkmcnt(8)
    buffer_store_dwordx4 v[32:35], v184, s[48:51], s69 offen sc1
    s_waitcnt lgkmcnt(7)
    buffer_store_dwordx4 v[36:39], v185, s[48:51], s69 offen sc1
    s_waitcnt lgkmcnt(6)
    buffer_store_dwordx4 v[40:43], v186, s[48:51], s69 offen sc1
    s_waitcnt lgkmcnt(5)
    buffer_store_dwordx4 v[44:47], v187, s[48:51], s69 offen sc1
    s_waitcnt lgkmcnt(4)
    buffer_store_dwordx4 v[48:51], v188, s[48:51], s69 offen sc1
    s_waitcnt lgkmcnt(3)
    buffer_store_dwordx4 v[52:55], v189, s[48:51], s69 offen sc1
    s_waitcnt lgkmcnt(2)
    buffer_store_dwordx4 v[56:59], v190, s[48:51], s69 offen sc1
    s_waitcnt lgkmcnt(1)
    buffer_store_dwordx4 v[60:63], v191, s[48:51], s69 offen sc1
    s_waitcnt lgkmcnt(0)
    buffer_store_dwordx4 v[64:67], v192, s[48:51], s69 offen sc1
L_qkv_done:
    s_and_b32 s72, s56, 3
    s_lshl_b32 s72, s72, 12
    s_and_b32 s73, s55, 12
    s_add_u32 s72, s72, s73
    s_add_u32 s72, s72, 29900800
    s_cmp_lg_u32 s52, 0
    s_cbranch_scc1 L_pub_6
    s_buffer_load_dword s75, s[84:87], 0
    s_waitcnt lgkmcnt(0)
    s_cmp_ge_u32 s75, 1
    s_cbranch_scc1 L_ini_7
    v_mov_b32 v5, 0
    s_mov_b32 s74, 0
L_inir_8:
    s_sleep 6
    s_mov_b64 exec, 1
    buffer_load_dword v6, v5, s[84:87], 0 offen offset:0 sc1
    s_mov_b64 exec, -1
    s_waitcnt vmcnt(0)
    v_readfirstlane_b32 s75, v6
    s_add_u32 s74, s74, 1
    s_cmp_ge_u32 s75, 1
    s_cbranch_scc1 L_ini_7
    s_cmp_lt_u32 s74, 262144
    s_cbranch_scc1 L_inir_8
L_ini_7:
L_pub_6:
    s_waitcnt vmcnt(0)
    s_barrier
    s_cmp_lg_u32 s52, 0
    s_cbranch_scc1 L_pub_5
    v_lshlrev_b32 v5, 8, v0
    v_mov_b32 v6, 1
    s_mov_b32 exec_lo, 65535
    s_mov_b32 exec_hi, 0
    buffer_atomic_add v6, v5, s[48:51], s72 offen sc1
    s_mov_b64 exec, -1
L_pub_5:
    s_branch L_attn
L_ln:
    s_sub_u32 s3, s2, 192
    s_mov_b32 s40, s16
    s_mov_b32 s41, s17
    s_mov_b32 s42, 2359296
    s_mov_b32 s43, 0x00020000
    v_lshrrev_b32 v2, 3, v0
    v_and_b32 v3, 7, v0
    s_lshl_b32 s53, s52, 3
    v_add_u32 v4, s53, v2
    s_and_b32 s58, s3, 7
    s_lshr_b32 s56, s3, 3
    s_lshl_b32 s58, s58, 3
    s_add_u32 s58, s58, s56
    s_lshl_b32 s56, s58, 5
    v_add_u32 v6, s56, v4
    v_mul_u32_u24 v7, 1152, v6
    v_lshl_add_u32 v7, v3, 4, v7
    buffer_load_dwordx4 v[160:163], v7, s[40:43], 0 offen offset:0
    buffer_load_dwordx4 v[164:167], v7, s[40:43], 0 offen offset:128
    buffer_load_dwordx4 v[168:171], v7, s[40:43], 0 offen offset:256
    buffer_load_dwordx4 v[172:175], v7, s[40:43], 0 offen offset:384
    buffer_load_dwordx4 v[176:179], v7, s[40:43], 0 offen offset:512
    buffer_load_dwordx4 v[180:183], v7, s[40:43], 0 offen offset:640
    buffer_load_dwordx4 v[184:187], v7, s[40:43], 0 offen offset:768
    buffer_load_dwordx4 v[188:191], v7, s[40:43], 0 offen offset:896
    buffer_load_dwordx4 v[192:195], v7, s[40:43], 0 offen offset:1024
    s_mov_b32 s44, s32
    s_mov_b32 s45, s33
    s_mov_b32 s46, 1152
    s_mov_b32 s47, 0x00020000
    v_lshlrev_b32 v8, 4, v3
    buffer_load_dwordx4 v[196:199], v8, s[44:47], 0 offen offset:0
    buffer_load_dwordx4 v[200:203], v8, s[44:47], 0 offen offset:128
    buffer_load_dwordx4 v[204:207], v8, s[44:47], 0 offen offset:256
    buffer_load_dwordx4 v[208:211], v8, s[44:47], 0 offen offset:384
    buffer_load_dwordx4 v[212:215], v8, s[44:47], 0 offen offset:512
    buffer_load_dwordx4 v[216:219], v8, s[44:47], 0 offen offset:640
    buffer_load_dwordx4 v[220:223], v8, s[44:47], 0 offen offset:768
    buffer_load_dwordx4 v[224:227], v8, s[44:47], 0 offen offset:896
    buffer_load_dwordx4 v[228:231], v8, s[44:47], 0 offen offset:1024
    s_mul_i32 s57, s58, 36864
    s_add_u32 s57, s57, 0
    v_mov_b32 v8, 0
    v_mov_b32 v9, 0
    s_waitcnt vmcnt(17)
    v_lshlrev_b32 v88, 16, v160
    v_and_b32 v89, 0xffff0000, v160
    v_pk_add_f32 v[8:9], v[8:9], v[88:89]
    v_lshlrev_b32 v90, 16, v161
    v_and_b32 v91, 0xffff0000, v161
    v_pk_add_f32 v[8:9], v[8:9], v[90:91]
    v_lshlrev_b32 v92, 16, v162
    v_and_b32 v93, 0xffff0000, v162
    v_pk_add_f32 v[8:9], v[8:9], v[92:93]
    v_lshlrev_b32 v94, 16, v163
    v_and_b32 v95, 0xffff0000, v163
    v_pk_add_f32 v[8:9], v[8:9], v[94:95]
    s_waitcnt vmcnt(16)
    v_lshlrev_b32 v96, 16, v164
    v_and_b32 v97, 0xffff0000, v164
    v_pk_add_f32 v[8:9], v[8:9], v[96:97]
    v_lshlrev_b32 v98, 16, v165
    v_and_b32 v99, 0xffff0000, v165
    v_pk_add_f32 v[8:9], v[8:9], v[98:99]
    v_lshlrev_b32 v100, 16, v166
    v_and_b32 v101, 0xffff0000, v166
    v_pk_add_f32 v[8:9], v[8:9], v[100:101]
    v_lshlrev_b32 v102, 16, v167
    v_and_b32 v103, 0xffff0000, v167
    v_pk_add_f32 v[8:9], v[8:9], v[102:103]
    s_waitcnt vmcnt(15)
    v_lshlrev_b32 v104, 16, v168
    v_and_b32 v105, 0xffff0000, v168
    v_pk_add_f32 v[8:9], v[8:9], v[104:105]
    v_lshlrev_b32 v106, 16, v169
    v_and_b32 v107, 0xffff0000, v169
    v_pk_add_f32 v[8:9], v[8:9], v[106:107]
    v_lshlrev_b32 v108, 16, v170
    v_and_b32 v109, 0xffff0000, v170
    v_pk_add_f32 v[8:9], v[8:9], v[108:109]
    v_lshlrev_b32 v110, 16, v171
    v_and_b32 v111, 0xffff0000, v171
    v_pk_add_f32 v[8:9], v[8:9], v[110:111]
    s_waitcnt vmcnt(14)
    v_lshlrev_b32 v112, 16, v172
    v_and_b32 v113, 0xffff0000, v172
    v_pk_add_f32 v[8:9], v[8:9], v[112:113]
    v_lshlrev_b32 v114, 16, v173
    v_and_b32 v115, 0xffff0000, v173
    v_pk_add_f32 v[8:9], v[8:9], v[114:115]
    v_lshlrev_b32 v116, 16, v174
    v_and_b32 v117, 0xffff0000, v174
    v_pk_add_f32 v[8:9], v[8:9], v[116:117]
    v_lshlrev_b32 v118, 16, v175
    v_and_b32 v119, 0xffff0000, v175
    v_pk_add_f32 v[8:9], v[8:9], v[118:119]
    s_waitcnt vmcnt(13)
    v_lshlrev_b32 v120, 16, v176
    v_and_b32 v121, 0xffff0000, v176
    v_pk_add_f32 v[8:9], v[8:9], v[120:121]
    v_lshlrev_b32 v122, 16, v177
    v_and_b32 v123, 0xffff0000, v177
    v_pk_add_f32 v[8:9], v[8:9], v[122:123]
    v_lshlrev_b32 v124, 16, v178
    v_and_b32 v125, 0xffff0000, v178
    v_pk_add_f32 v[8:9], v[8:9], v[124:125]
    v_lshlrev_b32 v126, 16, v179
    v_and_b32 v127, 0xffff0000, v179
    v_pk_add_f32 v[8:9], v[8:9], v[126:127]
    s_waitcnt vmcnt(12)
    v_lshlrev_b32 v128, 16, v180
    v_and_b32 v129, 0xffff0000, v180
    v_pk_add_f32 v[8:9], v[8:9], v[128:129]
    v_lshlrev_b32 v130, 16, v181
    v_and_b32 v131, 0xffff0000, v181
    v_pk_add_f32 v[8:9], v[8:9], v[130:131]
    v_lshlrev_b32 v132, 16, v182
    v_and_b32 v133, 0xffff0000, v182
    v_pk_add_f32 v[8:9], v[8:9], v[132:133]
    v_lshlrev_b32 v134, 16, v183
    v_and_b32 v135, 0xffff0000, v183
    v_pk_add_f32 v[8:9], v[8:9], v[134:135]
    s_waitcnt vmcnt(11)
    v_lshlrev_b32 v136, 16, v184
    v_and_b32 v137, 0xffff0000, v184
    v_pk_add_f32 v[8:9], v[8:9], v[136:137]
    v_lshlrev_b32 v138, 16, v185
    v_and_b32 v139, 0xffff0000, v185
    v_pk_add_f32 v[8:9], v[8:9], v[138:139]
    v_lshlrev_b32 v140, 16, v186
    v_and_b32 v141, 0xffff0000, v186
    v_pk_add_f32 v[8:9], v[8:9], v[140:141]
    v_lshlrev_b32 v142, 16, v187
    v_and_b32 v143, 0xffff0000, v187
    v_pk_add_f32 v[8:9], v[8:9], v[142:143]
    s_waitcnt vmcnt(10)
    v_lshlrev_b32 v144, 16, v188
    v_and_b32 v145, 0xffff0000, v188
    v_pk_add_f32 v[8:9], v[8:9], v[144:145]
    v_lshlrev_b32 v146, 16, v189
    v_and_b32 v147, 0xffff0000, v189
    v_pk_add_f32 v[8:9], v[8:9], v[146:147]
    v_lshlrev_b32 v148, 16, v190
    v_and_b32 v149, 0xffff0000, v190
    v_pk_add_f32 v[8:9], v[8:9], v[148:149]
    v_lshlrev_b32 v150, 16, v191
    v_and_b32 v151, 0xffff0000, v191
    v_pk_add_f32 v[8:9], v[8:9], v[150:151]
    s_waitcnt vmcnt(9)
    v_lshlrev_b32 v152, 16, v192
    v_and_b32 v153, 0xffff0000, v192
    v_pk_add_f32 v[8:9], v[8:9], v[152:153]
    v_lshlrev_b32 v154, 16, v193
    v_and_b32 v155, 0xffff0000, v193
    v_pk_add_f32 v[8:9], v[8:9], v[154:155]
    v_lshlrev_b32 v156, 16, v194
    v_and_b32 v157, 0xffff0000, v194
    v_pk_add_f32 v[8:9], v[8:9], v[156:157]
    v_lshlrev_b32 v158, 16, v195
    v_and_b32 v159, 0xffff0000, v195
    v_pk_add_f32 v[8:9], v[8:9], v[158:159]
    v_add_f32 v8, v8, v9
    s_nop 1
    v_add_f32_dpp v8, v8, v8 quad_perm:[1,0,3,2] row_mask:0xf bank_mask:0xf
    s_nop 1
    v_add_f32_dpp v8, v8, v8 quad_perm:[2,3,0,1] row_mask:0xf bank_mask:0xf
    s_nop 1
    v_add_f32_dpp v8, v8, v8 row_half_mirror row_mask:0xf bank_mask:0xf
    v_mul_f32 v8, 3135475257, v8
    v_mov_b32 v10, 0
    v_mov_b32 v9, v8
    v_mov_b32 v11, 0
    v_pk_add_f32 v[88:89], v[88:89], v[8:9]
    v_pk_add_f32 v[90:91], v[90:91], v[8:9]
    v_pk_add_f32 v[92:93], v[92:93], v[8:9]
    v_pk_add_f32 v[94:95], v[94:95], v[8:9]
    v_pk_add_f32 v[96:97], v[96:97], v[8:9]
    v_pk_add_f32 v[98:99], v[98:99], v[8:9]
    v_pk_add_f32 v[100:101], v[100:101], v[8:9]
    v_pk_add_f32 v[102:103], v[102:103], v[8:9]
    v_pk_add_f32 v[104:105], v[104:105], v[8:9]
    v_pk_add_f32 v[106:107], v[106:107], v[8:9]
    v_pk_add_f32 v[108:109], v[108:109], v[8:9]
    v_pk_add_f32 v[110:111], v[110:111], v[8:9]
    v_pk_add_f32 v[112:113], v[112:113], v[8:9]
    v_pk_add_f32 v[114:115], v[114:115], v[8:9]
    v_pk_add_f32 v[116:117], v[116:117], v[8:9]
    v_pk_add_f32 v[118:119], v[118:119], v[8:9]
    v_pk_add_f32 v[120:121], v[120:121], v[8:9]
    v_pk_add_f32 v[122:123], v[122:123], v[8:9]
    v_pk_add_f32 v[124:125], v[124:125], v[8:9]
    v_pk_add_f32 v[126:127], v[126:127], v[8:9]
    v_pk_add_f32 v[128:129], v[128:129], v[8:9]
    v_pk_add_f32 v[130:131], v[130:131], v[8:9]
    v_pk_add_f32 v[132:133], v[132:133], v[8:9]
    v_pk_add_f32 v[134:135], v[134:135], v[8:9]
    v_pk_add_f32 v[136:137], v[136:137], v[8:9]
    v_pk_add_f32 v[138:139], v[138:139], v[8:9]
    v_pk_add_f32 v[140:141], v[140:141], v[8:9]
    v_pk_add_f32 v[142:143], v[142:143], v[8:9]
    v_pk_add_f32 v[144:145], v[144:145], v[8:9]
    v_pk_add_f32 v[146:147], v[146:147], v[8:9]
    v_pk_add_f32 v[148:149], v[148:149], v[8:9]
    v_pk_add_f32 v[150:151], v[150:151], v[8:9]
    v_pk_add_f32 v[152:153], v[152:153], v[8:9]
    v_pk_add_f32 v[154:155], v[154:155], v[8:9]
    v_pk_add_f32 v[156:157], v[156:157], v[8:9]
    v_pk_add_f32 v[158:159], v[158:159], v[8:9]
    v_pk_fma_f32 v[10:11], v[88:89], v[88:89], v[10:11]
    v_pk_fma_f32 v[10:11], v[90:91], v[90:91], v[10:11]
    v_pk_fma_f32 v[10:11], v[92:93], v[92:93], v[10:11]
    v_pk_fma_f32 v[10:11], v[94:95], v[94:95], v[10:11]
    v_pk_fma_f32 v[10:11], v[96:97], v[96:97], v[10:11]
    v_pk_fma_f32 v[10:11], v[98:99], v[98:99], v[10:11]
    v_pk_fma_f32 v[10:11], v[100:101], v[100:101], v[10:11]
    v_pk_fma_f32 v[10:11], v[102:103], v[102:103], v[10:11]
    v_pk_fma_f32 v[10:11], v[104:105], v[104:105], v[10:11]
    v_pk_fma_f32 v[10:11], v[106:107], v[106:107], v[10:11]
    v_pk_fma_f32 v[10:11], v[108:109], v[108:109], v[10:11]
    v_pk_fma_f32 v[10:11], v[110:111], v[110:111], v[10:11]
    v_pk_fma_f32 v[10:11], v[112:113], v[112:113], v[10:11]
    v_pk_fma_f32 v[10:11], v[114:115], v[114:115], v[10:11]
    v_pk_fma_f32 v[10:11], v[116:117], v[116:117], v[10:11]
    v_pk_fma_f32 v[10:11], v[118:119], v[118:119], v[10:11]
    v_pk_fma_f32 v[10:11], v[120:121], v[120:121], v[10:11]
    v_pk_fma_f32 v[10:11], v[122:123], v[122:123], v[10:11]
    v_pk_fma_f32 v[10:11], v[124:125], v[124:125], v[10:11]
    v_pk_fma_f32 v[10:11], v[126:127], v[126:127], v[10:11]
    v_pk_fma_f32 v[10:11], v[128:129], v[128:129], v[10:11]
    v_pk_fma_f32 v[10:11], v[130:131], v[130:131], v[10:11]
    v_pk_fma_f32 v[10:11], v[132:133], v[132:133], v[10:11]
    v_pk_fma_f32 v[10:11], v[134:135], v[134:135], v[10:11]
    v_pk_fma_f32 v[10:11], v[136:137], v[136:137], v[10:11]
    v_pk_fma_f32 v[10:11], v[138:139], v[138:139], v[10:11]
    v_pk_fma_f32 v[10:11], v[140:141], v[140:141], v[10:11]
    v_pk_fma_f32 v[10:11], v[142:143], v[142:143], v[10:11]
    v_pk_fma_f32 v[10:11], v[144:145], v[144:145], v[10:11]
    v_pk_fma_f32 v[10:11], v[146:147], v[146:147], v[10:11]
    v_pk_fma_f32 v[10:11], v[148:149], v[148:149], v[10:11]
    v_pk_fma_f32 v[10:11], v[150:151], v[150:151], v[10:11]
    v_pk_fma_f32 v[10:11], v[152:153], v[152:153], v[10:11]
    v_pk_fma_f32 v[10:11], v[154:155], v[154:155], v[10:11]
    v_pk_fma_f32 v[10:11], v[156:157], v[156:157], v[10:11]
    v_pk_fma_f32 v[10:11], v[158:159], v[158:159], v[10:11]
    v_add_f32 v10, v10, v11
    s_nop 1
    v_add_f32_dpp v10, v10, v10 quad_perm:[1,0,3,2] row_mask:0xf bank_mask:0xf
    s_nop 1
    v_add_f32_dpp v10, v10, v10 quad_perm:[2,3,0,1] row_mask:0xf bank_mask:0xf
    s_nop 1
    v_add_f32_dpp v10, v10, v10 row_half_mirror row_mask:0xf bank_mask:0xf
    v_mov_b32 v12, 925353388
    v_fmac_f32 v12, 987991609, v10
    v_rsq_f32 v12, v12
    s_nop 0
    v_mov_b32 v13, v12
    v_pk_mul_f32 v[88:89], v[88:89], v[12:13]
    v_pk_mul_f32 v[90:91], v[90:91], v[12:13]
    v_pk_mul_f32 v[92:93], v[92:93], v[12:13]
    v_pk_mul_f32 v[94:95], v[94:95], v[12:13]
    v_pk_mul_f32 v[96:97], v[96:97], v[12:13]
    v_pk_mul_f32 v[98:99], v[98:99], v[12:13]
    v_pk_mul_f32 v[100:101], v[100:101], v[12:13]
    v_pk_mul_f32 v[102:103], v[102:103], v[12:13]
    v_pk_mul_f32 v[104:105], v[104:105], v[12:13]
    v_pk_mul_f32 v[106:107], v[106:107], v[12:13]
    v_pk_mul_f32 v[108:109], v[108:109], v[12:13]
    v_pk_mul_f32 v[110:111], v[110:111], v[12:13]
    v_pk_mul_f32 v[112:113], v[112:113], v[12:13]
    v_pk_mul_f32 v[114:115], v[114:115], v[12:13]
    v_pk_mul_f32 v[116:117], v[116:117], v[12:13]
    v_pk_mul_f32 v[118:119], v[118:119], v[12:13]
    v_pk_mul_f32 v[120:121], v[120:121], v[12:13]
    v_pk_mul_f32 v[122:123], v[122:123], v[12:13]
    v_pk_mul_f32 v[124:125], v[124:125], v[12:13]
    v_pk_mul_f32 v[126:127], v[126:127], v[12:13]
    v_pk_mul_f32 v[128:129], v[128:129], v[12:13]
    v_pk_mul_f32 v[130:131], v[130:131], v[12:13]
    v_pk_mul_f32 v[132:133], v[132:133], v[12:13]
    v_pk_mul_f32 v[134:135], v[134:135], v[12:13]
    v_pk_mul_f32 v[136:137], v[136:137], v[12:13]
    v_pk_mul_f32 v[138:139], v[138:139], v[12:13]
    v_pk_mul_f32 v[140:141], v[140:141], v[12:13]
    v_pk_mul_f32 v[142:143], v[142:143], v[12:13]
    v_pk_mul_f32 v[144:145], v[144:145], v[12:13]
    v_pk_mul_f32 v[146:147], v[146:147], v[12:13]
    v_pk_mul_f32 v[148:149], v[148:149], v[12:13]
    v_pk_mul_f32 v[150:151], v[150:151], v[12:13]
    v_pk_mul_f32 v[152:153], v[152:153], v[12:13]
    v_pk_mul_f32 v[154:155], v[154:155], v[12:13]
    v_pk_mul_f32 v[156:157], v[156:157], v[12:13]
    v_pk_mul_f32 v[158:159], v[158:159], v[12:13]
    v_cvt_pk_bf16_f32 v16, v88, v89
    v_cvt_pk_bf16_f32 v17, v90, v91
    v_cvt_pk_bf16_f32 v18, v92, v93
    v_cvt_pk_bf16_f32 v19, v94, v95
    v_cvt_pk_bf16_f32 v20, v96, v97
    v_cvt_pk_bf16_f32 v21, v98, v99
    v_cvt_pk_bf16_f32 v22, v100, v101
    v_cvt_pk_bf16_f32 v23, v102, v103
    v_cvt_pk_bf16_f32 v24, v104, v105
    v_cvt_pk_bf16_f32 v25, v106, v107
    v_cvt_pk_bf16_f32 v26, v108, v109
    v_cvt_pk_bf16_f32 v27, v110, v111
    v_cvt_pk_bf16_f32 v28, v112, v113
    v_cvt_pk_bf16_f32 v29, v114, v115
    v_cvt_pk_bf16_f32 v30, v116, v117
    v_cvt_pk_bf16_f32 v31, v118, v119
    v_cvt_pk_bf16_f32 v32, v120, v121
    v_cvt_pk_bf16_f32 v33, v122, v123
    v_cvt_pk_bf16_f32 v34, v124, v125
    v_cvt_pk_bf16_f32 v35, v126, v127
    v_cvt_pk_bf16_f32 v36, v128, v129
    v_cvt_pk_bf16_f32 v37, v130, v131
    v_cvt_pk_bf16_f32 v38, v132, v133
    v_cvt_pk_bf16_f32 v39, v134, v135
    v_cvt_pk_bf16_f32 v40, v136, v137
    v_cvt_pk_bf16_f32 v41, v138, v139
    v_cvt_pk_bf16_f32 v42, v140, v141
    v_cvt_pk_bf16_f32 v43, v142, v143
    v_cvt_pk_bf16_f32 v44, v144, v145
    v_cvt_pk_bf16_f32 v45, v146, v147
    v_cvt_pk_bf16_f32 v46, v148, v149
    v_cvt_pk_bf16_f32 v47, v150, v151
    v_cvt_pk_bf16_f32 v48, v152, v153
    v_cvt_pk_bf16_f32 v49, v154, v155
    v_cvt_pk_bf16_f32 v50, v156, v157
    v_cvt_pk_bf16_f32 v51, v158, v159
    v_mul_u32_u24 v5, 1216, v4
    v_lshl_add_u32 v5, v3, 4, v5
    ds_write_b128 v5, v[16:19] offset:0
    ds_write_b128 v5, v[20:23] offset:128
    ds_write_b128 v5, v[24:27] offset:256
    ds_write_b128 v5, v[28:31] offset:384
    ds_write_b128 v5, v[32:35] offset:512
    ds_write_b128 v5, v[36:39] offset:640
    ds_write_b128 v5, v[40:43] offset:768
    ds_write_b128 v5, v[44:47] offset:896
    ds_write_b128 v5, v[48:51] offset:1024
    s_lshr_b32 s55, s52, 1
    s_and_b32 s56, s52, 1
    v_lshrrev_b32 v6, 5, v0
    v_bfe_u32 v7, v0, 2, 2
    v_lshl_add_u32 v6, v6, 3, v7
    s_lshl_b32 s60, s55, 4
    v_add_u32 v6, s60, v6
    v_mul_u32_u24 v6, 1216, v6
    v_bfe_u32 v7, v0, 4, 1
    v_lshl_add_u32 v6, v7, 5, v6
    v_and_b32 v7, 3, v0
    v_lshl_add_u32 v6, v7, 3, v6
    s_mul_i32 s60, s56, 576
    v_add_u32 v6, s60, v6
    s_mul_i32 s60, s52, 9216
    s_add_u32 s57, s57, s60
    v_lshlrev_b32 v7, 4, v0
    s_waitcnt lgkmcnt(0)
    s_barrier
    ds_read_b64_tr_b16 v[16:17], v6 offset:0
    ds_read_b64_tr_b16 v[18:19], v6 offset:4864
    ds_read_b64_tr_b16 v[20:21], v6 offset:64
    ds_read_b64_tr_b16 v[22:23], v6 offset:4928
    ds_read_b64_tr_b16 v[24:25], v6 offset:128
    ds_read_b64_tr_b16 v[26:27], v6 offset:4992
    ds_read_b64_tr_b16 v[28:29], v6 offset:192
    ds_read_b64_tr_b16 v[30:31], v6 offset:5056
    ds_read_b64_tr_b16 v[32:33], v6 offset:256
    ds_read_b64_tr_b16 v[34:35], v6 offset:5120
    ds_read_b64_tr_b16 v[36:37], v6 offset:320
    ds_read_b64_tr_b16 v[38:39], v6 offset:5184
    ds_read_b64_tr_b16 v[40:41], v6 offset:384
    ds_read_b64_tr_b16 v[42:43], v6 offset:5248
    s_waitcnt lgkmcnt(12)
    buffer_store_dwordx4 v[16:19], v7, s[48:51], s57 offen offset:0 sc1
    ds_read_b64_tr_b16 v[44:45], v6 offset:448
    ds_read_b64_tr_b16 v[46:47], v6 offset:5312
    s_waitcnt lgkmcnt(12)
    buffer_store_dwordx4 v[20:23], v7, s[48:51], s57 offen offset:1024 sc1
    ds_read_b64_tr_b16 v[48:49], v6 offset:512
    ds_read_b64_tr_b16 v[50:51], v6 offset:5376
    s_waitcnt lgkmcnt(12)
    buffer_store_dwordx4 v[24:27], v7, s[48:51], s57 offen offset:2048 sc1
    s_waitcnt lgkmcnt(10)
    buffer_store_dwordx4 v[28:31], v7, s[48:51], s57 offen offset:3072 sc1
    s_waitcnt lgkmcnt(8)
    s_add_u32 s57, s57, 4096
    buffer_store_dwordx4 v[32:35], v7, s[48:51], s57 offen offset:0 sc1
    s_waitcnt lgkmcnt(6)
    buffer_store_dwordx4 v[36:39], v7, s[48:51], s57 offen offset:1024 sc1
    s_waitcnt lgkmcnt(4)
    buffer_store_dwordx4 v[40:43], v7, s[48:51], s57 offen offset:2048 sc1
    s_waitcnt lgkmcnt(2)
    buffer_store_dwordx4 v[44:47], v7, s[48:51], s57 offen offset:3072 sc1
    s_waitcnt lgkmcnt(0)
    s_add_u32 s57, s57, 4096
    buffer_store_dwordx4 v[48:51], v7, s[48:51], s57 offen offset:0 sc1
    s_lshr_b32 s72, s58, 4
    s_lshl_b32 s72, s72, 13
    s_add_u32 s72, s72, 29868032
    s_cmp_lg_u32 s52, 0
    s_cbranch_scc1 L_pub_10
    s_buffer_load_dword s75, s[84:87], 0
    s_waitcnt lgkmcnt(0)
    s_cmp_ge_u32 s75, 1
    s_cbranch_scc1 L_ini_11
    v_mov_b32 v5, 0
    s_mov_b32 s74, 0
L_inir_12:
    s_sleep 6
    s_mov_b64 exec, 1
    buffer_load_dword v6, v5, s[84:87], 0 offen offset:0 sc1
    s_mov_b64 exec, -1
    s_waitcnt vmcnt(0)
    v_readfirstlane_b32 s75, v6
    s_add_u32 s74, s74, 1
    s_cmp_ge_u32 s75, 1
    s_cbranch_scc1 L_ini_11
    s_cmp_lt_u32 s74, 262144
    s_cbranch_scc1 L_inir_12
L_ini_11:
L_pub_10:
    s_waitcnt vmcnt(0)
    s_barrier
    s_cmp_lg_u32 s52, 0
    s_cbranch_scc1 L_pub_9
    v_lshlrev_b32 v5, 8, v0
    v_mov_b32 v6, 1
    s_mov_b32 exec_lo, 4294967295
    s_mov_b32 exec_hi, 0
    buffer_atomic_add v6, v5, s[48:51], s72 offen sc1
    s_mov_b64 exec, -1
L_pub_9:
    v_mov_b32 v8, 0
    v_mov_b32 v9, 0
    v_lshlrev_b32 v12, 16, v196
    v_and_b32 v13, 0xffff0000, v196
    v_lshlrev_b32 v14, 16, v160
    v_and_b32 v15, 0xffff0000, v160
    v_pk_fma_f32 v[8:9], v[12:13], v[14:15], v[8:9]
    v_lshlrev_b32 v12, 16, v197
    v_and_b32 v13, 0xffff0000, v197
    v_lshlrev_b32 v14, 16, v161
    v_and_b32 v15, 0xffff0000, v161
    v_pk_fma_f32 v[8:9], v[12:13], v[14:15], v[8:9]
    v_lshlrev_b32 v12, 16, v198
    v_and_b32 v13, 0xffff0000, v198
    v_lshlrev_b32 v14, 16, v162
    v_and_b32 v15, 0xffff0000, v162
    v_pk_fma_f32 v[8:9], v[12:13], v[14:15], v[8:9]
    v_lshlrev_b32 v12, 16, v199
    v_and_b32 v13, 0xffff0000, v199
    v_lshlrev_b32 v14, 16, v163
    v_and_b32 v15, 0xffff0000, v163
    v_pk_fma_f32 v[8:9], v[12:13], v[14:15], v[8:9]
    v_lshlrev_b32 v12, 16, v200
    v_and_b32 v13, 0xffff0000, v200
    v_lshlrev_b32 v14, 16, v164
    v_and_b32 v15, 0xffff0000, v164
    v_pk_fma_f32 v[8:9], v[12:13], v[14:15], v[8:9]
    v_lshlrev_b32 v12, 16, v201
    v_and_b32 v13, 0xffff0000, v201
    v_lshlrev_b32 v14, 16, v165
    v_and_b32 v15, 0xffff0000, v165
    v_pk_fma_f32 v[8:9], v[12:13], v[14:15], v[8:9]
    v_lshlrev_b32 v12, 16, v202
    v_and_b32 v13, 0xffff0000, v202
    v_lshlrev_b32 v14, 16, v166
    v_and_b32 v15, 0xffff0000, v166
    v_pk_fma_f32 v[8:9], v[12:13], v[14:15], v[8:9]
    v_lshlrev_b32 v12, 16, v203
    v_and_b32 v13, 0xffff0000, v203
    v_lshlrev_b32 v14, 16, v167
    v_and_b32 v15, 0xffff0000, v167
    v_pk_fma_f32 v[8:9], v[12:13], v[14:15], v[8:9]
    v_lshlrev_b32 v12, 16, v204
    v_and_b32 v13, 0xffff0000, v204
    v_lshlrev_b32 v14, 16, v168
    v_and_b32 v15, 0xffff0000, v168
    v_pk_fma_f32 v[8:9], v[12:13], v[14:15], v[8:9]
    v_lshlrev_b32 v12, 16, v205
    v_and_b32 v13, 0xffff0000, v205
    v_lshlrev_b32 v14, 16, v169
    v_and_b32 v15, 0xffff0000, v169
    v_pk_fma_f32 v[8:9], v[12:13], v[14:15], v[8:9]
    v_lshlrev_b32 v12, 16, v206
    v_and_b32 v13, 0xffff0000, v206
    v_lshlrev_b32 v14, 16, v170
    v_and_b32 v15, 0xffff0000, v170
    v_pk_fma_f32 v[8:9], v[12:13], v[14:15], v[8:9]
    v_lshlrev_b32 v12, 16, v207
    v_and_b32 v13, 0xffff0000, v207
    v_lshlrev_b32 v14, 16, v171
    v_and_b32 v15, 0xffff0000, v171
    v_pk_fma_f32 v[8:9], v[12:13], v[14:15], v[8:9]
    v_lshlrev_b32 v12, 16, v208
    v_and_b32 v13, 0xffff0000, v208
    v_lshlrev_b32 v14, 16, v172
    v_and_b32 v15, 0xffff0000, v172
    v_pk_fma_f32 v[8:9], v[12:13], v[14:15], v[8:9]
    v_lshlrev_b32 v12, 16, v209
    v_and_b32 v13, 0xffff0000, v209
    v_lshlrev_b32 v14, 16, v173
    v_and_b32 v15, 0xffff0000, v173
    v_pk_fma_f32 v[8:9], v[12:13], v[14:15], v[8:9]
    v_lshlrev_b32 v12, 16, v210
    v_and_b32 v13, 0xffff0000, v210
    v_lshlrev_b32 v14, 16, v174
    v_and_b32 v15, 0xffff0000, v174
    v_pk_fma_f32 v[8:9], v[12:13], v[14:15], v[8:9]
    v_lshlrev_b32 v12, 16, v211
    v_and_b32 v13, 0xffff0000, v211
    v_lshlrev_b32 v14, 16, v175
    v_and_b32 v15, 0xffff0000, v175
    v_pk_fma_f32 v[8:9], v[12:13], v[14:15], v[8:9]
    v_lshlrev_b32 v12, 16, v212
    v_and_b32 v13, 0xffff0000, v212
    v_lshlrev_b32 v14, 16, v176
    v_and_b32 v15, 0xffff0000, v176
    v_pk_fma_f32 v[8:9], v[12:13], v[14:15], v[8:9]
    v_lshlrev_b32 v12, 16, v213
    v_and_b32 v13, 0xffff0000, v213
    v_lshlrev_b32 v14, 16, v177
    v_and_b32 v15, 0xffff0000, v177
    v_pk_fma_f32 v[8:9], v[12:13], v[14:15], v[8:9]
    v_lshlrev_b32 v12, 16, v214
    v_and_b32 v13, 0xffff0000, v214
    v_lshlrev_b32 v14, 16, v178
    v_and_b32 v15, 0xffff0000, v178
    v_pk_fma_f32 v[8:9], v[12:13], v[14:15], v[8:9]
    v_lshlrev_b32 v12, 16, v215
    v_and_b32 v13, 0xffff0000, v215
    v_lshlrev_b32 v14, 16, v179
    v_and_b32 v15, 0xffff0000, v179
    v_pk_fma_f32 v[8:9], v[12:13], v[14:15], v[8:9]
    v_lshlrev_b32 v12, 16, v216
    v_and_b32 v13, 0xffff0000, v216
    v_lshlrev_b32 v14, 16, v180
    v_and_b32 v15, 0xffff0000, v180
    v_pk_fma_f32 v[8:9], v[12:13], v[14:15], v[8:9]
    v_lshlrev_b32 v12, 16, v217
    v_and_b32 v13, 0xffff0000, v217
    v_lshlrev_b32 v14, 16, v181
    v_and_b32 v15, 0xffff0000, v181
    v_pk_fma_f32 v[8:9], v[12:13], v[14:15], v[8:9]
    v_lshlrev_b32 v12, 16, v218
    v_and_b32 v13, 0xffff0000, v218
    v_lshlrev_b32 v14, 16, v182
    v_and_b32 v15, 0xffff0000, v182
    v_pk_fma_f32 v[8:9], v[12:13], v[14:15], v[8:9]
    v_lshlrev_b32 v12, 16, v219
    v_and_b32 v13, 0xffff0000, v219
    v_lshlrev_b32 v14, 16, v183
    v_and_b32 v15, 0xffff0000, v183
    v_pk_fma_f32 v[8:9], v[12:13], v[14:15], v[8:9]
    v_lshlrev_b32 v12, 16, v220
    v_and_b32 v13, 0xffff0000, v220
    v_lshlrev_b32 v14, 16, v184
    v_and_b32 v15, 0xffff0000, v184
    v_pk_fma_f32 v[8:9], v[12:13], v[14:15], v[8:9]
    v_lshlrev_b32 v12, 16, v221
    v_and_b32 v13, 0xffff0000, v221
    v_lshlrev_b32 v14, 16, v185
    v_and_b32 v15, 0xffff0000, v185
    v_pk_fma_f32 v[8:9], v[12:13], v[14:15], v[8:9]
    v_lshlrev_b32 v12, 16, v222
    v_and_b32 v13, 0xffff0000, v222
    v_lshlrev_b32 v14, 16, v186
    v_and_b32 v15, 0xffff0000, v186
    v_pk_fma_f32 v[8:9], v[12:13], v[14:15], v[8:9]
    v_lshlrev_b32 v12, 16, v223
    v_and_b32 v13, 0xffff0000, v223
    v_lshlrev_b32 v14, 16, v187
    v_and_b32 v15, 0xffff0000, v187
    v_pk_fma_f32 v[8:9], v[12:13], v[14:15], v[8:9]
    v_lshlrev_b32 v12, 16, v224
    v_and_b32 v13, 0xffff0000, v224
    v_lshlrev_b32 v14, 16, v188
    v_and_b32 v15, 0xffff0000, v188
    v_pk_fma_f32 v[8:9], v[12:13], v[14:15], v[8:9]
    v_lshlrev_b32 v12, 16, v225
    v_and_b32 v13, 0xffff0000, v225
    v_lshlrev_b32 v14, 16, v189
    v_and_b32 v15, 0xffff0000, v189
    v_pk_fma_f32 v[8:9], v[12:13], v[14:15], v[8:9]
    v_lshlrev_b32 v12, 16, v226
    v_and_b32 v13, 0xffff0000, v226
    v_lshlrev_b32 v14, 16, v190
    v_and_b32 v15, 0xffff0000, v190
    v_pk_fma_f32 v[8:9], v[12:13], v[14:15], v[8:9]
    v_lshlrev_b32 v12, 16, v227
    v_and_b32 v13, 0xffff0000, v227
    v_lshlrev_b32 v14, 16, v191
    v_and_b32 v15, 0xffff0000, v191
    v_pk_fma_f32 v[8:9], v[12:13], v[14:15], v[8:9]
    v_lshlrev_b32 v12, 16, v228
    v_and_b32 v13, 0xffff0000, v228
    v_lshlrev_b32 v14, 16, v192
    v_and_b32 v15, 0xffff0000, v192
    v_pk_fma_f32 v[8:9], v[12:13], v[14:15], v[8:9]
    v_lshlrev_b32 v12, 16, v229
    v_and_b32 v13, 0xffff0000, v229
    v_lshlrev_b32 v14, 16, v193
    v_and_b32 v15, 0xffff0000, v193
    v_pk_fma_f32 v[8:9], v[12:13], v[14:15], v[8:9]
    v_lshlrev_b32 v12, 16, v230
    v_and_b32 v13, 0xffff0000, v230
    v_lshlrev_b32 v14, 16, v194
    v_and_b32 v15, 0xffff0000, v194
    v_pk_fma_f32 v[8:9], v[12:13], v[14:15], v[8:9]
    v_lshlrev_b32 v12, 16, v231
    v_and_b32 v13, 0xffff0000, v231
    v_lshlrev_b32 v14, 16, v195
    v_and_b32 v15, 0xffff0000, v195
    v_pk_fma_f32 v[8:9], v[12:13], v[14:15], v[8:9]
    v_add_f32 v8, v8, v9
    s_nop 1
    v_add_f32_dpp v8, v8, v8 quad_perm:[1,0,3,2] row_mask:0xf bank_mask:0xf
    s_nop 1
    v_add_f32_dpp v8, v8, v8 quad_perm:[2,3,0,1] row_mask:0xf bank_mask:0xf
    s_nop 1
    v_add_f32_dpp v8, v8, v8 row_half_mirror row_mask:0xf bank_mask:0xf
    v_mul_f32 v8, 3216550459, v8
    v_exp_f32 v8, v8
    s_lshl_b32 s56, s58, 5
    v_add_f32 v8, 1.0, v8
    v_rcp_f32 v8, v8
    v_add_u32 v6, s56, v4
    v_lshlrev_b32 v6, 2, v6
    s_mov_b32 s57, 17768448
    s_mov_b32 exec_lo, 0x01010101
    s_mov_b32 exec_hi, 0x01010101
    buffer_store_dword v8, v6, s[48:51], s57 offen sc1
    s_mov_b64 exec, -1
    s_cmp_ge_u32 s3, 18
    s_cbranch_scc1 L_nowo
    s_mov_b32 s40, s20
    s_mov_b32 s41, s21
    s_mov_b32 s42, 663552
    s_mov_b32 s43, 0x00020000
    v_lshrrev_b32 v2, 3, v0
    v_and_b32 v3, 7, v0
    s_lshl_b32 s53, s52, 3
    v_add_u32 v4, s53, v2
    s_lshl_b32 s57, s3, 1
    s_lshr_b32 s55, s52, 1
    s_add_u32 s57, s57, s55
    s_and_b32 s56, s52, 1
    s_lshl_b32 s56, s56, 2
    s_lshl_b32 s57, s57, 4
    s_add_u32 s57, s57, s56
    v_lshrrev_b32 v6, 2, v2
    v_and_b32 v7, 3, v2
    v_lshl_add_u32 v6, v6, 3, v7
    v_add_u32 v6, s57, v6
    v_mul_u32_u24 v7, 1152, v6
    v_lshl_add_u32 v7, v3, 4, v7
    buffer_load_dwordx4 v[16:19], v7, s[40:43], 0 offen offset:0
    buffer_load_dwordx4 v[20:23], v7, s[40:43], 0 offen offset:128
    buffer_load_dwordx4 v[24:27], v7, s[40:43], 0 offen offset:256
    buffer_load_dwordx4 v[28:31], v7, s[40:43], 0 offen offset:384
    buffer_load_dwordx4 v[32:35], v7, s[40:43], 0 offen offset:512
    buffer_load_dwordx4 v[36:39], v7, s[40:43], 0 offen offset:640
    buffer_load_dwordx4 v[40:43], v7, s[40:43], 0 offen offset:768
    buffer_load_dwordx4 v[44:47], v7, s[40:43], 0 offen offset:896
    buffer_load_dwordx4 v[48:51], v7, s[40:43], 0 offen offset:1024
    s_mul_i32 s57, s3, 36864
    s_add_u32 s57, s57, 17104896
    s_waitcnt vmcnt(0)
    v_mul_u32_u24 v5, 1216, v4
    v_lshl_add_u32 v5, v3, 4, v5
    ds_write_b128 v5, v[16:19] offset:0
    ds_write_b128 v5, v[20:23] offset:128
    ds_write_b128 v5, v[24:27] offset:256
    ds_write_b128 v5, v[28:31] offset:384
    ds_write_b128 v5, v[32:35] offset:512
    ds_write_b128 v5, v[36:39] offset:640
    ds_write_b128 v5, v[40:43] offset:768
    ds_write_b128 v5, v[44:47] offset:896
    ds_write_b128 v5, v[48:51] offset:1024
    s_lshr_b32 s55, s52, 1
    s_and_b32 s56, s52, 1
    v_lshrrev_b32 v6, 5, v0
    v_bfe_u32 v7, v0, 2, 2
    v_lshl_add_u32 v6, v6, 3, v7
    s_lshl_b32 s60, s55, 4
    v_add_u32 v6, s60, v6
    v_mul_u32_u24 v6, 1216, v6
    v_bfe_u32 v7, v0, 4, 1
    v_lshl_add_u32 v6, v7, 5, v6
    v_and_b32 v7, 3, v0
    v_lshl_add_u32 v6, v7, 3, v6
    s_mul_i32 s60, s56, 576
    v_add_u32 v6, s60, v6
    s_mul_i32 s60, s52, 9216
    s_add_u32 s57, s57, s60
    v_lshlrev_b32 v7, 4, v0
    s_waitcnt lgkmcnt(0)
    s_barrier
    ds_read_b64_tr_b16 v[16:17], v6 offset:0
    ds_read_b64_tr_b16 v[18:19], v6 offset:4864
    ds_read_b64_tr_b16 v[20:21], v6 offset:64
    ds_read_b64_tr_b16 v[22:23], v6 offset:4928
    ds_read_b64_tr_b16 v[24:25], v6 offset:128
    ds_read_b64_tr_b16 v[26:27], v6 offset:4992
    ds_read_b64_tr_b16 v[28:29], v6 offset:192
    ds_read_b64_tr_b16 v[30:31], v6 offset:5056
    ds_read_b64_tr_b16 v[32:33], v6 offset:256
    ds_read_b64_tr_b16 v[34:35], v6 offset:5120
    ds_read_b64_tr_b16 v[36:37], v6 offset:320
    ds_read_b64_tr_b16 v[38:39], v6 offset:5184
    ds_read_b64_tr_b16 v[40:41], v6 offset:384
    ds_read_b64_tr_b16 v[42:43], v6 offset:5248
    s_waitcnt lgkmcnt(12)
    buffer_store_dwordx4 v[16:19], v7, s[48:51], s57 offen offset:0 sc1
    ds_read_b64_tr_b16 v[44:45], v6 offset:448
    ds_read_b64_tr_b16 v[46:47], v6 offset:5312
    s_waitcnt lgkmcnt(12)
    buffer_store_dwordx4 v[20:23], v7, s[48:51], s57 offen offset:1024 sc1
    ds_read_b64_tr_b16 v[48:49], v6 offset:512
    ds_read_b64_tr_b16 v[50:51], v6 offset:5376
    s_waitcnt lgkmcnt(12)
    buffer_store_dwordx4 v[24:27], v7, s[48:51], s57 offen offset:2048 sc1
    s_waitcnt lgkmcnt(10)
    buffer_store_dwordx4 v[28:31], v7, s[48:51], s57 offen offset:3072 sc1
    s_waitcnt lgkmcnt(8)
    s_add_u32 s57, s57, 4096
    buffer_store_dwordx4 v[32:35], v7, s[48:51], s57 offen offset:0 sc1
    s_waitcnt lgkmcnt(6)
    buffer_store_dwordx4 v[36:39], v7, s[48:51], s57 offen offset:1024 sc1
    s_waitcnt lgkmcnt(4)
    buffer_store_dwordx4 v[40:43], v7, s[48:51], s57 offen offset:2048 sc1
    s_waitcnt lgkmcnt(2)
    buffer_store_dwordx4 v[44:47], v7, s[48:51], s57 offen offset:3072 sc1
    s_waitcnt lgkmcnt(0)
    s_add_u32 s57, s57, 4096
    buffer_store_dwordx4 v[48:51], v7, s[48:51], s57 offen offset:0 sc1
L_nowo:
    s_mov_b32 s72, 29786112
    s_cmp_lg_u32 s52, 0
    s_cbranch_scc1 L_pub_14
    s_buffer_load_dword s75, s[84:87], 128
    s_waitcnt lgkmcnt(0)
    s_cmp_ge_u32 s75, 24
    s_cbranch_scc1 L_ini_15
    v_mov_b32 v5, 0
    s_mov_b32 s74, 0
L_inir_16:
    s_sleep 6
    s_mov_b64 exec, 1
    buffer_load_dword v6, v5, s[84:87], 0 offen offset:128 sc1
    s_mov_b64 exec, -1
    s_waitcnt vmcnt(0)
    v_readfirstlane_b32 s75, v6
    s_add_u32 s74, s74, 1
    s_cmp_ge_u32 s75, 24
    s_cbranch_scc1 L_ini_15
    s_cmp_lt_u32 s74, 262144
    s_cbranch_scc1 L_inir_16
L_ini_15:
L_pub_14:
    s_waitcnt vmcnt(0)
    s_barrier
    s_cmp_lg_u32 s52, 0
    s_cbranch_scc1 L_pub_13
    v_lshlrev_b32 v5, 8, v0
    v_mov_b32 v6, 1
    s_mov_b32 exec_lo, 4294967295
    s_mov_b32 exec_hi, 0
    buffer_atomic_add v6, v5, s[48:51], s72 offen sc1
    s_mov_b64 exec, -1
L_pub_13:
L_attn:
    s_and_b32 s61, s2, 7
    s_lshl_b32 s61, s61, 2
    s_bfe_u32 s62, s2, 0x20003
    s_add_u32 s61, s61, s62
    s_lshr_b32 s62, s2, 5
    s_lshl_b32 s62, s62, 3
    s_lshl_b32 s63, s52, 1
    s_add_u32 s62, s62, s63
    s_mul_i32 s54, s61, 147456
    s_add_u32 s54, s54, 10027008
    s_lshl_b32 s64, s52, 10
    s_add_u32 s65, s64, 36864
    v_lshlrev_b32 v5, 4, v0
    v_add_u32 v4, s64, v5
    s_lshl_b32 s63, s61, 6
    s_add_u32 s63, s63, s62
    s_mul_i32 s63, s63, 1152
    s_add_u32 s63, s63, 7667712
    v_and_b32 v6, 31, v0
    v_lshlrev_b32 v7, 2, v6
    s_mov_b32 s56, 0
    v_mov_b32 v29, 0x3f803f80
    v_mov_b32 v17, 0
    v_mov_b32 v31, 0x3f803f80
    v_mov_b32 v19, 0
    v_mov_b32 v32, 0
    v_mov_b32 v33, 0
    v_mov_b32 v34, 0
    v_mov_b32 v35, 0
    v_mov_b32 v36, 0
    v_mov_b32 v37, 0
    v_mov_b32 v38, 0
    v_mov_b32 v39, 0
    v_mov_b32 v40, 0
    v_mov_b32 v41, 0
    v_mov_b32 v42, 0
    v_mov_b32 v43, 0
    v_mov_b32 v44, 0
    v_mov_b32 v45, 0
    v_mov_b32 v46, 0
    v_mov_b32 v47, 0
    s_mov_b32 exec_lo, 50529027
    s_mov_b32 exec_hi, 50529027
    v_mov_b32 v36, 0x3f803f80
    v_mov_b32 v37, 0x3f803f80
    v_mov_b32 v44, 0x3f803f80
    v_mov_b32 v45, 0x3f803f80
    s_mov_b32 exec_lo, 808464432
    s_mov_b32 exec_hi, 808464432
    v_mov_b32 v38, 0x3f803f80
    v_mov_b32 v39, 0x3f803f80
    v_mov_b32 v46, 0x3f803f80
    v_mov_b32 v47, 0x3f803f80
    s_mov_b64 exec, -1
    v_mov_b32 v145, 0x4444
    v_mov_b32 v146, 0x4444
    s_mov_b32 exec_lo, 0xffff0000
    s_mov_b32 exec_hi, 0xffff0000
    v_mov_b32 v145, 0xeeee
    s_mov_b32 exec_lo, 0xaaaaaaaa
    s_mov_b32 exec_hi, 0xaaaaaaaa
    v_mov_b32 v146, 0xeeee
    s_mov_b64 exec, -1
    s_mov_b32 s58, 0x0c0c0c0c
    s_mov_b32 s59, 0x0c0c0c0c
L_attn_start:
    s_lshr_b32 s57, s2, 6
    v_mov_b32 v1, v5
    v_add_u32 v2, 1024, v7
    v_lshrrev_b32 v3, 4, v0
    v_mul_u32_u24 v3, 288, v3
    v_and_b32 v128, 15, v0
    v_lshl_add_u32 v3, v128, 4, v3
    v_add_u32 v3, 1152, v3
    v_lshrrev_b32 v144, 5, v0
    v_and_b32 v128, 1, v0
    v_lshl_add_u32 v144, v144, 1, v128
    v_mul_u32_u24 v144, 288, v144
    v_bfe_u32 v128, v0, 3, 1
    v_lshl_add_u32 v144, v128, 4, v144
    v_bfe_u32 v128, v0, 4, 1
    v_lshl_add_u32 v144, v128, 3, v144
    v_add_u32 v144, 1408, v144
    v_mov_b32 v148, 0
    v_mov_b32 v149, 0
    v_mov_b32 v150, 0
    v_mov_b32 v151, 0
    v_mov_b32 v152, 0
    v_mov_b32 v153, 0
    v_mov_b32 v154, 0
    v_mov_b32 v155, 0
    v_mov_b32 v96, 0
    v_mov_b32 v97, 0
    v_mov_b32 v98, 0
    v_mov_b32 v99, 0
    v_mov_b32 v100, 0
    v_mov_b32 v101, 0
    v_mov_b32 v102, 0
    v_mov_b32 v103, 0
    v_mov_b32 v104, 0
    v_mov_b32 v105, 0
    v_mov_b32 v106, 0
    v_mov_b32 v107, 0
    v_mov_b32 v108, 0
    v_mov_b32 v109, 0
    v_mov_b32 v110, 0
    v_mov_b32 v111, 0
    v_mov_b32 v112, 0
    v_mov_b32 v113, 0
    v_mov_b32 v114, 0
    v_mov_b32 v115, 0
    v_mov_b32 v116, 0
    v_mov_b32 v117, 0
    v_mov_b32 v118, 0
    v_mov_b32 v119, 0
    v_mov_b32 v120, 0
    v_mov_b32 v121, 0
    v_mov_b32 v122, 0
    v_mov_b32 v123, 0
    v_mov_b32 v124, 0
    v_mov_b32 v125, 0
    v_mov_b32 v126, 0
    v_mov_b32 v127, 0
    v_mov_b32 v56, 0
    v_mov_b32 v57, 0
    v_mov_b32 v58, 0
    v_mov_b32 v59, 0
    v_mov_b32 v60, 0
    v_mov_b32 v61, 0
    v_mov_b32 v62, 0
    v_mov_b32 v63, 0
    s_mov_b32 s80, s38
    s_mov_b32 s81, s39
    s_mov_b32 s82, 268435456
    s_mov_b32 s83, 0x00020000
    s_mul_i32 s66, s57, 36864
    s_add_u32 s66, s66, s54
    s_add_u32 s57, s57, 1
    s_and_b32 s57, s57, 3
    s_cmp_lg_u32 s56, 0
    s_cbranch_scc1 L_attn_noq
    s_lshr_b32 s72, s61, 3
    s_lshl_b32 s72, s72, 4
    s_bfe_u32 s73, s2, 0x40003
    s_add_u32 s72, s72, s73
    s_lshl_b32 s72, s72, 8
    s_add_u32 s79, s72, 29900800
    s_lshr_b32 s73, s2, 6
    s_lshl_b32 s73, s73, 2
    s_add_u32 s72, s79, s73
    s_cmp_lg_u32 s52, 0
    s_cbranch_scc1 L_pw_17
    s_buffer_load_dword s75, s[84:87], 128
    s_waitcnt lgkmcnt(0)
    s_cmp_ge_u32 s75, 24
    s_cbranch_scc1 L_ini_18
    v_mov_b32 v8, 0
    s_mov_b32 s74, 0
L_inir_19:
    s_sleep 6
    s_mov_b64 exec, 1
    buffer_load_dword v9, v8, s[84:87], 0 offen offset:128 sc1
    s_mov_b64 exec, -1
    s_waitcnt vmcnt(0)
    v_readfirstlane_b32 s75, v9
    s_add_u32 s74, s74, 1
    s_cmp_ge_u32 s75, 24
    s_cbranch_scc1 L_ini_18
    s_cmp_lt_u32 s74, 262144
    s_cbranch_scc1 L_inir_19
L_ini_18:
    s_mov_b32 s74, 0
L_poll_20:
    s_buffer_load_dword s75, s[48:51], s72 glc
    s_add_u32 s74, s74, 1
    s_waitcnt lgkmcnt(0)
    s_cmp_ge_u32 s75, 12
    s_cbranch_scc1 L_polld_21
    s_sleep 2
    s_cmp_lt_u32 s74, 262144
    s_cbranch_scc1 L_poll_20
L_polld_21:
L_pw_17:
    s_barrier
    buffer_load_dwordx4 v[8:11], v5, s[48:51], s63 offen offset:0 sc1
    buffer_load_dword v16, v7, s[48:51], s63 offen offset:1024 sc1
    buffer_load_dwordx4 v[12:15], v5, s[48:51], s63 offen offset:1152 sc1
    buffer_load_dword v18, v7, s[48:51], s63 offen offset:2176 sc1
L_attn_noq:
    s_add_u32 m0, s64, 0
    s_add_u32 s60, s66, 0
    buffer_load_dwordx4 v4, s[48:51], s60 offen sc1 lds
    s_add_u32 m0, s64, 4096
    s_add_u32 s60, s66, 4096
    buffer_load_dwordx4 v4, s[48:51], s60 offen sc1 lds
    s_add_u32 m0, s64, 8192
    s_add_u32 s60, s66, 8192
    buffer_load_dwordx4 v4, s[48:51], s60 offen sc1 lds
    s_add_u32 m0, s64, 12288
    s_add_u32 s60, s66, 12288
    buffer_load_dwordx4 v4, s[48:51], s60 offen sc1 lds
    s_add_u32 m0, s64, 16384
    s_add_u32 s60, s66, 16384
    buffer_load_dwordx4 v4, s[48:51], s60 offen sc1 lds
    s_add_u32 m0, s64, 20480
    s_add_u32 s60, s66, 20480
    buffer_load_dwordx4 v4, s[48:51], s60 offen sc1 lds
    s_add_u32 m0, s64, 24576
    s_add_u32 s60, s66, 24576
    buffer_load_dwordx4 v4, s[48:51], s60 offen sc1 lds
    s_add_u32 m0, s64, 28672
    s_add_u32 s60, s66, 28672
    buffer_load_dwordx4 v4, s[48:51], s60 offen sc1 lds
    s_add_u32 m0, s64, 32768
    s_add_u32 s60, s66, 32768
    buffer_load_dwordx4 v4, s[48:51], s60 offen sc1 lds
    s_mul_i32 s66, s57, 36864
    s_add_u32 s66, s66, s54
    s_add_u32 s57, s57, 1
    s_and_b32 s57, s57, 3
    s_mov_b32 s67, s65
    s_mov_b32 s68, s64
    s_waitcnt vmcnt(8) lgkmcnt(0)
    s_barrier
    s_mov_b32 s76, 0xc0c0c0c0
    s_mov_b32 s77, 0xc0c0c0c0
    ds_read_b128 v[20:23], v1 offset:0
    ds_read_b32 v28, v2 offset:0
    ds_read_b128 v[32:35], v3 offset:0
    s_mov_b64 exec, s[58:59]
    ds_read_b64 v[36:37], v144 offset:0
    s_mov_b64 exec, s[76:77]
    ds_read_b64 v[38:39], v144 offset:0
    s_mov_b64 exec, -1
    v_cmp_gt_u32 vcc, 32, v0
    s_nop 1
    v_cndmask_b32 v16, 0, v16, vcc
    v_cndmask_b32 v18, 0, v18, vcc
    s_waitcnt lgkmcnt(0)
    s_cmp_lg_u32 s56, 0
    s_cbranch_scc1 L_attn_havemax
    v_mfma_f32_32x32x16_bf16 v[64:79], v[20:23], v[8:11], 0
    v_mfma_f32_32x32x8_bf16 v[64:79], v[28:29], v[16:17], v[64:79]
    v_mfma_f32_32x32x16_bf16 v[80:95], v[20:23], v[12:15], 0
    v_mfma_f32_32x32x8_bf16 v[80:95], v[28:29], v[18:19], v[80:95]
    s_nop 15
    v_max3_f32 v130, v64, v65, v66
    v_max_f32 v130, v130, v67
    v_max3_f32 v130, v130, v68, v69
    v_max3_f32 v130, v130, v70, v71
    v_max3_f32 v130, v130, v72, v73
    v_max3_f32 v130, v130, v74, v75
    v_max3_f32 v130, v130, v76, v77
    v_max3_f32 v130, v130, v78, v79
    v_max3_f32 v131, v80, v81, v82
    v_max_f32 v131, v131, v83
    v_max3_f32 v131, v131, v84, v85
    v_max3_f32 v131, v131, v86, v87
    v_max3_f32 v131, v131, v88, v89
    v_max3_f32 v131, v131, v90, v91
    v_max3_f32 v131, v131, v92, v93
    v_max3_f32 v131, v131, v94, v95
    v_mov_b32 v128, v130
    s_nop 1
    v_permlane32_swap_b32 v130, v128
    s_nop 1
    v_max_f32 v130, v130, v128
    v_sub_f32 v130, 0, v130
    v_and_b32 v128, 0xffff0000, v130
    v_sub_f32 v130, v130, v128
    v_and_b32 v129, 0xffff0000, v130
    v_sub_f32 v130, v130, v129
    v_lshrrev_b32 v128, 16, v128
    v_or_b32 v128, v128, v129
    v_lshrrev_b32 v130, 16, v130
    v_cmp_gt_u32 vcc, 32, v0
    s_nop 1
    v_cndmask_b32 v17, v130, v128, vcc
    v_mov_b32 v128, v131
    s_nop 1
    v_permlane32_swap_b32 v131, v128
    s_nop 1
    v_max_f32 v131, v131, v128
    v_sub_f32 v131, 0, v131
    v_and_b32 v128, 0xffff0000, v131
    v_sub_f32 v131, v131, v128
    v_and_b32 v129, 0xffff0000, v131
    v_sub_f32 v131, v131, v129
    v_lshrrev_b32 v128, 16, v128
    v_or_b32 v128, v128, v129
    v_lshrrev_b32 v131, 16, v131
    v_cmp_gt_u32 vcc, 32, v0
    s_nop 1
    v_cndmask_b32 v19, v131, v128, vcc
    s_nop 1
L_attn_havemax:
    v_mfma_f32_32x32x16_bf16 v[64:79], v[20:23], v[8:11], 0
    v_mfma_f32_32x32x8_bf16 v[64:79], v[28:29], v[16:17], v[64:79]
    s_waitcnt vmcnt(7)
    s_barrier
    s_mov_b32 s55, 0
    s_setprio 1
    s_nop 7
    s_branch L_attn_entry
.p2align 6
L_attn_loop:
    s_waitcnt vmcnt(0) lgkmcnt(0)
    s_barrier
    v_xor_b32 v1, 36864, v1
    v_xor_b32 v2, 36864, v2
    v_xor_b32 v3, 36864, v3
    v_xor_b32 v144, 36864, v144
    s_cmp_eq_u32 s55, 3
    s_cselect_b32 s82, 0, s82
    s_mul_i32 s66, s57, 36864
    s_add_u32 s66, s66, s54
    s_add_u32 s57, s57, 1
    s_and_b32 s57, s57, 3
    s_mov_b32 s69, s67
    s_mov_b32 s67, s68
    s_mov_b32 s68, s69
L_attn_nodma:
    v_mfma_f32_32x32x16_bf16 v[80:95], v[24:27], v[12:15], 0
    ds_read_b128 v[20:23], v1 offset:0
    ds_read_b32 v28, v2 offset:0
    v_exp_f32 v64, v64
    v_exp_f32 v65, v65
    v_exp_f32 v66, v66
    v_exp_f32 v67, v67
    v_cvt_pk_bf16_f32 v48, v64, v65
    v_cvt_pk_bf16_f32 v49, v66, v67
    v_mfma_f32_32x32x8_bf16 v[80:95], v[30:31], v[18:19], v[80:95]
    v_exp_f32 v68, v68
    v_exp_f32 v69, v69
    v_exp_f32 v70, v70
    v_exp_f32 v71, v71
    v_cvt_pk_bf16_f32 v50, v68, v69
    v_cvt_pk_bf16_f32 v51, v70, v71
    v_exp_f32 v72, v72
    v_smfmac_f32_32x32x32_bf16 v[112:127], v[32:35], v[56:63], v145
    v_exp_f32 v73, v73
    v_exp_f32 v74, v74
    v_exp_f32 v75, v75
    v_cvt_pk_bf16_f32 v52, v72, v73
    v_cvt_pk_bf16_f32 v53, v74, v75
    v_exp_f32 v76, v76
    v_exp_f32 v77, v77
    v_smfmac_f32_16x16x64_bf16 v[152:155], v[36:39], v[56:63], v146
    v_exp_f32 v78, v78
    v_exp_f32 v79, v79
    v_cvt_pk_bf16_f32 v54, v76, v77
    v_cvt_pk_bf16_f32 v55, v78, v79
    s_waitcnt lgkmcnt(0)
    v_mfma_f32_32x32x16_bf16 v[64:79], v[20:23], v[8:11], 0
    ds_read_b128 v[32:35], v3 offset:0
    s_mov_b64 exec, s[58:59]
    ds_read_b64 v[36:37], v144 offset:0
    s_mov_b64 exec, s[76:77]
    ds_read_b64 v[38:39], v144 offset:0
    s_mov_b64 exec, -1
    v_exp_f32 v80, v80
    v_exp_f32 v81, v81
    v_exp_f32 v82, v82
    v_exp_f32 v83, v83
    v_mfma_f32_32x32x8_bf16 v[64:79], v[28:29], v[16:17], v[64:79]
    v_cvt_pk_bf16_f32 v56, v80, v81
    v_cvt_pk_bf16_f32 v57, v82, v83
    v_exp_f32 v84, v84
    v_exp_f32 v85, v85
    v_exp_f32 v86, v86
    v_exp_f32 v87, v87
    v_cvt_pk_bf16_f32 v58, v84, v85
    v_cvt_pk_bf16_f32 v59, v86, v87
    v_smfmac_f32_32x32x32_bf16 v[96:111], v[40:43], v[48:55], v145
    v_exp_f32 v88, v88
    v_exp_f32 v89, v89
    v_exp_f32 v90, v90
    v_exp_f32 v91, v91
    v_cvt_pk_bf16_f32 v60, v88, v89
    v_cvt_pk_bf16_f32 v61, v90, v91
    v_exp_f32 v92, v92
    v_smfmac_f32_16x16x64_bf16 v[148:151], v[44:47], v[48:55], v146
    v_exp_f32 v93, v93
    v_exp_f32 v94, v94
    v_exp_f32 v95, v95
    v_cvt_pk_bf16_f32 v62, v92, v93
    v_cvt_pk_bf16_f32 v63, v94, v95
L_attn_entry:
    v_mfma_f32_32x32x16_bf16 v[80:95], v[20:23], v[12:15], 0
    ds_read_b128 v[24:27], v1 offset:2304
    ds_read_b32 v30, v2 offset:2304
    v_exp_f32 v64, v64
    v_exp_f32 v65, v65
    v_exp_f32 v66, v66
    v_exp_f32 v67, v67
    v_cvt_pk_bf16_f32 v48, v64, v65
    v_cvt_pk_bf16_f32 v49, v66, v67
    v_mfma_f32_32x32x8_bf16 v[80:95], v[28:29], v[18:19], v[80:95]
    v_exp_f32 v68, v68
    v_exp_f32 v69, v69
    v_exp_f32 v70, v70
    v_exp_f32 v71, v71
    v_cvt_pk_bf16_f32 v50, v68, v69
    v_cvt_pk_bf16_f32 v51, v70, v71
    v_exp_f32 v72, v72
    v_smfmac_f32_32x32x32_bf16 v[112:127], v[40:43], v[56:63], v145
    v_exp_f32 v73, v73
    v_exp_f32 v74, v74
    v_exp_f32 v75, v75
    v_cvt_pk_bf16_f32 v52, v72, v73
    v_cvt_pk_bf16_f32 v53, v74, v75
    v_exp_f32 v76, v76
    v_exp_f32 v77, v77
    v_smfmac_f32_16x16x64_bf16 v[152:155], v[44:47], v[56:63], v146
    v_exp_f32 v78, v78
    v_exp_f32 v79, v79
    v_cvt_pk_bf16_f32 v54, v76, v77
    v_cvt_pk_bf16_f32 v55, v78, v79
    s_waitcnt lgkmcnt(0)
    v_mfma_f32_32x32x16_bf16 v[64:79], v[24:27], v[8:11], 0
    ds_read_b128 v[40:43], v3 offset:2304
    s_mov_b64 exec, s[58:59]
    ds_read_b64 v[44:45], v144 offset:2304
    s_mov_b64 exec, s[76:77]
    ds_read_b64 v[46:47], v144 offset:2304
    s_mov_b64 exec, -1
    v_exp_f32 v80, v80
    v_exp_f32 v81, v81
    v_exp_f32 v82, v82
    v_exp_f32 v83, v83
    v_mfma_f32_32x32x8_bf16 v[64:79], v[30:31], v[16:17], v[64:79]
    v_cvt_pk_bf16_f32 v56, v80, v81
    v_cvt_pk_bf16_f32 v57, v82, v83
    v_exp_f32 v84, v84
    v_exp_f32 v85, v85
    v_exp_f32 v86, v86
    v_exp_f32 v87, v87
    v_cvt_pk_bf16_f32 v58, v84, v85
    v_cvt_pk_bf16_f32 v59, v86, v87
    v_smfmac_f32_32x32x32_bf16 v[96:111], v[32:35], v[48:55], v145
    v_exp_f32 v88, v88
    v_exp_f32 v89, v89
    v_exp_f32 v90, v90
    v_exp_f32 v91, v91
    v_cvt_pk_bf16_f32 v60, v88, v89
    v_cvt_pk_bf16_f32 v61, v90, v91
    v_exp_f32 v92, v92
    v_smfmac_f32_16x16x64_bf16 v[148:151], v[36:39], v[48:55], v146
    v_exp_f32 v93, v93
    v_exp_f32 v94, v94
    v_exp_f32 v95, v95
    v_cvt_pk_bf16_f32 v62, v92, v93
    v_cvt_pk_bf16_f32 v63, v94, v95
    v_mfma_f32_32x32x16_bf16 v[80:95], v[24:27], v[12:15], 0
    ds_read_b128 v[20:23], v1 offset:4608
    ds_read_b32 v28, v2 offset:4608
    v_exp_f32 v64, v64
    v_exp_f32 v65, v65
    v_exp_f32 v66, v66
    v_exp_f32 v67, v67
    v_cvt_pk_bf16_f32 v48, v64, v65
    v_cvt_pk_bf16_f32 v49, v66, v67
    v_mfma_f32_32x32x8_bf16 v[80:95], v[30:31], v[18:19], v[80:95]
    v_exp_f32 v68, v68
    v_exp_f32 v69, v69
    v_exp_f32 v70, v70
    v_exp_f32 v71, v71
    v_cvt_pk_bf16_f32 v50, v68, v69
    v_cvt_pk_bf16_f32 v51, v70, v71
    v_exp_f32 v72, v72
    v_smfmac_f32_32x32x32_bf16 v[112:127], v[32:35], v[56:63], v145
    v_exp_f32 v73, v73
    v_exp_f32 v74, v74
    v_exp_f32 v75, v75
    v_cvt_pk_bf16_f32 v52, v72, v73
    v_cvt_pk_bf16_f32 v53, v74, v75
    v_exp_f32 v76, v76
    v_exp_f32 v77, v77
    v_smfmac_f32_16x16x64_bf16 v[152:155], v[36:39], v[56:63], v146
    v_exp_f32 v78, v78
    v_exp_f32 v79, v79
    v_cvt_pk_bf16_f32 v54, v76, v77
    v_cvt_pk_bf16_f32 v55, v78, v79
    s_waitcnt lgkmcnt(0)
    v_mfma_f32_32x32x16_bf16 v[64:79], v[20:23], v[8:11], 0
    ds_read_b128 v[32:35], v3 offset:4608
    s_mov_b64 exec, s[58:59]
    ds_read_b64 v[36:37], v144 offset:4608
    s_mov_b64 exec, s[76:77]
    ds_read_b64 v[38:39], v144 offset:4608
    s_mov_b64 exec, -1
    v_exp_f32 v80, v80
    v_exp_f32 v81, v81
    v_exp_f32 v82, v82
    v_exp_f32 v83, v83
    v_mfma_f32_32x32x8_bf16 v[64:79], v[28:29], v[16:17], v[64:79]
    v_cvt_pk_bf16_f32 v56, v80, v81
    v_cvt_pk_bf16_f32 v57, v82, v83
    v_exp_f32 v84, v84
    v_exp_f32 v85, v85
    v_exp_f32 v86, v86
    v_exp_f32 v87, v87
    v_cvt_pk_bf16_f32 v58, v84, v85
    v_cvt_pk_bf16_f32 v59, v86, v87
    v_smfmac_f32_32x32x32_bf16 v[96:111], v[40:43], v[48:55], v145
    v_exp_f32 v88, v88
    v_exp_f32 v89, v89
    v_exp_f32 v90, v90
    v_exp_f32 v91, v91
    v_cvt_pk_bf16_f32 v60, v88, v89
    v_cvt_pk_bf16_f32 v61, v90, v91
    v_exp_f32 v92, v92
    v_smfmac_f32_16x16x64_bf16 v[148:151], v[44:47], v[48:55], v146
    v_exp_f32 v93, v93
    v_exp_f32 v94, v94
    v_exp_f32 v95, v95
    v_cvt_pk_bf16_f32 v62, v92, v93
    v_cvt_pk_bf16_f32 v63, v94, v95
    s_cmp_lg_u32 s55, 0
    s_cbranch_scc1 L_attn_k2
    s_waitcnt vmcnt(0)
    s_barrier
L_attn_k2:
    s_cmp_lg_u32 s55, 0
    s_cbranch_scc1 L_attn_k3
    s_mov_b32 s76, 0
L_q2_22:
    s_buffer_load_dwordx4 s[72:75], s[48:51], s79 glc
    s_add_u32 s76, s76, 1
    s_waitcnt lgkmcnt(0)
    s_min_u32 s72, s72, s73
    s_min_u32 s74, s74, s75
    s_min_u32 s72, s72, s74
    s_cmp_ge_u32 s72, 12
    s_cbranch_scc1 L_q2d_23
    s_sleep 4
    s_cmp_lt_u32 s76, 262144
    s_cbranch_scc1 L_q2_22
L_q2d_23:
    s_bfe_u32 s72, s2, 0x50003
    s_lshl_b32 s72, s72, 8
    s_add_u32 s72, s72, 29786112
    s_mov_b32 s74, 0
L_poll_24:
    s_buffer_load_dword s75, s[48:51], s72 glc
    s_add_u32 s74, s74, 1
    s_waitcnt lgkmcnt(0)
    s_cmp_ge_u32 s75, 64
    s_cbranch_scc1 L_polld_25
    s_sleep 8
    s_cmp_lt_u32 s74, 262144
    s_cbranch_scc1 L_poll_24
L_polld_25:
    s_lshl_b32 s69, s62, 7
    s_add_u32 s69, s69, 17768448
    buffer_load_dword v136, v7, s[48:51], s69 offen sc1
    buffer_load_dword v137, v7, s[48:51], s69 offen offset:128 sc1
    s_mov_b32 s76, 0xc0c0c0c0
L_attn_k3:
    v_mfma_f32_32x32x16_bf16 v[80:95], v[20:23], v[12:15], 0
    ds_read_b128 v[24:27], v1 offset:6912
    ds_read_b32 v30, v2 offset:6912
    v_exp_f32 v64, v64
    v_exp_f32 v65, v65
    v_exp_f32 v66, v66
    v_exp_f32 v67, v67
    v_cvt_pk_bf16_f32 v48, v64, v65
    v_cvt_pk_bf16_f32 v49, v66, v67
    v_mfma_f32_32x32x8_bf16 v[80:95], v[28:29], v[18:19], v[80:95]
    v_exp_f32 v68, v68
    v_exp_f32 v69, v69
    v_exp_f32 v70, v70
    v_exp_f32 v71, v71
    v_cvt_pk_bf16_f32 v50, v68, v69
    v_cvt_pk_bf16_f32 v51, v70, v71
    v_exp_f32 v72, v72
    v_smfmac_f32_32x32x32_bf16 v[112:127], v[40:43], v[56:63], v145
    s_add_u32 m0, s67, 0
    s_add_u32 s60, s66, 0
    buffer_load_dwordx4 v4, s[80:83], s60 offen sc1 lds
    v_exp_f32 v73, v73
    v_exp_f32 v74, v74
    v_exp_f32 v75, v75
    v_cvt_pk_bf16_f32 v52, v72, v73
    v_cvt_pk_bf16_f32 v53, v74, v75
    v_exp_f32 v76, v76
    v_exp_f32 v77, v77
    v_smfmac_f32_16x16x64_bf16 v[152:155], v[44:47], v[56:63], v146
    v_exp_f32 v78, v78
    v_exp_f32 v79, v79
    v_cvt_pk_bf16_f32 v54, v76, v77
    v_cvt_pk_bf16_f32 v55, v78, v79
    s_waitcnt lgkmcnt(0)
    v_mfma_f32_32x32x16_bf16 v[64:79], v[24:27], v[8:11], 0
    ds_read_b128 v[40:43], v3 offset:6912
    s_mov_b64 exec, s[58:59]
    ds_read_b64 v[44:45], v144 offset:6912
    s_mov_b64 exec, s[76:77]
    ds_read_b64 v[46:47], v144 offset:6912
    s_mov_b64 exec, -1
    v_exp_f32 v80, v80
    v_exp_f32 v81, v81
    v_exp_f32 v82, v82
    v_exp_f32 v83, v83
    v_mfma_f32_32x32x8_bf16 v[64:79], v[30:31], v[16:17], v[64:79]
    v_cvt_pk_bf16_f32 v56, v80, v81
    v_cvt_pk_bf16_f32 v57, v82, v83
    v_exp_f32 v84, v84
    v_exp_f32 v85, v85
    v_exp_f32 v86, v86
    v_exp_f32 v87, v87
    v_cvt_pk_bf16_f32 v58, v84, v85
    v_cvt_pk_bf16_f32 v59, v86, v87
    v_smfmac_f32_32x32x32_bf16 v[96:111], v[32:35], v[48:55], v145
    v_exp_f32 v88, v88
    v_exp_f32 v89, v89
    v_exp_f32 v90, v90
    v_exp_f32 v91, v91
    v_cvt_pk_bf16_f32 v60, v88, v89
    v_cvt_pk_bf16_f32 v61, v90, v91
    v_exp_f32 v92, v92
    v_smfmac_f32_16x16x64_bf16 v[148:151], v[36:39], v[48:55], v146
    v_exp_f32 v93, v93
    v_exp_f32 v94, v94
    v_exp_f32 v95, v95
    v_cvt_pk_bf16_f32 v62, v92, v93
    v_cvt_pk_bf16_f32 v63, v94, v95
    v_mfma_f32_32x32x16_bf16 v[80:95], v[24:27], v[12:15], 0
    ds_read_b128 v[20:23], v1 offset:9216
    ds_read_b32 v28, v2 offset:9216
    v_exp_f32 v64, v64
    v_exp_f32 v65, v65
    v_exp_f32 v66, v66
    v_exp_f32 v67, v67
    v_cvt_pk_bf16_f32 v48, v64, v65
    v_cvt_pk_bf16_f32 v49, v66, v67
    v_mfma_f32_32x32x8_bf16 v[80:95], v[30:31], v[18:19], v[80:95]
    v_exp_f32 v68, v68
    v_exp_f32 v69, v69
    v_exp_f32 v70, v70
    v_exp_f32 v71, v71
    v_cvt_pk_bf16_f32 v50, v68, v69
    v_cvt_pk_bf16_f32 v51, v70, v71
    v_exp_f32 v72, v72
    v_smfmac_f32_32x32x32_bf16 v[112:127], v[32:35], v[56:63], v145
    s_add_u32 m0, s67, 4096
    s_add_u32 s60, s66, 4096
    buffer_load_dwordx4 v4, s[80:83], s60 offen sc1 lds
    v_exp_f32 v73, v73
    v_exp_f32 v74, v74
    v_exp_f32 v75, v75
    v_cvt_pk_bf16_f32 v52, v72, v73
    v_cvt_pk_bf16_f32 v53, v74, v75
    v_exp_f32 v76, v76
    v_exp_f32 v77, v77
    v_smfmac_f32_16x16x64_bf16 v[152:155], v[36:39], v[56:63], v146
    v_exp_f32 v78, v78
    v_exp_f32 v79, v79
    v_cvt_pk_bf16_f32 v54, v76, v77
    v_cvt_pk_bf16_f32 v55, v78, v79
    s_waitcnt lgkmcnt(0)
    v_mfma_f32_32x32x16_bf16 v[64:79], v[20:23], v[8:11], 0
    ds_read_b128 v[32:35], v3 offset:9216
    s_mov_b64 exec, s[58:59]
    ds_read_b64 v[36:37], v144 offset:9216
    s_mov_b64 exec, s[76:77]
    ds_read_b64 v[38:39], v144 offset:9216
    s_mov_b64 exec, -1
    v_exp_f32 v80, v80
    v_exp_f32 v81, v81
    v_exp_f32 v82, v82
    v_exp_f32 v83, v83
    v_mfma_f32_32x32x8_bf16 v[64:79], v[28:29], v[16:17], v[64:79]
    v_cvt_pk_bf16_f32 v56, v80, v81
    v_cvt_pk_bf16_f32 v57, v82, v83
    v_exp_f32 v84, v84
    v_exp_f32 v85, v85
    v_exp_f32 v86, v86
    v_exp_f32 v87, v87
    v_cvt_pk_bf16_f32 v58, v84, v85
    v_cvt_pk_bf16_f32 v59, v86, v87
    v_smfmac_f32_32x32x32_bf16 v[96:111], v[40:43], v[48:55], v145
    v_exp_f32 v88, v88
    v_exp_f32 v89, v89
    v_exp_f32 v90, v90
    v_exp_f32 v91, v91
    v_cvt_pk_bf16_f32 v60, v88, v89
    v_cvt_pk_bf16_f32 v61, v90, v91
    v_exp_f32 v92, v92
    v_smfmac_f32_16x16x64_bf16 v[148:151], v[44:47], v[48:55], v146
    v_exp_f32 v93, v93
    v_exp_f32 v94, v94
    v_exp_f32 v95, v95
    v_cvt_pk_bf16_f32 v62, v92, v93
    v_cvt_pk_bf16_f32 v63, v94, v95
    v_mfma_f32_32x32x16_bf16 v[80:95], v[20:23], v[12:15], 0
    ds_read_b128 v[24:27], v1 offset:11520
    ds_read_b32 v30, v2 offset:11520
    v_exp_f32 v64, v64
    v_exp_f32 v65, v65
    v_exp_f32 v66, v66
    v_exp_f32 v67, v67
    v_cvt_pk_bf16_f32 v48, v64, v65
    v_cvt_pk_bf16_f32 v49, v66, v67
    v_mfma_f32_32x32x8_bf16 v[80:95], v[28:29], v[18:19], v[80:95]
    v_exp_f32 v68, v68
    v_exp_f32 v69, v69
    v_exp_f32 v70, v70
    v_exp_f32 v71, v71
    v_cvt_pk_bf16_f32 v50, v68, v69
    v_cvt_pk_bf16_f32 v51, v70, v71
    v_exp_f32 v72, v72
    v_smfmac_f32_32x32x32_bf16 v[112:127], v[40:43], v[56:63], v145
    s_add_u32 m0, s67, 8192
    s_add_u32 s60, s66, 8192
    buffer_load_dwordx4 v4, s[80:83], s60 offen sc1 lds
    v_exp_f32 v73, v73
    v_exp_f32 v74, v74
    v_exp_f32 v75, v75
    v_cvt_pk_bf16_f32 v52, v72, v73
    v_cvt_pk_bf16_f32 v53, v74, v75
    v_exp_f32 v76, v76
    v_exp_f32 v77, v77
    v_smfmac_f32_16x16x64_bf16 v[152:155], v[44:47], v[56:63], v146
    v_exp_f32 v78, v78
    v_exp_f32 v79, v79
    v_cvt_pk_bf16_f32 v54, v76, v77
    v_cvt_pk_bf16_f32 v55, v78, v79
    s_waitcnt lgkmcnt(0)
    v_mfma_f32_32x32x16_bf16 v[64:79], v[24:27], v[8:11], 0
    ds_read_b128 v[40:43], v3 offset:11520
    s_mov_b64 exec, s[58:59]
    ds_read_b64 v[44:45], v144 offset:11520
    s_mov_b64 exec, s[76:77]
    ds_read_b64 v[46:47], v144 offset:11520
    s_mov_b64 exec, -1
    v_exp_f32 v80, v80
    v_exp_f32 v81, v81
    v_exp_f32 v82, v82
    v_exp_f32 v83, v83
    v_mfma_f32_32x32x8_bf16 v[64:79], v[30:31], v[16:17], v[64:79]
    v_cvt_pk_bf16_f32 v56, v80, v81
    v_cvt_pk_bf16_f32 v57, v82, v83
    v_exp_f32 v84, v84
    v_exp_f32 v85, v85
    v_exp_f32 v86, v86
    v_exp_f32 v87, v87
    v_cvt_pk_bf16_f32 v58, v84, v85
    v_cvt_pk_bf16_f32 v59, v86, v87
    v_smfmac_f32_32x32x32_bf16 v[96:111], v[32:35], v[48:55], v145
    v_exp_f32 v88, v88
    v_exp_f32 v89, v89
    v_exp_f32 v90, v90
    v_exp_f32 v91, v91
    v_cvt_pk_bf16_f32 v60, v88, v89
    v_cvt_pk_bf16_f32 v61, v90, v91
    v_exp_f32 v92, v92
    v_smfmac_f32_16x16x64_bf16 v[148:151], v[36:39], v[48:55], v146
    v_exp_f32 v93, v93
    v_exp_f32 v94, v94
    v_exp_f32 v95, v95
    v_cvt_pk_bf16_f32 v62, v92, v93
    v_cvt_pk_bf16_f32 v63, v94, v95
    v_mfma_f32_32x32x16_bf16 v[80:95], v[24:27], v[12:15], 0
    ds_read_b128 v[20:23], v1 offset:13824
    ds_read_b32 v28, v2 offset:13824
    v_exp_f32 v64, v64
    v_exp_f32 v65, v65
    v_exp_f32 v66, v66
    v_exp_f32 v67, v67
    v_cvt_pk_bf16_f32 v48, v64, v65
    v_cvt_pk_bf16_f32 v49, v66, v67
    v_mfma_f32_32x32x8_bf16 v[80:95], v[30:31], v[18:19], v[80:95]
    v_exp_f32 v68, v68
    v_exp_f32 v69, v69
    v_exp_f32 v70, v70
    v_exp_f32 v71, v71
    v_cvt_pk_bf16_f32 v50, v68, v69
    v_cvt_pk_bf16_f32 v51, v70, v71
    v_exp_f32 v72, v72
    v_smfmac_f32_32x32x32_bf16 v[112:127], v[32:35], v[56:63], v145
    s_add_u32 m0, s67, 12288
    s_add_u32 s60, s66, 12288
    buffer_load_dwordx4 v4, s[80:83], s60 offen sc1 lds
    v_exp_f32 v73, v73
    v_exp_f32 v74, v74
    v_exp_f32 v75, v75
    v_cvt_pk_bf16_f32 v52, v72, v73
    v_cvt_pk_bf16_f32 v53, v74, v75
    v_exp_f32 v76, v76
    v_exp_f32 v77, v77
    v_smfmac_f32_16x16x64_bf16 v[152:155], v[36:39], v[56:63], v146
    v_exp_f32 v78, v78
    v_exp_f32 v79, v79
    v_cvt_pk_bf16_f32 v54, v76, v77
    v_cvt_pk_bf16_f32 v55, v78, v79
    s_waitcnt lgkmcnt(0)
    v_mfma_f32_32x32x16_bf16 v[64:79], v[20:23], v[8:11], 0
    ds_read_b128 v[32:35], v3 offset:13824
    s_mov_b64 exec, s[58:59]
    ds_read_b64 v[36:37], v144 offset:13824
    s_mov_b64 exec, s[76:77]
    ds_read_b64 v[38:39], v144 offset:13824
    s_mov_b64 exec, -1
    v_exp_f32 v80, v80
    v_exp_f32 v81, v81
    v_exp_f32 v82, v82
    v_exp_f32 v83, v83
    v_mfma_f32_32x32x8_bf16 v[64:79], v[28:29], v[16:17], v[64:79]
    v_cvt_pk_bf16_f32 v56, v80, v81
    v_cvt_pk_bf16_f32 v57, v82, v83
    v_exp_f32 v84, v84
    v_exp_f32 v85, v85
    v_exp_f32 v86, v86
    v_exp_f32 v87, v87
    v_cvt_pk_bf16_f32 v58, v84, v85
    v_cvt_pk_bf16_f32 v59, v86, v87
    v_smfmac_f32_32x32x32_bf16 v[96:111], v[40:43], v[48:55], v145
    v_exp_f32 v88, v88
    v_exp_f32 v89, v89
    v_exp_f32 v90, v90
    v_exp_f32 v91, v91
    v_cvt_pk_bf16_f32 v60, v88, v89
    v_cvt_pk_bf16_f32 v61, v90, v91
    v_exp_f32 v92, v92
    v_smfmac_f32_16x16x64_bf16 v[148:151], v[44:47], v[48:55], v146
    v_exp_f32 v93, v93
    v_exp_f32 v94, v94
    v_exp_f32 v95, v95
    v_cvt_pk_bf16_f32 v62, v92, v93
    v_cvt_pk_bf16_f32 v63, v94, v95
    v_mfma_f32_32x32x16_bf16 v[80:95], v[20:23], v[12:15], 0
    ds_read_b128 v[24:27], v1 offset:16128
    ds_read_b32 v30, v2 offset:16128
    v_exp_f32 v64, v64
    v_exp_f32 v65, v65
    v_exp_f32 v66, v66
    v_exp_f32 v67, v67
    v_cvt_pk_bf16_f32 v48, v64, v65
    v_cvt_pk_bf16_f32 v49, v66, v67
    v_mfma_f32_32x32x8_bf16 v[80:95], v[28:29], v[18:19], v[80:95]
    v_exp_f32 v68, v68
    v_exp_f32 v69, v69
    v_exp_f32 v70, v70
    v_exp_f32 v71, v71
    v_cvt_pk_bf16_f32 v50, v68, v69
    v_cvt_pk_bf16_f32 v51, v70, v71
    v_exp_f32 v72, v72
    v_smfmac_f32_32x32x32_bf16 v[112:127], v[40:43], v[56:63], v145
    s_add_u32 m0, s67, 16384
    s_add_u32 s60, s66, 16384
    buffer_load_dwordx4 v4, s[80:83], s60 offen sc1 lds
    v_exp_f32 v73, v73
    v_exp_f32 v74, v74
    v_exp_f32 v75, v75
    v_cvt_pk_bf16_f32 v52, v72, v73
    v_cvt_pk_bf16_f32 v53, v74, v75
    v_exp_f32 v76, v76
    v_exp_f32 v77, v77
    v_smfmac_f32_16x16x64_bf16 v[152:155], v[44:47], v[56:63], v146
    v_exp_f32 v78, v78
    v_exp_f32 v79, v79
    v_cvt_pk_bf16_f32 v54, v76, v77
    v_cvt_pk_bf16_f32 v55, v78, v79
    s_waitcnt lgkmcnt(0)
    v_mfma_f32_32x32x16_bf16 v[64:79], v[24:27], v[8:11], 0
    ds_read_b128 v[40:43], v3 offset:16128
    s_mov_b64 exec, s[58:59]
    ds_read_b64 v[44:45], v144 offset:16128
    s_mov_b64 exec, s[76:77]
    ds_read_b64 v[46:47], v144 offset:16128
    s_mov_b64 exec, -1
    v_exp_f32 v80, v80
    v_exp_f32 v81, v81
    v_exp_f32 v82, v82
    v_exp_f32 v83, v83
    v_mfma_f32_32x32x8_bf16 v[64:79], v[30:31], v[16:17], v[64:79]
    v_cvt_pk_bf16_f32 v56, v80, v81
    v_cvt_pk_bf16_f32 v57, v82, v83
    v_exp_f32 v84, v84
    v_exp_f32 v85, v85
    v_exp_f32 v86, v86
    v_exp_f32 v87, v87
    v_cvt_pk_bf16_f32 v58, v84, v85
    v_cvt_pk_bf16_f32 v59, v86, v87
    v_smfmac_f32_32x32x32_bf16 v[96:111], v[32:35], v[48:55], v145
    v_exp_f32 v88, v88
    v_exp_f32 v89, v89
    v_exp_f32 v90, v90
    v_exp_f32 v91, v91
    v_cvt_pk_bf16_f32 v60, v88, v89
    v_cvt_pk_bf16_f32 v61, v90, v91
    v_exp_f32 v92, v92
    v_smfmac_f32_16x16x64_bf16 v[148:151], v[36:39], v[48:55], v146
    v_exp_f32 v93, v93
    v_exp_f32 v94, v94
    v_exp_f32 v95, v95
    v_cvt_pk_bf16_f32 v62, v92, v93
    v_cvt_pk_bf16_f32 v63, v94, v95
    v_mfma_f32_32x32x16_bf16 v[80:95], v[24:27], v[12:15], 0
    ds_read_b128 v[20:23], v1 offset:18432
    ds_read_b32 v28, v2 offset:18432
    v_exp_f32 v64, v64
    v_exp_f32 v65, v65
    v_exp_f32 v66, v66
    v_exp_f32 v67, v67
    v_cvt_pk_bf16_f32 v48, v64, v65
    v_cvt_pk_bf16_f32 v49, v66, v67
    v_mfma_f32_32x32x8_bf16 v[80:95], v[30:31], v[18:19], v[80:95]
    v_exp_f32 v68, v68
    v_exp_f32 v69, v69
    v_exp_f32 v70, v70
    v_exp_f32 v71, v71
    v_cvt_pk_bf16_f32 v50, v68, v69
    v_cvt_pk_bf16_f32 v51, v70, v71
    v_exp_f32 v72, v72
    v_smfmac_f32_32x32x32_bf16 v[112:127], v[32:35], v[56:63], v145
    s_add_u32 m0, s67, 20480
    s_add_u32 s60, s66, 20480
    buffer_load_dwordx4 v4, s[80:83], s60 offen sc1 lds
    v_exp_f32 v73, v73
    v_exp_f32 v74, v74
    v_exp_f32 v75, v75
    v_cvt_pk_bf16_f32 v52, v72, v73
    v_cvt_pk_bf16_f32 v53, v74, v75
    v_exp_f32 v76, v76
    v_exp_f32 v77, v77
    v_smfmac_f32_16x16x64_bf16 v[152:155], v[36:39], v[56:63], v146
    v_exp_f32 v78, v78
    v_exp_f32 v79, v79
    v_cvt_pk_bf16_f32 v54, v76, v77
    v_cvt_pk_bf16_f32 v55, v78, v79
    s_waitcnt lgkmcnt(0)
    v_mfma_f32_32x32x16_bf16 v[64:79], v[20:23], v[8:11], 0
    ds_read_b128 v[32:35], v3 offset:18432
    s_mov_b64 exec, s[58:59]
    ds_read_b64 v[36:37], v144 offset:18432
    s_mov_b64 exec, s[76:77]
    ds_read_b64 v[38:39], v144 offset:18432
    s_mov_b64 exec, -1
    v_exp_f32 v80, v80
    v_exp_f32 v81, v81
    v_exp_f32 v82, v82
    v_exp_f32 v83, v83
    v_mfma_f32_32x32x8_bf16 v[64:79], v[28:29], v[16:17], v[64:79]
    v_cvt_pk_bf16_f32 v56, v80, v81
    v_cvt_pk_bf16_f32 v57, v82, v83
    v_exp_f32 v84, v84
    v_exp_f32 v85, v85
    v_exp_f32 v86, v86
    v_exp_f32 v87, v87
    v_cvt_pk_bf16_f32 v58, v84, v85
    v_cvt_pk_bf16_f32 v59, v86, v87
    v_smfmac_f32_32x32x32_bf16 v[96:111], v[40:43], v[48:55], v145
    v_exp_f32 v88, v88
    v_exp_f32 v89, v89
    v_exp_f32 v90, v90
    v_exp_f32 v91, v91
    v_cvt_pk_bf16_f32 v60, v88, v89
    v_cvt_pk_bf16_f32 v61, v90, v91
    v_exp_f32 v92, v92
    v_smfmac_f32_16x16x64_bf16 v[148:151], v[44:47], v[48:55], v146
    v_exp_f32 v93, v93
    v_exp_f32 v94, v94
    v_exp_f32 v95, v95
    v_cvt_pk_bf16_f32 v62, v92, v93
    v_cvt_pk_bf16_f32 v63, v94, v95
    v_mfma_f32_32x32x16_bf16 v[80:95], v[20:23], v[12:15], 0
    ds_read_b128 v[24:27], v1 offset:20736
    ds_read_b32 v30, v2 offset:20736
    v_exp_f32 v64, v64
    v_exp_f32 v65, v65
    v_exp_f32 v66, v66
    v_exp_f32 v67, v67
    v_cvt_pk_bf16_f32 v48, v64, v65
    v_cvt_pk_bf16_f32 v49, v66, v67
    v_mfma_f32_32x32x8_bf16 v[80:95], v[28:29], v[18:19], v[80:95]
    v_exp_f32 v68, v68
    v_exp_f32 v69, v69
    v_exp_f32 v70, v70
    v_exp_f32 v71, v71
    v_cvt_pk_bf16_f32 v50, v68, v69
    v_cvt_pk_bf16_f32 v51, v70, v71
    v_exp_f32 v72, v72
    v_smfmac_f32_32x32x32_bf16 v[112:127], v[40:43], v[56:63], v145
    s_add_u32 m0, s67, 24576
    s_add_u32 s60, s66, 24576
    buffer_load_dwordx4 v4, s[80:83], s60 offen sc1 lds
    v_exp_f32 v73, v73
    v_exp_f32 v74, v74
    v_exp_f32 v75, v75
    v_cvt_pk_bf16_f32 v52, v72, v73
    v_cvt_pk_bf16_f32 v53, v74, v75
    v_exp_f32 v76, v76
    v_exp_f32 v77, v77
    v_smfmac_f32_16x16x64_bf16 v[152:155], v[44:47], v[56:63], v146
    v_exp_f32 v78, v78
    v_exp_f32 v79, v79
    v_cvt_pk_bf16_f32 v54, v76, v77
    v_cvt_pk_bf16_f32 v55, v78, v79
    s_waitcnt lgkmcnt(0)
    v_mfma_f32_32x32x16_bf16 v[64:79], v[24:27], v[8:11], 0
    ds_read_b128 v[40:43], v3 offset:20736
    s_mov_b64 exec, s[58:59]
    ds_read_b64 v[44:45], v144 offset:20736
    s_mov_b64 exec, s[76:77]
    ds_read_b64 v[46:47], v144 offset:20736
    s_mov_b64 exec, -1
    v_exp_f32 v80, v80
    v_exp_f32 v81, v81
    v_exp_f32 v82, v82
    v_exp_f32 v83, v83
    v_mfma_f32_32x32x8_bf16 v[64:79], v[30:31], v[16:17], v[64:79]
    v_cvt_pk_bf16_f32 v56, v80, v81
    v_cvt_pk_bf16_f32 v57, v82, v83
    v_exp_f32 v84, v84
    v_exp_f32 v85, v85
    v_exp_f32 v86, v86
    v_exp_f32 v87, v87
    v_cvt_pk_bf16_f32 v58, v84, v85
    v_cvt_pk_bf16_f32 v59, v86, v87
    v_smfmac_f32_32x32x32_bf16 v[96:111], v[32:35], v[48:55], v145
    v_exp_f32 v88, v88
    v_exp_f32 v89, v89
    v_exp_f32 v90, v90
    v_exp_f32 v91, v91
    v_cvt_pk_bf16_f32 v60, v88, v89
    v_cvt_pk_bf16_f32 v61, v90, v91
    v_exp_f32 v92, v92
    v_smfmac_f32_16x16x64_bf16 v[148:151], v[36:39], v[48:55], v146
    v_exp_f32 v93, v93
    v_exp_f32 v94, v94
    v_exp_f32 v95, v95
    v_cvt_pk_bf16_f32 v62, v92, v93
    v_cvt_pk_bf16_f32 v63, v94, v95
    v_mfma_f32_32x32x16_bf16 v[80:95], v[24:27], v[12:15], 0
    ds_read_b128 v[20:23], v1 offset:23040
    ds_read_b32 v28, v2 offset:23040
    v_exp_f32 v64, v64
    v_exp_f32 v65, v65
    v_exp_f32 v66, v66
    v_exp_f32 v67, v67
    v_cvt_pk_bf16_f32 v48, v64, v65
    v_cvt_pk_bf16_f32 v49, v66, v67
    v_mfma_f32_32x32x8_bf16 v[80:95], v[30:31], v[18:19], v[80:95]
    v_exp_f32 v68, v68
    v_exp_f32 v69, v69
    v_exp_f32 v70, v70
    v_exp_f32 v71, v71
    v_cvt_pk_bf16_f32 v50, v68, v69
    v_cvt_pk_bf16_f32 v51, v70, v71
    v_exp_f32 v72, v72
    v_smfmac_f32_32x32x32_bf16 v[112:127], v[32:35], v[56:63], v145
    s_add_u32 m0, s67, 28672
    s_add_u32 s60, s66, 28672
    buffer_load_dwordx4 v4, s[80:83], s60 offen sc1 lds
    v_exp_f32 v73, v73
    v_exp_f32 v74, v74
    v_exp_f32 v75, v75
    v_cvt_pk_bf16_f32 v52, v72, v73
    v_cvt_pk_bf16_f32 v53, v74, v75
    v_exp_f32 v76, v76
    v_exp_f32 v77, v77
    v_smfmac_f32_16x16x64_bf16 v[152:155], v[36:39], v[56:63], v146
    v_exp_f32 v78, v78
    v_exp_f32 v79, v79
    v_cvt_pk_bf16_f32 v54, v76, v77
    v_cvt_pk_bf16_f32 v55, v78, v79
    s_waitcnt lgkmcnt(0)
    v_mfma_f32_32x32x16_bf16 v[64:79], v[20:23], v[8:11], 0
    ds_read_b128 v[32:35], v3 offset:23040
    s_mov_b64 exec, s[58:59]
    ds_read_b64 v[36:37], v144 offset:23040
    s_mov_b64 exec, s[76:77]
    ds_read_b64 v[38:39], v144 offset:23040
    s_mov_b64 exec, -1
    v_exp_f32 v80, v80
    v_exp_f32 v81, v81
    v_exp_f32 v82, v82
    v_exp_f32 v83, v83
    v_mfma_f32_32x32x8_bf16 v[64:79], v[28:29], v[16:17], v[64:79]
    v_cvt_pk_bf16_f32 v56, v80, v81
    v_cvt_pk_bf16_f32 v57, v82, v83
    v_exp_f32 v84, v84
    v_exp_f32 v85, v85
    v_exp_f32 v86, v86
    v_exp_f32 v87, v87
    v_cvt_pk_bf16_f32 v58, v84, v85
    v_cvt_pk_bf16_f32 v59, v86, v87
    v_smfmac_f32_32x32x32_bf16 v[96:111], v[40:43], v[48:55], v145
    v_exp_f32 v88, v88
    v_exp_f32 v89, v89
    v_exp_f32 v90, v90
    v_exp_f32 v91, v91
    v_cvt_pk_bf16_f32 v60, v88, v89
    v_cvt_pk_bf16_f32 v61, v90, v91
    v_exp_f32 v92, v92
    v_smfmac_f32_16x16x64_bf16 v[148:151], v[44:47], v[48:55], v146
    v_exp_f32 v93, v93
    v_exp_f32 v94, v94
    v_exp_f32 v95, v95
    v_cvt_pk_bf16_f32 v62, v92, v93
    v_cvt_pk_bf16_f32 v63, v94, v95
    v_mfma_f32_32x32x16_bf16 v[80:95], v[20:23], v[12:15], 0
    ds_read_b128 v[24:27], v1 offset:25344
    ds_read_b32 v30, v2 offset:25344
    v_exp_f32 v64, v64
    v_exp_f32 v65, v65
    v_exp_f32 v66, v66
    v_exp_f32 v67, v67
    v_cvt_pk_bf16_f32 v48, v64, v65
    v_cvt_pk_bf16_f32 v49, v66, v67
    v_mfma_f32_32x32x8_bf16 v[80:95], v[28:29], v[18:19], v[80:95]
    v_exp_f32 v68, v68
    v_exp_f32 v69, v69
    v_exp_f32 v70, v70
    v_exp_f32 v71, v71
    v_cvt_pk_bf16_f32 v50, v68, v69
    v_cvt_pk_bf16_f32 v51, v70, v71
    v_exp_f32 v72, v72
    v_smfmac_f32_32x32x32_bf16 v[112:127], v[40:43], v[56:63], v145
    s_add_u32 m0, s67, 32768
    s_add_u32 s60, s66, 32768
    buffer_load_dwordx4 v4, s[80:83], s60 offen sc1 lds
    v_exp_f32 v73, v73
    v_exp_f32 v74, v74
    v_exp_f32 v75, v75
    v_cvt_pk_bf16_f32 v52, v72, v73
    v_cvt_pk_bf16_f32 v53, v74, v75
    v_exp_f32 v76, v76
    v_exp_f32 v77, v77
    v_smfmac_f32_16x16x64_bf16 v[152:155], v[44:47], v[56:63], v146
    v_exp_f32 v78, v78
    v_exp_f32 v79, v79
    v_cvt_pk_bf16_f32 v54, v76, v77
    v_cvt_pk_bf16_f32 v55, v78, v79
    s_waitcnt lgkmcnt(0)
    v_mfma_f32_32x32x16_bf16 v[64:79], v[24:27], v[8:11], 0
    ds_read_b128 v[40:43], v3 offset:25344
    s_mov_b64 exec, s[58:59]
    ds_read_b64 v[44:45], v144 offset:25344
    s_mov_b64 exec, s[76:77]
    ds_read_b64 v[46:47], v144 offset:25344
    s_mov_b64 exec, -1
    v_exp_f32 v80, v80
    v_exp_f32 v81, v81
    v_exp_f32 v82, v82
    v_exp_f32 v83, v83
    v_mfma_f32_32x32x8_bf16 v[64:79], v[30:31], v[16:17], v[64:79]
    v_cvt_pk_bf16_f32 v56, v80, v81
    v_cvt_pk_bf16_f32 v57, v82, v83
    v_exp_f32 v84, v84
    v_exp_f32 v85, v85
    v_exp_f32 v86, v86
    v_exp_f32 v87, v87
    v_cvt_pk_bf16_f32 v58, v84, v85
    v_cvt_pk_bf16_f32 v59, v86, v87
    v_smfmac_f32_32x32x32_bf16 v[96:111], v[32:35], v[48:55], v145
    v_exp_f32 v88, v88
    v_exp_f32 v89, v89
    v_exp_f32 v90, v90
    v_exp_f32 v91, v91
    v_cvt_pk_bf16_f32 v60, v88, v89
    v_cvt_pk_bf16_f32 v61, v90, v91
    v_exp_f32 v92, v92
    v_smfmac_f32_16x16x64_bf16 v[148:151], v[36:39], v[48:55], v146
    v_exp_f32 v93, v93
    v_exp_f32 v94, v94
    v_exp_f32 v95, v95
    v_cvt_pk_bf16_f32 v62, v92, v93
    v_cvt_pk_bf16_f32 v63, v94, v95
    v_mfma_f32_32x32x16_bf16 v[80:95], v[24:27], v[12:15], 0
    ds_read_b128 v[20:23], v1 offset:27648
    ds_read_b32 v28, v2 offset:27648
    v_exp_f32 v64, v64
    v_exp_f32 v65, v65
    v_exp_f32 v66, v66
    v_exp_f32 v67, v67
    v_cvt_pk_bf16_f32 v48, v64, v65
    v_cvt_pk_bf16_f32 v49, v66, v67
    v_mfma_f32_32x32x8_bf16 v[80:95], v[30:31], v[18:19], v[80:95]
    v_exp_f32 v68, v68
    v_exp_f32 v69, v69
    v_exp_f32 v70, v70
    v_exp_f32 v71, v71
    v_cvt_pk_bf16_f32 v50, v68, v69
    v_cvt_pk_bf16_f32 v51, v70, v71
    v_exp_f32 v72, v72
    v_smfmac_f32_32x32x32_bf16 v[112:127], v[32:35], v[56:63], v145
    v_exp_f32 v73, v73
    v_exp_f32 v74, v74
    v_exp_f32 v75, v75
    v_cvt_pk_bf16_f32 v52, v72, v73
    v_cvt_pk_bf16_f32 v53, v74, v75
    v_exp_f32 v76, v76
    v_exp_f32 v77, v77
    v_smfmac_f32_16x16x64_bf16 v[152:155], v[36:39], v[56:63], v146
    v_exp_f32 v78, v78
    v_exp_f32 v79, v79
    v_cvt_pk_bf16_f32 v54, v76, v77
    v_cvt_pk_bf16_f32 v55, v78, v79
    s_waitcnt lgkmcnt(0)
    v_mfma_f32_32x32x16_bf16 v[64:79], v[20:23], v[8:11], 0
    ds_read_b128 v[32:35], v3 offset:27648
    s_mov_b64 exec, s[58:59]
    ds_read_b64 v[36:37], v144 offset:27648
    s_mov_b64 exec, s[76:77]
    ds_read_b64 v[38:39], v144 offset:27648
    s_mov_b64 exec, -1
    v_exp_f32 v80, v80
    v_exp_f32 v81, v81
    v_exp_f32 v82, v82
    v_exp_f32 v83, v83
    v_mfma_f32_32x32x8_bf16 v[64:79], v[28:29], v[16:17], v[64:79]
    v_cvt_pk_bf16_f32 v56, v80, v81
    v_cvt_pk_bf16_f32 v57, v82, v83
    v_exp_f32 v84, v84
    v_exp_f32 v85, v85
    v_exp_f32 v86, v86
    v_exp_f32 v87, v87
    v_cvt_pk_bf16_f32 v58, v84, v85
    v_cvt_pk_bf16_f32 v59, v86, v87
    v_smfmac_f32_32x32x32_bf16 v[96:111], v[40:43], v[48:55], v145
    v_exp_f32 v88, v88
    v_exp_f32 v89, v89
    v_exp_f32 v90, v90
    v_exp_f32 v91, v91
    v_cvt_pk_bf16_f32 v60, v88, v89
    v_cvt_pk_bf16_f32 v61, v90, v91
    v_exp_f32 v92, v92
    v_smfmac_f32_16x16x64_bf16 v[148:151], v[44:47], v[48:55], v146
    v_exp_f32 v93, v93
    v_exp_f32 v94, v94
    v_exp_f32 v95, v95
    v_cvt_pk_bf16_f32 v62, v92, v93
    v_cvt_pk_bf16_f32 v63, v94, v95
    v_mfma_f32_32x32x16_bf16 v[80:95], v[20:23], v[12:15], 0
    ds_read_b128 v[24:27], v1 offset:29952
    ds_read_b32 v30, v2 offset:29952
    v_exp_f32 v64, v64
    v_exp_f32 v65, v65
    v_exp_f32 v66, v66
    v_exp_f32 v67, v67
    v_cvt_pk_bf16_f32 v48, v64, v65
    v_cvt_pk_bf16_f32 v49, v66, v67
    v_mfma_f32_32x32x8_bf16 v[80:95], v[28:29], v[18:19], v[80:95]
    v_exp_f32 v68, v68
    v_exp_f32 v69, v69
    v_exp_f32 v70, v70
    v_exp_f32 v71, v71
    v_cvt_pk_bf16_f32 v50, v68, v69
    v_cvt_pk_bf16_f32 v51, v70, v71
    v_exp_f32 v72, v72
    v_smfmac_f32_32x32x32_bf16 v[112:127], v[40:43], v[56:63], v145
    v_exp_f32 v73, v73
    v_exp_f32 v74, v74
    v_exp_f32 v75, v75
    v_cvt_pk_bf16_f32 v52, v72, v73
    v_cvt_pk_bf16_f32 v53, v74, v75
    v_exp_f32 v76, v76
    v_exp_f32 v77, v77
    v_smfmac_f32_16x16x64_bf16 v[152:155], v[44:47], v[56:63], v146
    v_exp_f32 v78, v78
    v_exp_f32 v79, v79
    v_cvt_pk_bf16_f32 v54, v76, v77
    v_cvt_pk_bf16_f32 v55, v78, v79
    s_waitcnt lgkmcnt(0)
    v_mfma_f32_32x32x16_bf16 v[64:79], v[24:27], v[8:11], 0
    ds_read_b128 v[40:43], v3 offset:29952
    s_mov_b64 exec, s[58:59]
    ds_read_b64 v[44:45], v144 offset:29952
    s_mov_b64 exec, s[76:77]
    ds_read_b64 v[46:47], v144 offset:29952
    s_mov_b64 exec, -1
    v_exp_f32 v80, v80
    v_exp_f32 v81, v81
    v_exp_f32 v82, v82
    v_exp_f32 v83, v83
    v_mfma_f32_32x32x8_bf16 v[64:79], v[30:31], v[16:17], v[64:79]
    v_cvt_pk_bf16_f32 v56, v80, v81
    v_cvt_pk_bf16_f32 v57, v82, v83
    v_exp_f32 v84, v84
    v_exp_f32 v85, v85
    v_exp_f32 v86, v86
    v_exp_f32 v87, v87
    v_cvt_pk_bf16_f32 v58, v84, v85
    v_cvt_pk_bf16_f32 v59, v86, v87
    v_smfmac_f32_32x32x32_bf16 v[96:111], v[32:35], v[48:55], v145
    v_exp_f32 v88, v88
    v_exp_f32 v89, v89
    v_exp_f32 v90, v90
    v_exp_f32 v91, v91
    v_cvt_pk_bf16_f32 v60, v88, v89
    v_cvt_pk_bf16_f32 v61, v90, v91
    v_exp_f32 v92, v92
    v_smfmac_f32_16x16x64_bf16 v[148:151], v[36:39], v[48:55], v146
    v_exp_f32 v93, v93
    v_exp_f32 v94, v94
    v_exp_f32 v95, v95
    v_cvt_pk_bf16_f32 v62, v92, v93
    v_cvt_pk_bf16_f32 v63, v94, v95
    v_mfma_f32_32x32x16_bf16 v[80:95], v[24:27], v[12:15], 0
    ds_read_b128 v[20:23], v1 offset:32256
    ds_read_b32 v28, v2 offset:32256
    v_exp_f32 v64, v64
    v_exp_f32 v65, v65
    v_exp_f32 v66, v66
    v_exp_f32 v67, v67
    v_cvt_pk_bf16_f32 v48, v64, v65
    v_cvt_pk_bf16_f32 v49, v66, v67
    v_mfma_f32_32x32x8_bf16 v[80:95], v[30:31], v[18:19], v[80:95]
    v_exp_f32 v68, v68
    v_exp_f32 v69, v69
    v_exp_f32 v70, v70
    v_exp_f32 v71, v71
    v_cvt_pk_bf16_f32 v50, v68, v69
    v_cvt_pk_bf16_f32 v51, v70, v71
    v_exp_f32 v72, v72
    v_smfmac_f32_32x32x32_bf16 v[112:127], v[32:35], v[56:63], v145
    v_exp_f32 v73, v73
    v_exp_f32 v74, v74
    v_exp_f32 v75, v75
    v_cvt_pk_bf16_f32 v52, v72, v73
    v_cvt_pk_bf16_f32 v53, v74, v75
    v_exp_f32 v76, v76
    v_exp_f32 v77, v77
    v_smfmac_f32_16x16x64_bf16 v[152:155], v[36:39], v[56:63], v146
    v_exp_f32 v78, v78
    v_exp_f32 v79, v79
    v_cvt_pk_bf16_f32 v54, v76, v77
    v_cvt_pk_bf16_f32 v55, v78, v79
    s_waitcnt lgkmcnt(0)
    v_mfma_f32_32x32x16_bf16 v[64:79], v[20:23], v[8:11], 0
    ds_read_b128 v[32:35], v3 offset:32256
    s_mov_b64 exec, s[58:59]
    ds_read_b64 v[36:37], v144 offset:32256
    s_mov_b64 exec, s[76:77]
    ds_read_b64 v[38:39], v144 offset:32256
    s_mov_b64 exec, -1
    v_exp_f32 v80, v80
    v_exp_f32 v81, v81
    v_exp_f32 v82, v82
    v_exp_f32 v83, v83
    v_mfma_f32_32x32x8_bf16 v[64:79], v[28:29], v[16:17], v[64:79]
    v_cvt_pk_bf16_f32 v56, v80, v81
    v_cvt_pk_bf16_f32 v57, v82, v83
    v_exp_f32 v84, v84
    v_exp_f32 v85, v85
    v_exp_f32 v86, v86
    v_exp_f32 v87, v87
    v_cvt_pk_bf16_f32 v58, v84, v85
    v_cvt_pk_bf16_f32 v59, v86, v87
    v_smfmac_f32_32x32x32_bf16 v[96:111], v[40:43], v[48:55], v145
    v_exp_f32 v88, v88
    v_exp_f32 v89, v89
    v_exp_f32 v90, v90
    v_exp_f32 v91, v91
    v_cvt_pk_bf16_f32 v60, v88, v89
    v_cvt_pk_bf16_f32 v61, v90, v91
    v_exp_f32 v92, v92
    v_smfmac_f32_16x16x64_bf16 v[148:151], v[44:47], v[48:55], v146
    v_exp_f32 v93, v93
    v_exp_f32 v94, v94
    v_exp_f32 v95, v95
    v_cvt_pk_bf16_f32 v62, v92, v93
    v_cvt_pk_bf16_f32 v63, v94, v95
    v_mfma_f32_32x32x16_bf16 v[80:95], v[20:23], v[12:15], 0
    ds_read_b128 v[24:27], v1 offset:34560
    ds_read_b32 v30, v2 offset:34560
    v_exp_f32 v64, v64
    v_exp_f32 v65, v65
    v_exp_f32 v66, v66
    v_exp_f32 v67, v67
    v_cvt_pk_bf16_f32 v48, v64, v65
    v_cvt_pk_bf16_f32 v49, v66, v67
    v_mfma_f32_32x32x8_bf16 v[80:95], v[28:29], v[18:19], v[80:95]
    v_exp_f32 v68, v68
    v_exp_f32 v69, v69
    v_exp_f32 v70, v70
    v_exp_f32 v71, v71
    v_cvt_pk_bf16_f32 v50, v68, v69
    v_cvt_pk_bf16_f32 v51, v70, v71
    v_exp_f32 v72, v72
    v_smfmac_f32_32x32x32_bf16 v[112:127], v[40:43], v[56:63], v145
    v_exp_f32 v73, v73
    v_exp_f32 v74, v74
    v_exp_f32 v75, v75
    v_cvt_pk_bf16_f32 v52, v72, v73
    v_cvt_pk_bf16_f32 v53, v74, v75
    v_exp_f32 v76, v76
    v_exp_f32 v77, v77
    v_smfmac_f32_16x16x64_bf16 v[152:155], v[44:47], v[56:63], v146
    v_exp_f32 v78, v78
    v_exp_f32 v79, v79
    v_cvt_pk_bf16_f32 v54, v76, v77
    v_cvt_pk_bf16_f32 v55, v78, v79
    s_waitcnt lgkmcnt(0)
    v_mfma_f32_32x32x16_bf16 v[64:79], v[24:27], v[8:11], 0
    ds_read_b128 v[40:43], v3 offset:34560
    s_mov_b64 exec, s[58:59]
    ds_read_b64 v[44:45], v144 offset:34560
    s_mov_b64 exec, s[76:77]
    ds_read_b64 v[46:47], v144 offset:34560
    s_mov_b64 exec, -1
    v_exp_f32 v80, v80
    v_exp_f32 v81, v81
    v_exp_f32 v82, v82
    v_exp_f32 v83, v83
    v_mfma_f32_32x32x8_bf16 v[64:79], v[30:31], v[16:17], v[64:79]
    v_cvt_pk_bf16_f32 v56, v80, v81
    v_cvt_pk_bf16_f32 v57, v82, v83
    v_exp_f32 v84, v84
    v_exp_f32 v85, v85
    v_exp_f32 v86, v86
    v_exp_f32 v87, v87
    v_cvt_pk_bf16_f32 v58, v84, v85
    v_cvt_pk_bf16_f32 v59, v86, v87
    v_smfmac_f32_32x32x32_bf16 v[96:111], v[32:35], v[48:55], v145
    v_exp_f32 v88, v88
    v_exp_f32 v89, v89
    v_exp_f32 v90, v90
    v_exp_f32 v91, v91
    v_cvt_pk_bf16_f32 v60, v88, v89
    v_cvt_pk_bf16_f32 v61, v90, v91
    v_exp_f32 v92, v92
    v_smfmac_f32_16x16x64_bf16 v[148:151], v[36:39], v[48:55], v146
    v_exp_f32 v93, v93
    v_exp_f32 v94, v94
    v_exp_f32 v95, v95
    v_cvt_pk_bf16_f32 v62, v92, v93
    v_cvt_pk_bf16_f32 v63, v94, v95
    s_add_u32 s55, s55, 1
    s_cmp_lt_u32 s55, 4
    s_cbranch_scc1 L_attn_loop
    v_mfma_f32_32x32x16_bf16 v[80:95], v[24:27], v[12:15], 0
    v_exp_f32 v64, v64
    v_exp_f32 v65, v65
    v_exp_f32 v66, v66
    v_exp_f32 v67, v67
    v_cvt_pk_bf16_f32 v48, v64, v65
    v_cvt_pk_bf16_f32 v49, v66, v67
    v_mfma_f32_32x32x8_bf16 v[80:95], v[30:31], v[18:19], v[80:95]
    v_exp_f32 v68, v68
    v_exp_f32 v69, v69
    v_exp_f32 v70, v70
    v_exp_f32 v71, v71
    v_cvt_pk_bf16_f32 v50, v68, v69
    v_cvt_pk_bf16_f32 v51, v70, v71
    v_exp_f32 v72, v72
    v_smfmac_f32_32x32x32_bf16 v[112:127], v[32:35], v[56:63], v145
    v_exp_f32 v73, v73
    v_exp_f32 v74, v74
    v_exp_f32 v75, v75
    v_cvt_pk_bf16_f32 v52, v72, v73
    v_cvt_pk_bf16_f32 v53, v74, v75
    v_exp_f32 v76, v76
    v_exp_f32 v77, v77
    v_smfmac_f32_16x16x64_bf16 v[152:155], v[36:39], v[56:63], v146
    v_exp_f32 v78, v78
    v_exp_f32 v79, v79
    v_cvt_pk_bf16_f32 v54, v76, v77
    v_cvt_pk_bf16_f32 v55, v78, v79
    s_waitcnt lgkmcnt(0)
    v_exp_f32 v80, v80
    v_exp_f32 v81, v81
    v_exp_f32 v82, v82
    v_exp_f32 v83, v83
    v_cvt_pk_bf16_f32 v56, v80, v81
    v_cvt_pk_bf16_f32 v57, v82, v83
    v_exp_f32 v84, v84
    v_exp_f32 v85, v85
    v_exp_f32 v86, v86
    v_exp_f32 v87, v87
    v_cvt_pk_bf16_f32 v58, v84, v85
    v_cvt_pk_bf16_f32 v59, v86, v87
    v_smfmac_f32_32x32x32_bf16 v[96:111], v[40:43], v[48:55], v145
    v_exp_f32 v88, v88
    v_exp_f32 v89, v89
    v_exp_f32 v90, v90
    v_exp_f32 v91, v91
    v_cvt_pk_bf16_f32 v60, v88, v89
    v_cvt_pk_bf16_f32 v61, v90, v91
    v_exp_f32 v92, v92
    v_smfmac_f32_16x16x64_bf16 v[148:151], v[44:47], v[48:55], v146
    v_exp_f32 v93, v93
    v_exp_f32 v94, v94
    v_exp_f32 v95, v95
    v_cvt_pk_bf16_f32 v62, v92, v93
    v_cvt_pk_bf16_f32 v63, v94, v95
    s_nop 1
    v_smfmac_f32_32x32x32_bf16 v[112:127], v[40:43], v[56:63], v145
    v_smfmac_f32_16x16x64_bf16 v[152:155], v[44:47], v[56:63], v146
    s_nop 15
    s_setprio 3
    v_add_f32 v96, v96, v104
    v_add_f32 v97, v97, v105
    v_add_f32 v98, v98, v106
    v_add_f32 v99, v99, v107
    v_add_f32 v100, v100, v108
    v_add_f32 v101, v101, v109
    v_add_f32 v102, v102, v110
    v_add_f32 v103, v103, v111
    v_add_f32 v104, v150, v151
    v_add_f32 v106, v148, v149
    v_add_f32 v112, v112, v120
    v_add_f32 v113, v113, v121
    v_add_f32 v114, v114, v122
    v_add_f32 v115, v115, v123
    v_add_f32 v116, v116, v124
    v_add_f32 v117, v117, v125
    v_add_f32 v118, v118, v126
    v_add_f32 v119, v119, v127
    v_add_f32 v120, v154, v155
    v_add_f32 v122, v152, v153
    v_max_f32 v128, v106, v122
    v_mov_b32 v130, 0
    v_fma_f32 v128, v96, 0, v128
    v_fma_f32 v130, v112, 0, v130
    v_fma_f32 v128, v97, 0, v128
    v_fma_f32 v130, v113, 0, v130
    v_fma_f32 v128, v98, 0, v128
    v_fma_f32 v130, v114, 0, v130
    v_fma_f32 v128, v99, 0, v128
    v_fma_f32 v130, v115, 0, v130
    v_fma_f32 v128, v100, 0, v128
    v_fma_f32 v130, v116, 0, v130
    v_fma_f32 v128, v101, 0, v128
    v_fma_f32 v130, v117, 0, v130
    v_fma_f32 v128, v102, 0, v128
    v_fma_f32 v130, v118, 0, v130
    v_fma_f32 v128, v103, 0, v128
    v_fma_f32 v130, v119, 0, v130
    v_fma_f32 v128, v104, 0, v128
    v_fma_f32 v130, v120, 0, v130
    v_fma_f32 v128, v106, 0, v128
    v_fma_f32 v130, v122, 0, v130
    v_add_f32 v128, v128, v130
    v_mov_b32 v129, 0x5f800000
    v_cmp_nlt_f32 vcc, v128, v129
    v_rcp_f32 v106, v106
    v_rcp_f32 v122, v122
    s_cmp_lg_u64 vcc, 0
    s_cselect_b32 s69, 1, 0
    v_mov_b32 v128, s69
    s_lshl_b32 s69, s52, 2
    s_add_u32 s69, s69, 73728
    v_mov_b32 v129, s69
    ds_write_b32 v129, v128
    v_lshrrev_b32 v128, 5, v0
    v_lshlrev_b32 v128, 9, v128
    v_lshl_add_u32 v128, v6, 1, v128
    v_add_u32 v128, s64, v128
    v_lshrrev_b32 v131, 5, v0
    v_mul_u32_u24 v131, 384, v131
    v_sub_u32 v131, v128, v131
    s_waitcnt vmcnt(0)
    v_mul_f32 v106, v106, v136
    v_mul_f32 v96, v96, v106
    v_mul_f32 v97, v97, v106
    v_mul_f32 v98, v98, v106
    v_mul_f32 v99, v99, v106
    v_mul_f32 v100, v100, v106
    v_mul_f32 v101, v101, v106
    v_mul_f32 v102, v102, v106
    v_mul_f32 v103, v103, v106
    v_mul_f32 v104, v104, v106
    v_cvt_pk_bf16_f32 v96, v96, v97
    v_cvt_pk_bf16_f32 v97, v98, v99
    v_cvt_pk_bf16_f32 v98, v100, v101
    v_cvt_pk_bf16_f32 v99, v102, v103
    v_cvt_pk_bf16_f32 v100, v104, v104
    ds_write_b16 v128, v96 offset:0
    ds_write_b16_d16_hi v128, v96 offset:128
    ds_write_b16 v128, v97 offset:256
    ds_write_b16_d16_hi v128, v97 offset:384
    ds_write_b16 v128, v98 offset:4096
    ds_write_b16_d16_hi v128, v98 offset:4224
    ds_write_b16 v128, v99 offset:4352
    ds_write_b16_d16_hi v128, v99 offset:4480
    ds_write_b16 v131, v100 offset:8192
    v_mul_f32 v122, v122, v137
    v_mul_f32 v112, v112, v122
    v_mul_f32 v113, v113, v122
    v_mul_f32 v114, v114, v122
    v_mul_f32 v115, v115, v122
    v_mul_f32 v116, v116, v122
    v_mul_f32 v117, v117, v122
    v_mul_f32 v118, v118, v122
    v_mul_f32 v119, v119, v122
    v_mul_f32 v120, v120, v122
    v_cvt_pk_bf16_f32 v112, v112, v113
    v_cvt_pk_bf16_f32 v113, v114, v115
    v_cvt_pk_bf16_f32 v114, v116, v117
    v_cvt_pk_bf16_f32 v115, v118, v119
    v_cvt_pk_bf16_f32 v116, v120, v120
    ds_write_b16 v128, v112 offset:64
    ds_write_b16_d16_hi v128, v112 offset:192
    ds_write_b16 v128, v113 offset:320
    ds_write_b16_d16_hi v128, v113 offset:448
    ds_write_b16 v128, v114 offset:4160
    ds_write_b16_d16_hi v128, v114 offset:4288
    ds_write_b16 v128, v115 offset:4416
    ds_write_b16_d16_hi v128, v115 offset:4544
    ds_write_b16 v131, v116 offset:8256
    v_lshrrev_b32 v129, 3, v0
    v_lshlrev_b32 v129, 12, v129
    v_and_b32 v130, 7, v0
    v_lshl_add_u32 v129, v130, 4, v129
    s_mul_i32 s69, s61, 73728
    s_lshl_b32 s70, s62, 6
    s_add_u32 s69, s69, s70
    s_add_u32 s69, s69, 14745600
    s_add_u32 s70, s69, 32768
    s_add_u32 s71, s69, 65536
    s_waitcnt lgkmcnt(0)
    ds_read_b128 v[96:99], v4
    ds_read_b128 v[100:103], v4 offset:4096
    ds_read_b128 v[104:107], v4 offset:8192
    v_mov_b32 v130, 73728
    s_waitcnt lgkmcnt(2)
    buffer_store_dwordx4 v[96:99], v129, s[48:51], s69 offen sc1
    s_waitcnt lgkmcnt(1)
    buffer_store_dwordx4 v[100:103], v129, s[48:51], s70 offen sc1
    s_waitcnt lgkmcnt(0)
    s_mov_b64 exec, 0xffff
    buffer_store_dwordx4 v[104:107], v129, s[48:51], s71 offen sc1
    s_mov_b64 exec, -1
    s_barrier
    ds_read_b128 v[132:135], v130
    s_cmp_lg_u32 s56, 0
    s_cbranch_scc1 L_attn_out
    s_waitcnt lgkmcnt(0)
    v_or_b32 v128, v132, v133
    v_or3_b32 v128, v128, v134, v135
    s_nop 0
    v_readfirstlane_b32 s69, v128
    s_nop 3
    s_cmp_eq_u32 s69, 0
    s_cbranch_scc1 L_attn_out
    s_mov_b32 s56, 1
    v_mov_b32 v17, 0
    v_mov_b32 v130, 0xff800000
    v_mov_b32 v19, 0
    v_mov_b32 v131, 0xff800000
    s_mov_b32 s66, s54
    s_mov_b32 s55, 0
L_attn_mx_chunk:
    s_add_u32 m0, s64, 0
    s_add_u32 s60, s66, 0
    buffer_load_dwordx4 v4, s[48:51], s60 offen sc1 lds
    s_add_u32 m0, s64, 4096
    s_add_u32 s60, s66, 4096
    buffer_load_dwordx4 v4, s[48:51], s60 offen sc1 lds
    s_add_u32 m0, s64, 8192
    s_add_u32 s60, s66, 8192
    buffer_load_dwordx4 v4, s[48:51], s60 offen sc1 lds
    s_add_u32 m0, s64, 12288
    s_add_u32 s60, s66, 12288
    buffer_load_dwordx4 v4, s[48:51], s60 offen sc1 lds
    s_add_u32 m0, s64, 16384
    s_add_u32 s60, s66, 16384
    buffer_load_dwordx4 v4, s[48:51], s60 offen sc1 lds
    s_add_u32 m0, s64, 20480
    s_add_u32 s60, s66, 20480
    buffer_load_dwordx4 v4, s[48:51], s60 offen sc1 lds
    s_add_u32 m0, s64, 24576
    s_add_u32 s60, s66, 24576
    buffer_load_dwordx4 v4, s[48:51], s60 offen sc1 lds
    s_add_u32 m0, s64, 28672
    s_add_u32 s60, s66, 28672
    buffer_load_dwordx4 v4, s[48:51], s60 offen sc1 lds
    s_add_u32 m0, s64, 32768
    s_add_u32 s60, s66, 32768
    buffer_load_dwordx4 v4, s[48:51], s60 offen sc1 lds
    s_add_u32 s66, s66, 36864
    v_mov_b32 v1, v5
    v_add_u32 v2, 1024, v7
    s_mov_b32 s69, 0
    s_waitcnt vmcnt(0)
    s_barrier
L_attn_mx_tile:
    ds_read_b128 v[20:23], v1 offset:0
    ds_read_b32 v28, v2 offset:0
    v_add_u32 v1, 2304, v1
    v_add_u32 v2, 2304, v2
    s_waitcnt lgkmcnt(0)
    v_mfma_f32_32x32x16_bf16 v[64:79], v[20:23], v[8:11], 0
    v_mfma_f32_32x32x8_bf16 v[64:79], v[28:29], v[16:17], v[64:79]
    v_mfma_f32_32x32x16_bf16 v[80:95], v[20:23], v[12:15], 0
    v_mfma_f32_32x32x8_bf16 v[80:95], v[28:29], v[18:19], v[80:95]
    s_nop 15
    v_max3_f32 v130, v130, v64, v65
    v_max3_f32 v130, v130, v66, v67
    v_max3_f32 v130, v130, v68, v69
    v_max3_f32 v130, v130, v70, v71
    v_max3_f32 v130, v130, v72, v73
    v_max3_f32 v130, v130, v74, v75
    v_max3_f32 v130, v130, v76, v77
    v_max3_f32 v130, v130, v78, v79
    v_max3_f32 v131, v131, v80, v81
    v_max3_f32 v131, v131, v82, v83
    v_max3_f32 v131, v131, v84, v85
    v_max3_f32 v131, v131, v86, v87
    v_max3_f32 v131, v131, v88, v89
    v_max3_f32 v131, v131, v90, v91
    v_max3_f32 v131, v131, v92, v93
    v_max3_f32 v131, v131, v94, v95
    s_add_u32 s69, s69, 1
    s_cmp_lt_u32 s69, 16
    s_cbranch_scc1 L_attn_mx_tile
    s_barrier
    s_add_u32 s55, s55, 1
    s_cmp_lt_u32 s55, 4
    s_cbranch_scc1 L_attn_mx_chunk
    v_mov_b32 v128, v130
    s_nop 1
    v_permlane32_swap_b32 v130, v128
    s_nop 1
    v_max_f32 v130, v130, v128
    v_sub_f32 v130, 0, v130
    v_and_b32 v128, 0xffff0000, v130
    v_sub_f32 v130, v130, v128
    v_and_b32 v129, 0xffff0000, v130
    v_sub_f32 v130, v130, v129
    v_lshrrev_b32 v128, 16, v128
    v_or_b32 v128, v128, v129
    v_lshrrev_b32 v130, 16, v130
    v_cmp_gt_u32 vcc, 32, v0
    s_nop 1
    v_cndmask_b32 v17, v130, v128, vcc
    v_mov_b32 v128, v131
    s_nop 1
    v_permlane32_swap_b32 v131, v128
    s_nop 1
    v_max_f32 v131, v131, v128
    v_sub_f32 v131, 0, v131
    v_and_b32 v128, 0xffff0000, v131
    v_sub_f32 v131, v131, v128
    v_and_b32 v129, 0xffff0000, v131
    v_sub_f32 v131, v131, v129
    v_lshrrev_b32 v128, 16, v128
    v_or_b32 v128, v128, v129
    v_lshrrev_b32 v131, 16, v131
    v_cmp_gt_u32 vcc, 32, v0
    s_nop 1
    v_cndmask_b32 v19, v131, v128, vcc
    s_branch L_attn_start
L_attn_out:
    s_cmp_gt_u32 s61, 7
    s_cselect_b32 s72, 1, 0
    s_cmp_gt_u32 s61, 14
    s_addc_u32 s72, s72, 0
    s_cmp_gt_u32 s61, 19
    s_addc_u32 s72, s72, 0
    s_cmp_gt_u32 s61, 24
    s_addc_u32 s72, s72, 0
    s_lshr_b32 s73, s2, 5
    s_mul_i32 s73, s73, 5
    s_add_u32 s72, s72, s73
    s_mul_i32 s72, s72, 1536
    s_add_u32 s72, s72, 29671424
    s_lshr_b32 s73, 17318016, s61
    s_and_b32 s73, s73, 1
    s_cselect_b32 s73, 0xfff, 63
    s_waitcnt vmcnt(0)
    s_barrier
    s_cmp_lg_u32 s52, 0
    s_cbranch_scc1 L_pub_26
    v_lshlrev_b32 v5, 8, v0
    v_mov_b32 v6, 1
    s_mov_b32 exec_lo, s73
    s_mov_b32 exec_hi, 0
    buffer_atomic_add v6, v5, s[48:51], s72 offen sc1
    s_mov_b64 exec, -1
L_pub_26:
    s_cmp_ge_u32 s2, 192
    s_cbranch_scc1 L_done
    s_mov_b32 s40, s34
    s_mov_b32 s41, s35
    s_mov_b32 s42, 2359296
    s_mov_b32 s43, 0x00020000
    s_and_b32 s53, s2, 7
    s_lshl_b32 s53, s53, 2
    s_bfe_u32 s54, s2, 0x20003
    s_add_u32 s53, s53, s54
    s_lshr_b32 s54, s2, 5
    s_and_b32 s61, s52, 1
    s_lshr_b32 s62, s52, 1
    v_lshlrev_b32 v2, 4, v0
    v_and_b32 v5, 31, v0
    s_lshl_b32 s57, s53, 1
    s_add_u32 s63, s57, s62
    s_lshl_b32 s57, s63, 5
    v_add_u32 v5, s57, v5
    s_mul_i32 s56, s54, 393216
    s_lshl_b32 s57, s63, 11
    s_add_u32 s56, s56, s57
    s_lshl_b32 s57, s61, 10
    s_add_u32 s56, s56, s57
    s_add_u32 s56, s56, 17776640
    v_mul_u32_u24 v5, 1152, v5
    v_lshrrev_b32 v6, 5, v0
    v_lshl_add_u32 v5, v6, 4, v5
    s_mul_i32 s58, s54, 192
    s_lshl_b32 s57, s61, 5
    s_add_u32 s58, s57, s58
    s_lshl_b32 s76, s54, 5
    s_add_u32 s76, s76, s53
    s_lshl_b32 s76, s76, 8
    s_add_u32 s76, s76, 29736960
    s_mov_b32 s77, 0
L_y_27:
    s_buffer_load_dwordx4 s[72:75], s[48:51], s76 glc
    s_add_u32 s77, s77, 1
    s_waitcnt lgkmcnt(0)
    s_cmp_ge_u32 s72, 5
    s_cbranch_scc1 L_yd_28
    s_sleep 2
    s_cmp_lt_u32 s77, 262144
    s_cbranch_scc1 L_y_27
L_yd_28:
    s_add_u32 s57, s56, 0
    buffer_load_dwordx4 v[16:19], v2, s[48:51], s57 offen sc1
    s_add_u32 s57, s56, 2359296
    buffer_load_dwordx4 v[20:23], v2, s[48:51], s57 offen sc1
    s_add_u32 s57, s56, 4718592
    buffer_load_dwordx4 v[24:27], v2, s[48:51], s57 offen sc1
    s_add_u32 s57, s56, 7077888
    buffer_load_dwordx4 v[28:31], v2, s[48:51], s57 offen sc1
    s_add_u32 s57, s56, 9437184
    buffer_load_dwordx4 v[32:35], v2, s[48:51], s57 offen sc1
    s_cmp_ge_u32 s73, 5
    s_cbranch_scc1 L_yd_30
L_y_29:
    s_buffer_load_dwordx4 s[72:75], s[48:51], s76 glc
    s_add_u32 s77, s77, 1
    s_waitcnt lgkmcnt(0)
    s_cmp_ge_u32 s73, 5
    s_cbranch_scc1 L_yd_30
    s_cmp_lt_u32 s77, 262144
    s_cbranch_scc1 L_y_29
L_yd_30:
    s_add_u32 s57, s56, 131072
    buffer_load_dwordx4 v[36:39], v2, s[48:51], s57 offen sc1
    s_add_u32 s57, s56, 2490368
    buffer_load_dwordx4 v[40:43], v2, s[48:51], s57 offen sc1
    s_add_u32 s57, s56, 4849664
    buffer_load_dwordx4 v[44:47], v2, s[48:51], s57 offen sc1
    s_add_u32 s57, s56, 7208960
    buffer_load_dwordx4 v[48:51], v2, s[48:51], s57 offen sc1
    s_add_u32 s57, s56, 9568256
    buffer_load_dwordx4 v[52:55], v2, s[48:51], s57 offen sc1
    s_cmp_ge_u32 s74, 5
    s_cbranch_scc1 L_yd_32
L_y_31:
    s_buffer_load_dwordx4 s[72:75], s[48:51], s76 glc
    s_add_u32 s77, s77, 1
    s_waitcnt lgkmcnt(0)
    s_cmp_ge_u32 s74, 5
    s_cbranch_scc1 L_yd_32
    s_cmp_lt_u32 s77, 262144
    s_cbranch_scc1 L_y_31
L_yd_32:
    s_add_u32 s57, s56, 262144
    buffer_load_dwordx4 v[56:59], v2, s[48:51], s57 offen sc1
    s_add_u32 s57, s56, 2621440
    buffer_load_dwordx4 v[60:63], v2, s[48:51], s57 offen sc1
    s_add_u32 s57, s56, 4980736
    buffer_load_dwordx4 v[64:67], v2, s[48:51], s57 offen sc1
    s_add_u32 s57, s56, 7340032
    buffer_load_dwordx4 v[68:71], v2, s[48:51], s57 offen sc1
    s_add_u32 s57, s56, 9699328
    buffer_load_dwordx4 v[72:75], v2, s[48:51], s57 offen sc1
    s_waitcnt vmcnt(14)
    v_lshlrev_b32 v80, 16, v16
    v_and_b32 v81, 0xffff0000, v16
    v_lshlrev_b32 v82, 16, v17
    v_and_b32 v83, 0xffff0000, v17
    v_lshlrev_b32 v84, 16, v18
    v_and_b32 v85, 0xffff0000, v18
    v_lshlrev_b32 v86, 16, v19
    v_and_b32 v87, 0xffff0000, v19
    s_waitcnt vmcnt(13)
    v_lshlrev_b32 v88, 16, v20
    v_and_b32 v89, 0xffff0000, v20
    v_lshlrev_b32 v90, 16, v21
    v_and_b32 v91, 0xffff0000, v21
    v_lshlrev_b32 v92, 16, v22
    v_and_b32 v93, 0xffff0000, v22
    v_lshlrev_b32 v94, 16, v23
    v_and_b32 v95, 0xffff0000, v23
    v_pk_add_f32 v[80:81], v[80:81], v[88:89]
    v_pk_add_f32 v[82:83], v[82:83], v[90:91]
    v_pk_add_f32 v[84:85], v[84:85], v[92:93]
    v_pk_add_f32 v[86:87], v[86:87], v[94:95]
    s_waitcnt vmcnt(12)
    v_lshlrev_b32 v88, 16, v24
    v_and_b32 v89, 0xffff0000, v24
    v_lshlrev_b32 v90, 16, v25
    v_and_b32 v91, 0xffff0000, v25
    v_lshlrev_b32 v92, 16, v26
    v_and_b32 v93, 0xffff0000, v26
    v_lshlrev_b32 v94, 16, v27
    v_and_b32 v95, 0xffff0000, v27
    v_pk_add_f32 v[80:81], v[80:81], v[88:89]
    v_pk_add_f32 v[82:83], v[82:83], v[90:91]
    v_pk_add_f32 v[84:85], v[84:85], v[92:93]
    v_pk_add_f32 v[86:87], v[86:87], v[94:95]
    s_waitcnt vmcnt(11)
    v_lshlrev_b32 v88, 16, v28
    v_and_b32 v89, 0xffff0000, v28
    v_lshlrev_b32 v90, 16, v29
    v_and_b32 v91, 0xffff0000, v29
    v_lshlrev_b32 v92, 16, v30
    v_and_b32 v93, 0xffff0000, v30
    v_lshlrev_b32 v94, 16, v31
    v_and_b32 v95, 0xffff0000, v31
    v_pk_add_f32 v[80:81], v[80:81], v[88:89]
    v_pk_add_f32 v[82:83], v[82:83], v[90:91]
    v_pk_add_f32 v[84:85], v[84:85], v[92:93]
    v_pk_add_f32 v[86:87], v[86:87], v[94:95]
    s_waitcnt vmcnt(10)
    v_lshlrev_b32 v88, 16, v32
    v_and_b32 v89, 0xffff0000, v32
    v_lshlrev_b32 v90, 16, v33
    v_and_b32 v91, 0xffff0000, v33
    v_lshlrev_b32 v92, 16, v34
    v_and_b32 v93, 0xffff0000, v34
    v_lshlrev_b32 v94, 16, v35
    v_and_b32 v95, 0xffff0000, v35
    v_pk_add_f32 v[80:81], v[80:81], v[88:89]
    v_pk_add_f32 v[82:83], v[82:83], v[90:91]
    v_pk_add_f32 v[84:85], v[84:85], v[92:93]
    v_pk_add_f32 v[86:87], v[86:87], v[94:95]
    v_cvt_pk_bf16_f32 v80, v80, v81
    v_cvt_pk_bf16_f32 v81, v82, v83
    v_cvt_pk_bf16_f32 v82, v84, v85
    v_cvt_pk_bf16_f32 v83, v86, v87
    s_nop 1
    v_permlane32_swap_b32 v80, v82
    v_permlane32_swap_b32 v81, v83
    buffer_store_dwordx4 v[80:83], v5, s[40:43], s58 offen offset:0 nt
    s_waitcnt vmcnt(10)
    v_lshlrev_b32 v96, 16, v36
    v_and_b32 v97, 0xffff0000, v36
    v_lshlrev_b32 v98, 16, v37
    v_and_b32 v99, 0xffff0000, v37
    v_lshlrev_b32 v100, 16, v38
    v_and_b32 v101, 0xffff0000, v38
    v_lshlrev_b32 v102, 16, v39
    v_and_b32 v103, 0xffff0000, v39
    s_waitcnt vmcnt(9)
    v_lshlrev_b32 v104, 16, v40
    v_and_b32 v105, 0xffff0000, v40
    v_lshlrev_b32 v106, 16, v41
    v_and_b32 v107, 0xffff0000, v41
    v_lshlrev_b32 v108, 16, v42
    v_and_b32 v109, 0xffff0000, v42
    v_lshlrev_b32 v110, 16, v43
    v_and_b32 v111, 0xffff0000, v43
    v_pk_add_f32 v[96:97], v[96:97], v[104:105]
    v_pk_add_f32 v[98:99], v[98:99], v[106:107]
    v_pk_add_f32 v[100:101], v[100:101], v[108:109]
    v_pk_add_f32 v[102:103], v[102:103], v[110:111]
    s_waitcnt vmcnt(8)
    v_lshlrev_b32 v104, 16, v44
    v_and_b32 v105, 0xffff0000, v44
    v_lshlrev_b32 v106, 16, v45
    v_and_b32 v107, 0xffff0000, v45
    v_lshlrev_b32 v108, 16, v46
    v_and_b32 v109, 0xffff0000, v46
    v_lshlrev_b32 v110, 16, v47
    v_and_b32 v111, 0xffff0000, v47
    v_pk_add_f32 v[96:97], v[96:97], v[104:105]
    v_pk_add_f32 v[98:99], v[98:99], v[106:107]
    v_pk_add_f32 v[100:101], v[100:101], v[108:109]
    v_pk_add_f32 v[102:103], v[102:103], v[110:111]
    s_waitcnt vmcnt(7)
    v_lshlrev_b32 v104, 16, v48
    v_and_b32 v105, 0xffff0000, v48
    v_lshlrev_b32 v106, 16, v49
    v_and_b32 v107, 0xffff0000, v49
    v_lshlrev_b32 v108, 16, v50
    v_and_b32 v109, 0xffff0000, v50
    v_lshlrev_b32 v110, 16, v51
    v_and_b32 v111, 0xffff0000, v51
    v_pk_add_f32 v[96:97], v[96:97], v[104:105]
    v_pk_add_f32 v[98:99], v[98:99], v[106:107]
    v_pk_add_f32 v[100:101], v[100:101], v[108:109]
    v_pk_add_f32 v[102:103], v[102:103], v[110:111]
    s_waitcnt vmcnt(6)
    v_lshlrev_b32 v104, 16, v52
    v_and_b32 v105, 0xffff0000, v52
    v_lshlrev_b32 v106, 16, v53
    v_and_b32 v107, 0xffff0000, v53
    v_lshlrev_b32 v108, 16, v54
    v_and_b32 v109, 0xffff0000, v54
    v_lshlrev_b32 v110, 16, v55
    v_and_b32 v111, 0xffff0000, v55
    v_pk_add_f32 v[96:97], v[96:97], v[104:105]
    v_pk_add_f32 v[98:99], v[98:99], v[106:107]
    v_pk_add_f32 v[100:101], v[100:101], v[108:109]
    v_pk_add_f32 v[102:103], v[102:103], v[110:111]
    v_cvt_pk_bf16_f32 v96, v96, v97
    v_cvt_pk_bf16_f32 v97, v98, v99
    v_cvt_pk_bf16_f32 v98, v100, v101
    v_cvt_pk_bf16_f32 v99, v102, v103
    s_nop 1
    v_permlane32_swap_b32 v96, v98
    v_permlane32_swap_b32 v97, v99
    buffer_store_dwordx4 v[96:99], v5, s[40:43], s58 offen offset:64 nt
    s_waitcnt vmcnt(6)
    v_lshlrev_b32 v112, 16, v56
    v_and_b32 v113, 0xffff0000, v56
    v_lshlrev_b32 v114, 16, v57
    v_and_b32 v115, 0xffff0000, v57
    v_lshlrev_b32 v116, 16, v58
    v_and_b32 v117, 0xffff0000, v58
    v_lshlrev_b32 v118, 16, v59
    v_and_b32 v119, 0xffff0000, v59
    s_waitcnt vmcnt(5)
    v_lshlrev_b32 v120, 16, v60
    v_and_b32 v121, 0xffff0000, v60
    v_lshlrev_b32 v122, 16, v61
    v_and_b32 v123, 0xffff0000, v61
    v_lshlrev_b32 v124, 16, v62
    v_and_b32 v125, 0xffff0000, v62
    v_lshlrev_b32 v126, 16, v63
    v_and_b32 v127, 0xffff0000, v63
    v_pk_add_f32 v[112:113], v[112:113], v[120:121]
    v_pk_add_f32 v[114:115], v[114:115], v[122:123]
    v_pk_add_f32 v[116:117], v[116:117], v[124:125]
    v_pk_add_f32 v[118:119], v[118:119], v[126:127]
    s_waitcnt vmcnt(4)
    v_lshlrev_b32 v120, 16, v64
    v_and_b32 v121, 0xffff0000, v64
    v_lshlrev_b32 v122, 16, v65
    v_and_b32 v123, 0xffff0000, v65
    v_lshlrev_b32 v124, 16, v66
    v_and_b32 v125, 0xffff0000, v66
    v_lshlrev_b32 v126, 16, v67
    v_and_b32 v127, 0xffff0000, v67
    v_pk_add_f32 v[112:113], v[112:113], v[120:121]
    v_pk_add_f32 v[114:115], v[114:115], v[122:123]
    v_pk_add_f32 v[116:117], v[116:117], v[124:125]
    v_pk_add_f32 v[118:119], v[118:119], v[126:127]
    s_waitcnt vmcnt(3)
    v_lshlrev_b32 v120, 16, v68
    v_and_b32 v121, 0xffff0000, v68
    v_lshlrev_b32 v122, 16, v69
    v_and_b32 v123, 0xffff0000, v69
    v_lshlrev_b32 v124, 16, v70
    v_and_b32 v125, 0xffff0000, v70
    v_lshlrev_b32 v126, 16, v71
    v_and_b32 v127, 0xffff0000, v71
    v_pk_add_f32 v[112:113], v[112:113], v[120:121]
    v_pk_add_f32 v[114:115], v[114:115], v[122:123]
    v_pk_add_f32 v[116:117], v[116:117], v[124:125]
    v_pk_add_f32 v[118:119], v[118:119], v[126:127]
    s_waitcnt vmcnt(2)
    v_lshlrev_b32 v120, 16, v72
    v_and_b32 v121, 0xffff0000, v72
    v_lshlrev_b32 v122, 16, v73
    v_and_b32 v123, 0xffff0000, v73
    v_lshlrev_b32 v124, 16, v74
    v_and_b32 v125, 0xffff0000, v74
    v_lshlrev_b32 v126, 16, v75
    v_and_b32 v127, 0xffff0000, v75
    v_pk_add_f32 v[112:113], v[112:113], v[120:121]
    v_pk_add_f32 v[114:115], v[114:115], v[122:123]
    v_pk_add_f32 v[116:117], v[116:117], v[124:125]
    v_pk_add_f32 v[118:119], v[118:119], v[126:127]
    v_cvt_pk_bf16_f32 v112, v112, v113
    v_cvt_pk_bf16_f32 v113, v114, v115
    v_cvt_pk_bf16_f32 v114, v116, v117
    v_cvt_pk_bf16_f32 v115, v118, v119
    s_nop 1
    v_permlane32_swap_b32 v112, v114
    v_permlane32_swap_b32 v113, v115
    buffer_store_dwordx4 v[112:115], v5, s[40:43], s58 offen offset:128 nt
    s_branch L_done
L_slotB:
    s_sub_u32 s3, s2, 256
    s_cmp_eq_u32 s3, 255
    s_cselect_b32 s78, 24, s3
    s_cmp_eq_u32 s3, 24
    s_cselect_b32 s78, 99, s78
    s_cmp_gt_u32 s78, 24
    s_cbranch_scc1 L_noinit
    s_setprio 3
    v_lshrrev_b32 v5, 3, v0
    v_and_b32 v6, 7, v0
    v_lshlrev_b32 v6, 4, v6
    v_lshl_add_u32 v5, v5, 8, v6
    v_mov_b32 v8, 0
    v_mov_b32 v9, 0
    v_mov_b32 v10, 0
    v_mov_b32 v11, 0
    s_cmp_eq_u32 s78, 24
    s_cbranch_scc1 L_inie_33
    s_lshl_b32 s72, s78, 2
    s_add_u32 s72, s72, s52
    s_lshl_b32 s72, s72, 11
    s_add_u32 s72, s72, 29605888
    buffer_store_dwordx4 v[8:11], v5, s[48:51], s72 offen sc1
    s_movk_i32 s73, 128
    s_branch L_inij_34
L_inie_33:
    s_mul_i32 s72, s52, 12288
    s_add_u32 s72, s72, 29868032
    buffer_store_dwordx4 v[8:11], v5, s[48:51], s72 offen sc1
    buffer_store_dwordx4 v[8:11], v5, s[48:51], s72 offen offset:2048 sc1
    s_add_u32 s72, s72, 4096
    buffer_store_dwordx4 v[8:11], v5, s[48:51], s72 offen sc1
    buffer_store_dwordx4 v[8:11], v5, s[48:51], s72 offen offset:2048 sc1
    s_add_u32 s72, s72, 4096
    buffer_store_dwordx4 v[8:11], v5, s[48:51], s72 offen sc1
    buffer_store_dwordx4 v[8:11], v5, s[48:51], s72 offen offset:2048 sc1
    s_mov_b32 s73, 0
L_inij_34:
    buffer_load_dword v12, v8, s[84:87], 0 offen offset:64 sc1
    s_waitcnt vmcnt(0)
    s_barrier
    s_cmp_lg_u32 s52, 0
    s_cbranch_scc1 L_ini_35
    v_mov_b32 v6, 1
    s_mov_b64 exec, 1
    buffer_atomic_add v6, v8, s[84:87], s73 offen sc1
    s_mov_b64 exec, -1
L_ini_35:
    s_setprio 0
L_noinit:
    s_cmp_lg_u32 s52, 0
    s_cbranch_scc1 L_hz_36
    s_lshl_b32 s72, s3, 8
    s_add_u32 s72, s72, 29802496
    v_lshlrev_b32 v5, 4, v0
    v_mov_b32 v8, 0
    v_mov_b32 v9, 0
    v_mov_b32 v10, 0
    v_mov_b32 v11, 0
    s_mov_b64 exec, 0xff
    buffer_store_dwordx4 v[8:11], v5, s[48:51], s72 offen sc1
    s_mov_b64 exec, -1
L_hz_36:
    s_cmp_lt_u32 s3, 192
    s_cbranch_scc1 L_nox_37
    s_mov_b32 s40, s18
    s_mov_b32 s41, s19
    s_mov_b32 s42, 1990656
    s_mov_b32 s43, 0x00020000
    s_mov_b32 s44, s16
    s_mov_b32 s45, s17
    s_mov_b32 s46, 2359296
    s_mov_b32 s47, 0x00020000
    s_bfe_u32 s53, s3, 0x30003
    s_lshl_b32 s53, s53, 2
    s_add_u32 s53, s53, s52
    s_and_b32 s54, s3, 1
    s_mul_i32 s54, s54, 13
    s_add_u32 s54, s54, 3456
    s_bfe_u32 s55, s3, 0x20001
    s_mul_i32 s55, s55, 4608
    s_add_u32 s55, s55, 2
    v_mul_u32_u24 v8, 9, v0
    s_add_u32 s56, s53, 0
    s_mul_i32 s57, s56, 745
    s_lshr_b32 s57, s57, 14
    s_mul_i32 s58, s57, 22
    s_sub_u32 s56, s56, s58
    s_cmp_ge_u32 s56, 14
    s_cbranch_scc1 L_tx_38
    s_lshl_b32 s56, s56, 6
    v_add_u32 v5, s56, v0
    v_mul_u32_u24 v6, 18725, v5
    v_lshrrev_b32 v6, 18, v6
    v_mul_u32_u24 v6, 13, v6
    s_mul_i32 s57, s57, 1728
    s_add_u32 s57, s57, s54
    v_add3_u32 v5, v5, v6, s57
    v_lshlrev_b32 v5, 7, v5
    buffer_load_dword v60, v5, s[40:43], 0 offen
    s_branch L_te_39
L_tx_38:
    s_sub_u32 s56, s56, 14
    s_mul_i32 s56, s56, 576
    s_add_u32 s56, s56, s57
    s_add_u32 s56, s56, s55
    v_add_lshl_u32 v5, v8, s56, 7
    buffer_load_dword v60, v5, s[44:47], 0 offen
L_te_39:
    s_add_u32 s56, s53, 32
    s_mul_i32 s57, s56, 745
    s_lshr_b32 s57, s57, 14
    s_mul_i32 s58, s57, 22
    s_sub_u32 s56, s56, s58
    s_cmp_ge_u32 s56, 14
    s_cbranch_scc1 L_tx_40
    s_lshl_b32 s56, s56, 6
    v_add_u32 v5, s56, v0
    v_mul_u32_u24 v6, 18725, v5
    v_lshrrev_b32 v6, 18, v6
    v_mul_u32_u24 v6, 13, v6
    s_mul_i32 s57, s57, 1728
    s_add_u32 s57, s57, s54
    v_add3_u32 v5, v5, v6, s57
    v_lshlrev_b32 v5, 7, v5
    buffer_load_dword v61, v5, s[40:43], 0 offen
    s_branch L_te_41
L_tx_40:
    s_sub_u32 s56, s56, 14
    s_mul_i32 s56, s56, 576
    s_add_u32 s56, s56, s57
    s_add_u32 s56, s56, s55
    v_add_lshl_u32 v5, v8, s56, 7
    buffer_load_dword v61, v5, s[44:47], 0 offen
L_te_41:
    s_waitcnt vmcnt(1)
    s_add_u32 s56, s53, 64
    s_mul_i32 s57, s56, 745
    s_lshr_b32 s57, s57, 14
    s_mul_i32 s58, s57, 22
    s_sub_u32 s56, s56, s58
    s_cmp_ge_u32 s56, 14
    s_cbranch_scc1 L_tx_42
    s_lshl_b32 s56, s56, 6
    v_add_u32 v5, s56, v0
    v_mul_u32_u24 v6, 18725, v5
    v_lshrrev_b32 v6, 18, v6
    v_mul_u32_u24 v6, 13, v6
    s_mul_i32 s57, s57, 1728
    s_add_u32 s57, s57, s54
    v_add3_u32 v5, v5, v6, s57
    v_lshlrev_b32 v5, 7, v5
    buffer_load_dword v60, v5, s[40:43], 0 offen
    s_branch L_te_43
L_tx_42:
    s_sub_u32 s56, s56, 14
    s_mul_i32 s56, s56, 576
    s_add_u32 s56, s56, s57
    s_add_u32 s56, s56, s55
    v_add_lshl_u32 v5, v8, s56, 7
    buffer_load_dword v60, v5, s[44:47], 0 offen
L_te_43:
    s_waitcnt vmcnt(1)
    s_add_u32 s56, s53, 96
    s_mul_i32 s57, s56, 745
    s_lshr_b32 s57, s57, 14
    s_mul_i32 s58, s57, 22
    s_sub_u32 s56, s56, s58
    s_cmp_ge_u32 s56, 14
    s_cbranch_scc1 L_tx_44
    s_lshl_b32 s56, s56, 6
    v_add_u32 v5, s56, v0
    v_mul_u32_u24 v6, 18725, v5
    v_lshrrev_b32 v6, 18, v6
    v_mul_u32_u24 v6, 13, v6
    s_mul_i32 s57, s57, 1728
    s_add_u32 s57, s57, s54
    v_add3_u32 v5, v5, v6, s57
    v_lshlrev_b32 v5, 7, v5
    buffer_load_dword v61, v5, s[40:43], 0 offen
    s_branch L_te_45
L_tx_44:
    s_sub_u32 s56, s56, 14
    s_mul_i32 s56, s56, 576
    s_add_u32 s56, s56, s57
    s_add_u32 s56, s56, s55
    v_add_lshl_u32 v5, v8, s56, 7
    buffer_load_dword v61, v5, s[44:47], 0 offen
L_te_45:
    s_waitcnt vmcnt(1)
    s_add_u32 s56, s53, 128
    s_mul_i32 s57, s56, 745
    s_lshr_b32 s57, s57, 14
    s_mul_i32 s58, s57, 22
    s_sub_u32 s56, s56, s58
    s_cmp_ge_u32 s57, 7
    s_cbranch_scc1 L_te_47
    s_cmp_ge_u32 s56, 14
    s_cbranch_scc1 L_tx_46
    s_lshl_b32 s56, s56, 6
    v_add_u32 v5, s56, v0
    v_mul_u32_u24 v6, 18725, v5
    v_lshrrev_b32 v6, 18, v6
    v_mul_u32_u24 v6, 13, v6
    s_mul_i32 s57, s57, 1728
    s_add_u32 s57, s57, s54
    v_add3_u32 v5, v5, v6, s57
    v_lshlrev_b32 v5, 7, v5
    buffer_load_dword v60, v5, s[40:43], 0 offen
    s_branch L_te_47
L_tx_46:
    s_sub_u32 s56, s56, 14
    s_mul_i32 s56, s56, 576
    s_add_u32 s56, s56, s57
    s_add_u32 s56, s56, s55
    v_add_lshl_u32 v5, v8, s56, 7
    buffer_load_dword v60, v5, s[44:47], 0 offen
L_te_47:
    s_waitcnt vmcnt(1)
L_nox_37:
    s_cmp_lt_u32 s3, 192
    s_cbranch_scc1 L_w1h_48
    s_cmp_ge_u32 s53, 30
    s_cbranch_scc1 L_w1h_48
    s_mov_b32 s80, s24
    s_mov_b32 s81, s25
    s_mov_b32 s82, 18874368
    s_mov_b32 s83, 0x00020000
    s_mul_i32 s57, s53, 205
    s_lshr_b32 s57, s57, 10
    s_mul_i32 s58, s57, 5
    s_sub_u32 s58, s53, s58
    s_and_b32 s56, s3, 7
    s_mul_i32 s56, s56, 9
    s_lshr_b32 s56, s56, 1
    s_add_u32 s56, s56, s58
    s_lshl_b32 s56, s56, 8
    s_mul_i32 s57, s57, 294912
    s_add_u32 s56, s56, s57
    v_lshrrev_b32 v5, 1, v0
    v_mul_u32_u24 v5, 9216, v5
    v_and_b32 v6, 1, v0
    v_lshl_add_u32 v5, v6, 7, v5
    buffer_load_dword v62, v5, s[80:83], s56 offen
L_w1h_48:
    s_setprio 0
    s_cmp_lt_u32 s3, 216
    s_cbranch_scc1 L_mlp1
    s_waitcnt vmcnt(0)
    s_cmp_lg_u32 s52, 0
    s_cbranch_scc1 L_pw_49
    s_buffer_load_dword s75, s[84:87], 0
    s_waitcnt lgkmcnt(0)
    s_cmp_ge_u32 s75, 1
    s_cbranch_scc1 L_ini_50
    v_mov_b32 v5, 0
    s_mov_b32 s74, 0
L_inir_51:
    s_sleep 6
    s_mov_b64 exec, 1
    buffer_load_dword v6, v5, s[84:87], 0 offen offset:0 sc1
    s_mov_b64 exec, -1
    s_waitcnt vmcnt(0)
    v_readfirstlane_b32 s75, v6
    s_add_u32 s74, s74, 1
    s_cmp_ge_u32 s75, 1
    s_cbranch_scc1 L_ini_50
    s_cmp_lt_u32 s74, 262144
    s_cbranch_scc1 L_inir_51
L_ini_50:
L_pw_49:
    s_barrier
    s_cmp_lt_u32 s3, 192
    s_cbranch_scc1 L_mlp1
    s_bfe_u32 s72, s3, 0x20001
    s_lshl_b32 s72, s72, 5
    s_and_b32 s73, s3, 31
    s_add_u32 s72, s72, s73
    s_lshl_b32 s72, s72, 8
    s_add_u32 s72, s72, 29868032
    s_cmp_lg_u32 s52, 0
    s_cbranch_scc1 L_pw_52
    s_mov_b32 s74, 0
L_poll_53:
    s_buffer_load_dword s75, s[48:51], s72 glc
    s_add_u32 s74, s74, 1
    s_waitcnt lgkmcnt(0)
    s_cmp_ge_u32 s75, 16
    s_cbranch_scc1 L_polld_54
    s_sleep 4
    s_cmp_lt_u32 s74, 262144
    s_cbranch_scc1 L_poll_53
L_polld_54:
L_pw_52:
    s_barrier
    s_mov_b32 s40, s24
    s_mov_b32 s41, s25
    s_mov_b32 s42, 18874368
    s_mov_b32 s43, 0x00020000
    s_sub_u32 s67, 255, s3
    s_mul_i32 s66, s52, 4718592
    s_lshl_b32 s68, s67, 13
    s_add_u32 s66, s66, s68
    v_lshlrev_b32 v5, 7, v0
    v_add_u32 v5, s66, v5
    s_cmp_ge_u32 s3, 216
    s_cbranch_scc1 L_aux
L_mlp1:
    s_mov_b32 s40, s24
    s_mov_b32 s41, s25
    s_mov_b32 s42, 18874368
    s_mov_b32 s43, 0x00020000
    s_mov_b32 s44, s26
    s_mov_b32 s45, s27
    s_mov_b32 s46, 9216
    s_mov_b32 s47, 0x00020000
    s_and_b32 s66, s3, 7
    s_mul_i32 s66, s66, 27
    s_lshr_b32 s67, s3, 3
    s_add_u32 s67, s67, s66
    s_mul_i32 s66, s67, 171
    s_lshr_b32 s66, s66, 10
    s_mul_i32 s68, s66, 6
    s_sub_u32 s67, s67, s68
    s_add_u32 s59, s67, s68
    s_mul_i32 s54, s52, 73728
    s_lshl_b32 s70, s66, 8
    s_add_u32 s54, s54, s70
    s_lshr_b32 s70, s52, 1
    s_mul_i32 s55, s70, 18432
    s_and_b32 s70, s52, 1
    s_mul_i32 s70, s70, 1536
    s_add_u32 s55, s55, s70
    s_mul_i32 s70, s67, 3072
    s_add_u32 s55, s55, s70
    s_add_u32 s55, s55, 0
    s_lshl_b32 s60, s52, 11
    s_mul_i32 s61, s52, 1536
    s_add_u32 s61, s61, 8192
    s_mov_b32 s62, 294912
    s_mov_b32 s63, 36864
    v_lshrrev_b32 v8, 4, v0
    v_and_b32 v9, 3, v0
    v_lshlrev_b32 v9, 4, v9
    v_lshl_add_u32 v8, v8, 6, v9
    v_bfe_u32 v9, v0, 2, 2
    v_mul_u32_u24 v10, 9216, v9
    v_add_u32 v5, v10, v8
    v_add_u32 v6, 36864, v5
    v_lshlrev_b32 v7, 4, v0
    s_lshl_b32 s69, s66, 2
    s_add_u32 s69, s69, s52
    s_lshl_b32 s71, s69, 6
    v_lshrrev_b32 v10, 5, v0
    v_lshlrev_b32 v11, 3, v10
    buffer_load_dwordx2 v[144:145], v11, s[44:47], s71 offen offset:0
    buffer_load_dwordx2 v[146:147], v11, s[44:47], s71 offen offset:16
    buffer_load_dwordx2 v[148:149], v11, s[44:47], s71 offen offset:32
    buffer_load_dwordx2 v[150:151], v11, s[44:47], s71 offen offset:48
    s_waitcnt vmcnt(0)
    s_cmp_lg_u32 s52, 0
    s_cbranch_scc1 L_pw_55
    s_buffer_load_dword s75, s[84:87], 0
    s_waitcnt lgkmcnt(0)
    s_cmp_ge_u32 s75, 1
    s_cbranch_scc1 L_ini_56
    v_mov_b32 v12, 0
    s_mov_b32 s74, 0
L_inir_57:
    s_sleep 6
    s_mov_b64 exec, 1
    buffer_load_dword v13, v12, s[84:87], 0 offen offset:0 sc1
    s_mov_b64 exec, -1
    s_waitcnt vmcnt(0)
    v_readfirstlane_b32 s75, v13
    s_add_u32 s74, s74, 1
    s_cmp_ge_u32 s75, 1
    s_cbranch_scc1 L_ini_56
    s_cmp_lt_u32 s74, 262144
    s_cbranch_scc1 L_inir_57
L_ini_56:
L_pw_55:
    s_barrier
    s_cmp_ge_u32 s3, 192
    s_cbranch_scc1 L_holdd_59
    s_lshl_b32 s72, s3, 8
    s_add_u32 s72, s72, 29802496
    s_and_b32 s73, s3, 63
    s_lshl_b32 s73, s73, 8
    s_add_u32 s73, s73, 29900800
    s_mov_b32 s74, 0
L_hold_58:
    s_buffer_load_dword s75, s[48:51], s72 glc
    s_add_u32 s74, s74, 1
    s_waitcnt lgkmcnt(0)
    s_cmp_lg_u32 s75, 0
    s_cbranch_scc1 L_holdd_59
    s_sleep 4
    s_and_b32 s75, s74, 15
    s_cbranch_scc1 L_hold_58
    s_buffer_load_dword s75, s[48:51], s73 glc
    s_waitcnt lgkmcnt(0)
    s_cmp_ge_u32 s75, 12
    s_cbranch_scc1 L_holdd_59
    s_cmp_lt_u32 s74, 262144
    s_cbranch_scc1 L_hold_58
L_holdd_59:
    s_add_u32 m0, s60, 0
    s_nop 0
    buffer_load_dwordx4 v5, s[40:43], s54 offen lds
    s_add_u32 m0, s60, 1024
    s_nop 0
    buffer_load_dwordx4 v6, s[40:43], s54 offen lds
    s_add_u32 s54, s54, s62
    s_add_u32 m0, s60, 14336
    s_nop 0
    buffer_load_dwordx4 v5, s[40:43], s54 offen lds
    s_add_u32 m0, s60, 15360
    s_nop 0
    buffer_load_dwordx4 v6, s[40:43], s54 offen lds
    s_add_u32 s54, s54, s62
    s_add_u32 m0, s60, 28672
    s_nop 0
    buffer_load_dwordx4 v5, s[40:43], s54 offen lds
    s_add_u32 m0, s60, 29696
    s_nop 0
    buffer_load_dwordx4 v6, s[40:43], s54 offen lds
    s_add_u32 s54, s54, s62
    s_add_u32 m0, s60, 43008
    s_nop 0
    buffer_load_dwordx4 v5, s[40:43], s54 offen lds
    s_add_u32 m0, s60, 44032
    s_nop 0
    buffer_load_dwordx4 v6, s[40:43], s54 offen lds
    s_add_u32 s54, s54, s62
    s_add_u32 m0, s60, 57344
    s_nop 0
    buffer_load_dwordx4 v5, s[40:43], s54 offen lds
    s_add_u32 m0, s60, 58368
    s_nop 0
    buffer_load_dwordx4 v6, s[40:43], s54 offen lds
    s_add_u32 s54, s54, s62
    v_lshlrev_b32 v8, 11, v10
    v_lshl_add_u32 v8, v9, 6, v8
    v_bfe_u32 v9, v0, 4, 1
    v_lshl_add_u32 v8, v9, 5, v8
    v_and_b32 v9, 3, v0
    v_lshl_add_u32 v8, v9, 3, v8
    s_lshl_b32 s70, s52, 8
    v_add_u32 v3, s70, v8
    v_add_u32 v4, 43008, v3
    v_add_u32 v1, 0x2000, v7
    v_add_u32 v2, 43008, v1
    s_lshl_b32 s72, s52, 5
    s_and_b32 s73, s3, 31
    s_add_u32 s72, s72, s73
    s_lshl_b32 s72, s72, 8
    s_add_u32 s72, s72, 29868032
    s_mov_b32 s74, 0
L_poll_60:
    s_buffer_load_dword s75, s[48:51], s72 glc
    s_add_u32 s74, s74, 1
    s_waitcnt lgkmcnt(0)
    s_cmp_ge_u32 s75, 16
    s_cbranch_scc1 L_polld_61
    s_sleep 4
    s_cmp_lt_u32 s74, 262144
    s_cbranch_scc1 L_poll_60
L_polld_61:
    s_barrier
    s_add_u32 m0, s61, 0
    s_nop 0
    buffer_load_dwordx4 v7, s[48:51], s55 offen offset:0 sc1 lds
    s_mov_b32 exec_hi, 0
    buffer_load_dwordx4 v7, s[48:51], s55 offen offset:1024 sc1 lds
    s_mov_b32 exec_hi, -1
    s_add_u32 s55, s55, s63
    s_add_u32 m0, s61, 14336
    s_nop 0
    buffer_load_dwordx4 v7, s[48:51], s55 offen offset:0 sc1 lds
    s_mov_b32 exec_hi, 0
    buffer_load_dwordx4 v7, s[48:51], s55 offen offset:1024 sc1 lds
    s_mov_b32 exec_hi, -1
    s_add_u32 s55, s55, s63
    s_add_u32 m0, s61, 28672
    s_nop 0
    buffer_load_dwordx4 v7, s[48:51], s55 offen offset:0 sc1 lds
    s_mov_b32 exec_hi, 0
    buffer_load_dwordx4 v7, s[48:51], s55 offen offset:1024 sc1 lds
    s_mov_b32 exec_hi, -1
    s_add_u32 s55, s55, s63
    s_add_u32 m0, s61, 43008
    s_nop 0
    buffer_load_dwordx4 v7, s[48:51], s55 offen offset:0 sc1 lds
    s_mov_b32 exec_hi, 0
    buffer_load_dwordx4 v7, s[48:51], s55 offen offset:1024 sc1 lds
    s_mov_b32 exec_hi, -1
    s_add_u32 s55, s55, s63
    s_add_u32 m0, s61, 57344
    s_nop 0
    buffer_load_dwordx4 v7, s[48:51], s55 offen offset:0 sc1 lds
    s_mov_b32 exec_hi, 0
    buffer_load_dwordx4 v7, s[48:51], s55 offen offset:1024 sc1 lds
    s_mov_b32 exec_hi, -1
    s_add_u32 s55, s55, s63
    s_waitcnt vmcnt(8)
    s_barrier
    ds_read_b64_tr_b16 v[16:17], v3 offset:0
    ds_read_b64_tr_b16 v[18:19], v3 offset:1024
    ds_read_b128 v[20:23], v1 offset:0
    ds_read_b128 v[24:27], v1 offset:1024
    ds_read_b128 v[28:31], v1 offset:2048
    ds_read_b64_tr_b16 v[32:33], v3 offset:4096
    ds_read_b64_tr_b16 v[34:35], v3 offset:5120
    ds_read_b128 v[36:39], v1 offset:3072
    ds_read_b128 v[40:43], v1 offset:4096
    ds_read_b128 v[44:47], v1 offset:5120
    v_lshlrev_b32 v128, 16, v144
    v_and_b32 v129, 0xffff0000, v144
    v_lshlrev_b32 v130, 16, v145
    v_and_b32 v131, 0xffff0000, v145
    v_lshlrev_b32 v132, 16, v146
    v_and_b32 v133, 0xffff0000, v146
    v_lshlrev_b32 v134, 16, v147
    v_and_b32 v135, 0xffff0000, v147
    v_lshlrev_b32 v136, 16, v148
    v_and_b32 v137, 0xffff0000, v148
    v_lshlrev_b32 v138, 16, v149
    v_and_b32 v139, 0xffff0000, v149
    v_lshlrev_b32 v140, 16, v150
    v_and_b32 v141, 0xffff0000, v150
    v_lshlrev_b32 v142, 16, v151
    v_and_b32 v143, 0xffff0000, v151
    s_setprio 0
    s_waitcnt vmcnt(6) lgkmcnt(0)
    s_barrier
    v_mfma_f32_32x32x16_bf16 v[80:95], v[16:19], v[20:23], v[128:143]
    s_add_u32 m0, s60, 0
    ds_read_b64_tr_b16 v[48:49], v3 offset:14336
    ds_read_b64_tr_b16 v[50:51], v3 offset:15360
    ds_read_b128 v[52:55], v1 offset:14336
    buffer_load_dwordx4 v5, s[40:43], s54 offen lds
    v_mfma_f32_32x32x16_bf16 v[96:111], v[16:19], v[24:27], v[128:143]
    s_add_u32 m0, s60, 1024
    ds_read_b128 v[56:59], v1 offset:15360
    ds_read_b128 v[60:63], v1 offset:16384
    ds_read_b64_tr_b16 v[64:65], v3 offset:18432
    v_mfma_f32_32x32x16_bf16 v[112:127], v[16:19], v[28:31], v[128:143]
    buffer_load_dwordx4 v6, s[40:43], s54 offen lds
    s_add_u32 s54, s54, s62
    ds_read_b64_tr_b16 v[66:67], v3 offset:19456
    ds_read_b128 v[68:71], v1 offset:17408
    v_mfma_f32_32x32x16_bf16 v[80:95], v[32:35], v[36:39], v[80:95]
    s_add_u32 m0, s61, 0
    ds_read_b128 v[72:75], v1 offset:18432
    ds_read_b128 v[76:79], v1 offset:19456
    buffer_load_dwordx4 v7, s[48:51], s55 offen offset:0 sc1 lds
    v_mfma_f32_32x32x16_bf16 v[96:111], v[32:35], v[40:43], v[96:111]
    s_mov_b32 exec_hi, 0
    buffer_load_dwordx4 v7, s[48:51], s55 offen offset:1024 sc1 lds
    s_mov_b32 exec_hi, -1
    s_add_u32 s55, s55, s63
    v_mfma_f32_32x32x16_bf16 v[112:127], v[32:35], v[44:47], v[112:127]
    s_waitcnt vmcnt(8) lgkmcnt(0)
    s_barrier
    v_mfma_f32_32x32x16_bf16 v[80:95], v[48:51], v[52:55], v[80:95]
    s_add_u32 m0, s60, 14336
    ds_read_b64_tr_b16 v[16:17], v3 offset:28672
    ds_read_b64_tr_b16 v[18:19], v3 offset:29696
    ds_read_b128 v[20:23], v1 offset:28672
    buffer_load_dwordx4 v5, s[40:43], s54 offen lds
    v_mfma_f32_32x32x16_bf16 v[96:111], v[48:51], v[56:59], v[96:111]
    s_add_u32 m0, s60, 15360
    ds_read_b128 v[24:27], v1 offset:29696
    ds_read_b128 v[28:31], v1 offset:30720
    ds_read_b64_tr_b16 v[32:33], v3 offset:32768
    v_mfma_f32_32x32x16_bf16 v[112:127], v[48:51], v[60:63], v[112:127]
    buffer_load_dwordx4 v6, s[40:43], s54 offen lds
    s_add_u32 s54, s54, s62
    ds_read_b64_tr_b16 v[34:35], v3 offset:33792
    ds_read_b128 v[36:39], v1 offset:31744
    v_mfma_f32_32x32x16_bf16 v[80:95], v[64:67], v[68:71], v[80:95]
    s_add_u32 m0, s61, 14336
    ds_read_b128 v[40:43], v1 offset:32768
    ds_read_b128 v[44:47], v1 offset:33792
    buffer_load_dwordx4 v7, s[48:51], s55 offen offset:0 sc1 lds
    v_mfma_f32_32x32x16_bf16 v[96:111], v[64:67], v[72:75], v[96:111]
    s_mov_b32 exec_hi, 0
    buffer_load_dwordx4 v7, s[48:51], s55 offen offset:1024 sc1 lds
    s_mov_b32 exec_hi, -1
    s_add_u32 s55, s55, s63
    v_mfma_f32_32x32x16_bf16 v[112:127], v[64:67], v[76:79], v[112:127]
    s_waitcnt vmcnt(10) lgkmcnt(0)
    s_barrier
    v_mfma_f32_32x32x16_bf16 v[80:95], v[16:19], v[20:23], v[80:95]
    s_add_u32 m0, s60, 28672
    ds_read_b64_tr_b16 v[48:49], v4 offset:0
    ds_read_b64_tr_b16 v[50:51], v4 offset:1024
    ds_read_b128 v[52:55], v2 offset:0
    buffer_load_dwordx4 v5, s[40:43], s54 offen lds
    v_mfma_f32_32x32x16_bf16 v[96:111], v[16:19], v[24:27], v[96:111]
    s_add_u32 m0, s60, 29696
    ds_read_b128 v[56:59], v2 offset:1024
    ds_read_b128 v[60:63], v2 offset:2048
    ds_read_b64_tr_b16 v[64:65], v4 offset:4096
    v_mfma_f32_32x32x16_bf16 v[112:127], v[16:19], v[28:31], v[112:127]
    buffer_load_dwordx4 v6, s[40:43], s54 offen lds
    s_add_u32 s54, s54, s62
    ds_read_b64_tr_b16 v[66:67], v4 offset:5120
    ds_read_b128 v[68:71], v2 offset:3072
    v_mfma_f32_32x32x16_bf16 v[80:95], v[32:35], v[36:39], v[80:95]
    s_add_u32 m0, s61, 28672
    ds_read_b128 v[72:75], v2 offset:4096
    ds_read_b128 v[76:79], v2 offset:5120
    buffer_load_dwordx4 v7, s[48:51], s55 offen offset:0 sc1 lds
    v_mfma_f32_32x32x16_bf16 v[96:111], v[32:35], v[40:43], v[96:111]
    s_mov_b32 exec_hi, 0
    buffer_load_dwordx4 v7, s[48:51], s55 offen offset:1024 sc1 lds
    s_mov_b32 exec_hi, -1
    s_add_u32 s55, s55, s63
    v_mfma_f32_32x32x16_bf16 v[112:127], v[32:35], v[44:47], v[112:127]
    s_waitcnt vmcnt(12) lgkmcnt(0)
    s_barrier
    v_mfma_f32_32x32x16_bf16 v[80:95], v[48:51], v[52:55], v[80:95]
    s_add_u32 m0, s60, 43008
    ds_read_b64_tr_b16 v[16:17], v4 offset:14336
    ds_read_b64_tr_b16 v[18:19], v4 offset:15360
    ds_read_b128 v[20:23], v2 offset:14336
    buffer_load_dwordx4 v5, s[40:43], s54 offen lds
    v_mfma_f32_32x32x16_bf16 v[96:111], v[48:51], v[56:59], v[96:111]
    s_add_u32 m0, s60, 44032
    ds_read_b128 v[24:27], v2 offset:15360
    ds_read_b128 v[28:31], v2 offset:16384
    ds_read_b64_tr_b16 v[32:33], v4 offset:18432
    v_mfma_f32_32x32x16_bf16 v[112:127], v[48:51], v[60:63], v[112:127]
    buffer_load_dwordx4 v6, s[40:43], s54 offen lds
    s_add_u32 s54, s54, s62
    ds_read_b64_tr_b16 v[34:35], v4 offset:19456
    ds_read_b128 v[36:39], v2 offset:17408
    v_mfma_f32_32x32x16_bf16 v[80:95], v[64:67], v[68:71], v[80:95]
    s_add_u32 m0, s61, 43008
    ds_read_b128 v[40:43], v2 offset:18432
    ds_read_b128 v[44:47], v2 offset:19456
    buffer_load_dwordx4 v7, s[48:51], s55 offen offset:0 sc1 lds
    v_mfma_f32_32x32x16_bf16 v[96:111], v[64:67], v[72:75], v[96:111]
    s_mov_b32 exec_hi, 0
    buffer_load_dwordx4 v7, s[48:51], s55 offen offset:1024 sc1 lds
    s_mov_b32 exec_hi, -1
    s_add_u32 s55, s55, s63
    v_mfma_f32_32x32x16_bf16 v[112:127], v[64:67], v[76:79], v[112:127]
    s_mov_b32 s58, 5
.p2align 6
L_mlp1_loop:
    s_waitcnt vmcnt(12) lgkmcnt(0)
    s_barrier
    v_mfma_f32_32x32x16_bf16 v[80:95], v[16:19], v[20:23], v[80:95]
    s_add_u32 m0, s60, 57344
    ds_read_b64_tr_b16 v[48:49], v3 offset:0
    ds_read_b64_tr_b16 v[50:51], v3 offset:1024
    ds_read_b128 v[52:55], v1 offset:0
    buffer_load_dwordx4 v5, s[40:43], s54 offen lds
    v_mfma_f32_32x32x16_bf16 v[96:111], v[16:19], v[24:27], v[96:111]
    s_add_u32 m0, s60, 58368
    ds_read_b128 v[56:59], v1 offset:1024
    ds_read_b128 v[60:63], v1 offset:2048
    ds_read_b64_tr_b16 v[64:65], v3 offset:4096
    v_mfma_f32_32x32x16_bf16 v[112:127], v[16:19], v[28:31], v[112:127]
    buffer_load_dwordx4 v6, s[40:43], s54 offen lds
    s_add_u32 s54, s54, s62
    ds_read_b64_tr_b16 v[66:67], v3 offset:5120
    ds_read_b128 v[68:71], v1 offset:3072
    v_mfma_f32_32x32x16_bf16 v[80:95], v[32:35], v[36:39], v[80:95]
    s_add_u32 m0, s61, 57344
    ds_read_b128 v[72:75], v1 offset:4096
    ds_read_b128 v[76:79], v1 offset:5120
    buffer_load_dwordx4 v7, s[48:51], s55 offen offset:0 sc1 lds
    v_mfma_f32_32x32x16_bf16 v[96:111], v[32:35], v[40:43], v[96:111]
    s_mov_b32 exec_hi, 0
    buffer_load_dwordx4 v7, s[48:51], s55 offen offset:1024 sc1 lds
    s_mov_b32 exec_hi, -1
    s_add_u32 s55, s55, s63
    v_mfma_f32_32x32x16_bf16 v[112:127], v[32:35], v[44:47], v[112:127]
    s_waitcnt vmcnt(12) lgkmcnt(0)
    s_barrier
    v_mfma_f32_32x32x16_bf16 v[80:95], v[48:51], v[52:55], v[80:95]
    s_add_u32 m0, s60, 0
    ds_read_b64_tr_b16 v[16:17], v3 offset:14336
    ds_read_b64_tr_b16 v[18:19], v3 offset:15360
    ds_read_b128 v[20:23], v1 offset:14336
    buffer_load_dwordx4 v5, s[40:43], s54 offen lds
    v_mfma_f32_32x32x16_bf16 v[96:111], v[48:51], v[56:59], v[96:111]
    s_add_u32 m0, s60, 1024
    ds_read_b128 v[24:27], v1 offset:15360
    ds_read_b128 v[28:31], v1 offset:16384
    ds_read_b64_tr_b16 v[32:33], v3 offset:18432
    v_mfma_f32_32x32x16_bf16 v[112:127], v[48:51], v[60:63], v[112:127]
    buffer_load_dwordx4 v6, s[40:43], s54 offen lds
    s_add_u32 s54, s54, s62
    ds_read_b64_tr_b16 v[34:35], v3 offset:19456
    ds_read_b128 v[36:39], v1 offset:17408
    v_mfma_f32_32x32x16_bf16 v[80:95], v[64:67], v[68:71], v[80:95]
    s_add_u32 m0, s61, 0
    ds_read_b128 v[40:43], v1 offset:18432
    ds_read_b128 v[44:47], v1 offset:19456
    buffer_load_dwordx4 v7, s[48:51], s55 offen offset:0 sc1 lds
    v_mfma_f32_32x32x16_bf16 v[96:111], v[64:67], v[72:75], v[96:111]
    s_mov_b32 exec_hi, 0
    buffer_load_dwordx4 v7, s[48:51], s55 offen offset:1024 sc1 lds
    s_mov_b32 exec_hi, -1
    s_add_u32 s55, s55, s63
    v_mfma_f32_32x32x16_bf16 v[112:127], v[64:67], v[76:79], v[112:127]
    s_waitcnt vmcnt(12) lgkmcnt(0)
    s_barrier
    v_mfma_f32_32x32x16_bf16 v[80:95], v[16:19], v[20:23], v[80:95]
    s_add_u32 m0, s60, 14336
    ds_read_b64_tr_b16 v[48:49], v3 offset:28672
    ds_read_b64_tr_b16 v[50:51], v3 offset:29696
    ds_read_b128 v[52:55], v1 offset:28672
    buffer_load_dwordx4 v5, s[40:43], s54 offen lds
    v_mfma_f32_32x32x16_bf16 v[96:111], v[16:19], v[24:27], v[96:111]
    s_add_u32 m0, s60, 15360
    ds_read_b128 v[56:59], v1 offset:29696
    ds_read_b128 v[60:63], v1 offset:30720
    ds_read_b64_tr_b16 v[64:65], v3 offset:32768
    v_mfma_f32_32x32x16_bf16 v[112:127], v[16:19], v[28:31], v[112:127]
    buffer_load_dwordx4 v6, s[40:43], s54 offen lds
    s_add_u32 s54, s54, s62
    ds_read_b64_tr_b16 v[66:67], v3 offset:33792
    ds_read_b128 v[68:71], v1 offset:31744
    v_mfma_f32_32x32x16_bf16 v[80:95], v[32:35], v[36:39], v[80:95]
    s_add_u32 m0, s61, 14336
    ds_read_b128 v[72:75], v1 offset:32768
    ds_read_b128 v[76:79], v1 offset:33792
    buffer_load_dwordx4 v7, s[48:51], s55 offen offset:0 sc1 lds
    v_mfma_f32_32x32x16_bf16 v[96:111], v[32:35], v[40:43], v[96:111]
    s_mov_b32 exec_hi, 0
    buffer_load_dwordx4 v7, s[48:51], s55 offen offset:1024 sc1 lds
    s_mov_b32 exec_hi, -1
    s_add_u32 s55, s55, s63
    v_mfma_f32_32x32x16_bf16 v[112:127], v[32:35], v[44:47], v[112:127]
    s_waitcnt vmcnt(12) lgkmcnt(0)
    s_barrier
    v_mfma_f32_32x32x16_bf16 v[80:95], v[48:51], v[52:55], v[80:95]
    s_add_u32 m0, s60, 28672
    ds_read_b64_tr_b16 v[16:17], v4 offset:0
    ds_read_b64_tr_b16 v[18:19], v4 offset:1024
    ds_read_b128 v[20:23], v2 offset:0
    buffer_load_dwordx4 v5, s[40:43], s54 offen lds
    v_mfma_f32_32x32x16_bf16 v[96:111], v[48:51], v[56:59], v[96:111]
    s_add_u32 m0, s60, 29696
    ds_read_b128 v[24:27], v2 offset:1024
    ds_read_b128 v[28:31], v2 offset:2048
    ds_read_b64_tr_b16 v[32:33], v4 offset:4096
    v_mfma_f32_32x32x16_bf16 v[112:127], v[48:51], v[60:63], v[112:127]
    buffer_load_dwordx4 v6, s[40:43], s54 offen lds
    s_add_u32 s54, s54, s62
    ds_read_b64_tr_b16 v[34:35], v4 offset:5120
    ds_read_b128 v[36:39], v2 offset:3072
    v_mfma_f32_32x32x16_bf16 v[80:95], v[64:67], v[68:71], v[80:95]
    s_add_u32 m0, s61, 28672
    ds_read_b128 v[40:43], v2 offset:4096
    ds_read_b128 v[44:47], v2 offset:5120
    buffer_load_dwordx4 v7, s[48:51], s55 offen offset:0 sc1 lds
    v_mfma_f32_32x32x16_bf16 v[96:111], v[64:67], v[72:75], v[96:111]
    s_mov_b32 exec_hi, 0
    buffer_load_dwordx4 v7, s[48:51], s55 offen offset:1024 sc1 lds
    s_mov_b32 exec_hi, -1
    s_add_u32 s55, s55, s63
    v_mfma_f32_32x32x16_bf16 v[112:127], v[64:67], v[76:79], v[112:127]
    s_waitcnt vmcnt(12) lgkmcnt(0)
    s_barrier
    v_mfma_f32_32x32x16_bf16 v[80:95], v[16:19], v[20:23], v[80:95]
    s_add_u32 m0, s60, 43008
    ds_read_b64_tr_b16 v[48:49], v4 offset:14336
    ds_read_b64_tr_b16 v[50:51], v4 offset:15360
    ds_read_b128 v[52:55], v2 offset:14336
    buffer_load_dwordx4 v5, s[40:43], s54 offen lds
    v_mfma_f32_32x32x16_bf16 v[96:111], v[16:19], v[24:27], v[96:111]
    s_add_u32 m0, s60, 44032
    ds_read_b128 v[56:59], v2 offset:15360
    ds_read_b128 v[60:63], v2 offset:16384
    ds_read_b64_tr_b16 v[64:65], v4 offset:18432
    v_mfma_f32_32x32x16_bf16 v[112:127], v[16:19], v[28:31], v[112:127]
    buffer_load_dwordx4 v6, s[40:43], s54 offen lds
    s_add_u32 s54, s54, s62
    ds_read_b64_tr_b16 v[66:67], v4 offset:19456
    ds_read_b128 v[68:71], v2 offset:17408
    v_mfma_f32_32x32x16_bf16 v[80:95], v[32:35], v[36:39], v[80:95]
    s_add_u32 m0, s61, 43008
    ds_read_b128 v[72:75], v2 offset:18432
    ds_read_b128 v[76:79], v2 offset:19456
    buffer_load_dwordx4 v7, s[48:51], s55 offen offset:0 sc1 lds
    v_mfma_f32_32x32x16_bf16 v[96:111], v[32:35], v[40:43], v[96:111]
    s_mov_b32 exec_hi, 0
    buffer_load_dwordx4 v7, s[48:51], s55 offen offset:1024 sc1 lds
    s_mov_b32 exec_hi, -1
    s_add_u32 s55, s55, s63
    v_mfma_f32_32x32x16_bf16 v[112:127], v[32:35], v[44:47], v[112:127]
    s_waitcnt vmcnt(12) lgkmcnt(0)
    s_barrier
    v_mfma_f32_32x32x16_bf16 v[80:95], v[48:51], v[52:55], v[80:95]
    s_add_u32 m0, s60, 57344
    ds_read_b64_tr_b16 v[16:17], v3 offset:0
    ds_read_b64_tr_b16 v[18:19], v3 offset:1024
    ds_read_b128 v[20:23], v1 offset:0
    buffer_load_dwordx4 v5, s[40:43], s54 offen lds
    v_mfma_f32_32x32x16_bf16 v[96:111], v[48:51], v[56:59], v[96:111]
    s_add_u32 m0, s60, 58368
    ds_read_b128 v[24:27], v1 offset:1024
    ds_read_b128 v[28:31], v1 offset:2048
    ds_read_b64_tr_b16 v[32:33], v3 offset:4096
    v_mfma_f32_32x32x16_bf16 v[112:127], v[48:51], v[60:63], v[112:127]
    buffer_load_dwordx4 v6, s[40:43], s54 offen lds
    s_add_u32 s54, s54, s62
    ds_read_b64_tr_b16 v[34:35], v3 offset:5120
    ds_read_b128 v[36:39], v1 offset:3072
    v_mfma_f32_32x32x16_bf16 v[80:95], v[64:67], v[68:71], v[80:95]
    s_add_u32 m0, s61, 57344
    ds_read_b128 v[40:43], v1 offset:4096
    ds_read_b128 v[44:47], v1 offset:5120
    buffer_load_dwordx4 v7, s[48:51], s55 offen offset:0 sc1 lds
    v_mfma_f32_32x32x16_bf16 v[96:111], v[64:67], v[72:75], v[96:111]
    s_mov_b32 exec_hi, 0
    buffer_load_dwordx4 v7, s[48:51], s55 offen offset:1024 sc1 lds
    s_mov_b32 exec_hi, -1
    s_add_u32 s55, s55, s63
    v_mfma_f32_32x32x16_bf16 v[112:127], v[64:67], v[76:79], v[112:127]
    s_waitcnt vmcnt(12) lgkmcnt(0)
    s_barrier
    v_mfma_f32_32x32x16_bf16 v[80:95], v[16:19], v[20:23], v[80:95]
    s_add_u32 m0, s60, 0
    ds_read_b64_tr_b16 v[48:49], v3 offset:14336
    ds_read_b64_tr_b16 v[50:51], v3 offset:15360
    ds_read_b128 v[52:55], v1 offset:14336
    buffer_load_dwordx4 v5, s[40:43], s54 offen lds
    v_mfma_f32_32x32x16_bf16 v[96:111], v[16:19], v[24:27], v[96:111]
    s_add_u32 m0, s60, 1024
    ds_read_b128 v[56:59], v1 offset:15360
    ds_read_b128 v[60:63], v1 offset:16384
    ds_read_b64_tr_b16 v[64:65], v3 offset:18432
    v_mfma_f32_32x32x16_bf16 v[112:127], v[16:19], v[28:31], v[112:127]
    buffer_load_dwordx4 v6, s[40:43], s54 offen lds
    s_add_u32 s54, s54, s62
    ds_read_b64_tr_b16 v[66:67], v3 offset:19456
    ds_read_b128 v[68:71], v1 offset:17408
    v_mfma_f32_32x32x16_bf16 v[80:95], v[32:35], v[36:39], v[80:95]
    s_add_u32 m0, s61, 0
    ds_read_b128 v[72:75], v1 offset:18432
    ds_read_b128 v[76:79], v1 offset:19456
    buffer_load_dwordx4 v7, s[48:51], s55 offen offset:0 sc1 lds
    v_mfma_f32_32x32x16_bf16 v[96:111], v[32:35], v[40:43], v[96:111]
    s_mov_b32 exec_hi, 0
    buffer_load_dwordx4 v7, s[48:51], s55 offen offset:1024 sc1 lds
    s_mov_b32 exec_hi, -1
    s_add_u32 s55, s55, s63
    v_mfma_f32_32x32x16_bf16 v[112:127], v[32:35], v[44:47], v[112:127]
    s_waitcnt vmcnt(12) lgkmcnt(0)
    s_barrier
    v_mfma_f32_32x32x16_bf16 v[80:95], v[48:51], v[52:55], v[80:95]
    s_add_u32 m0, s60, 14336
    ds_read_b64_tr_b16 v[16:17], v3 offset:28672
    ds_read_b64_tr_b16 v[18:19], v3 offset:29696
    ds_read_b128 v[20:23], v1 offset:28672
    buffer_load_dwordx4 v5, s[40:43], s54 offen lds
    v_mfma_f32_32x32x16_bf16 v[96:111], v[48:51], v[56:59], v[96:111]
    s_add_u32 m0, s60, 15360
    ds_read_b128 v[24:27], v1 offset:29696
    ds_read_b128 v[28:31], v1 offset:30720
    ds_read_b64_tr_b16 v[32:33], v3 offset:32768
    v_mfma_f32_32x32x16_bf16 v[112:127], v[48:51], v[60:63], v[112:127]
    buffer_load_dwordx4 v6, s[40:43], s54 offen lds
    s_add_u32 s54, s54, s62
    ds_read_b64_tr_b16 v[34:35], v3 offset:33792
    ds_read_b128 v[36:39], v1 offset:31744
    v_mfma_f32_32x32x16_bf16 v[80:95], v[64:67], v[68:71], v[80:95]
    s_add_u32 m0, s61, 14336
    ds_read_b128 v[40:43], v1 offset:32768
    ds_read_b128 v[44:47], v1 offset:33792
    buffer_load_dwordx4 v7, s[48:51], s55 offen offset:0 sc1 lds
    v_mfma_f32_32x32x16_bf16 v[96:111], v[64:67], v[72:75], v[96:111]
    s_mov_b32 exec_hi, 0
    buffer_load_dwordx4 v7, s[48:51], s55 offen offset:1024 sc1 lds
    s_mov_b32 exec_hi, -1
    s_add_u32 s55, s55, s63
    v_mfma_f32_32x32x16_bf16 v[112:127], v[64:67], v[76:79], v[112:127]
    s_waitcnt vmcnt(12) lgkmcnt(0)
    s_barrier
    v_mfma_f32_32x32x16_bf16 v[80:95], v[16:19], v[20:23], v[80:95]
    s_add_u32 m0, s60, 28672
    ds_read_b64_tr_b16 v[48:49], v4 offset:0
    ds_read_b64_tr_b16 v[50:51], v4 offset:1024
    ds_read_b128 v[52:55], v2 offset:0
    buffer_load_dwordx4 v5, s[40:43], s54 offen lds
    v_mfma_f32_32x32x16_bf16 v[96:111], v[16:19], v[24:27], v[96:111]
    s_add_u32 m0, s60, 29696
    ds_read_b128 v[56:59], v2 offset:1024
    ds_read_b128 v[60:63], v2 offset:2048
    ds_read_b64_tr_b16 v[64:65], v4 offset:4096
    v_mfma_f32_32x32x16_bf16 v[112:127], v[16:19], v[28:31], v[112:127]
    buffer_load_dwordx4 v6, s[40:43], s54 offen lds
    s_add_u32 s54, s54, s62
    ds_read_b64_tr_b16 v[66:67], v4 offset:5120
    ds_read_b128 v[68:71], v2 offset:3072
    v_mfma_f32_32x32x16_bf16 v[80:95], v[32:35], v[36:39], v[80:95]
    s_add_u32 m0, s61, 28672
    ds_read_b128 v[72:75], v2 offset:4096
    ds_read_b128 v[76:79], v2 offset:5120
    buffer_load_dwordx4 v7, s[48:51], s55 offen offset:0 sc1 lds
    v_mfma_f32_32x32x16_bf16 v[96:111], v[32:35], v[40:43], v[96:111]
    s_mov_b32 exec_hi, 0
    buffer_load_dwordx4 v7, s[48:51], s55 offen offset:1024 sc1 lds
    s_mov_b32 exec_hi, -1
    s_add_u32 s55, s55, s63
    v_mfma_f32_32x32x16_bf16 v[112:127], v[32:35], v[44:47], v[112:127]
    s_waitcnt vmcnt(12) lgkmcnt(0)
    s_barrier
    v_mfma_f32_32x32x16_bf16 v[80:95], v[48:51], v[52:55], v[80:95]
    s_add_u32 m0, s60, 43008
    ds_read_b64_tr_b16 v[16:17], v4 offset:14336
    ds_read_b64_tr_b16 v[18:19], v4 offset:15360
    ds_read_b128 v[20:23], v2 offset:14336
    buffer_load_dwordx4 v5, s[40:43], s54 offen lds
    v_mfma_f32_32x32x16_bf16 v[96:111], v[48:51], v[56:59], v[96:111]
    s_add_u32 m0, s60, 44032
    ds_read_b128 v[24:27], v2 offset:15360
    ds_read_b128 v[28:31], v2 offset:16384
    ds_read_b64_tr_b16 v[32:33], v4 offset:18432
    v_mfma_f32_32x32x16_bf16 v[112:127], v[48:51], v[60:63], v[112:127]
    buffer_load_dwordx4 v6, s[40:43], s54 offen lds
    s_add_u32 s54, s54, s62
    ds_read_b64_tr_b16 v[34:35], v4 offset:19456
    ds_read_b128 v[36:39], v2 offset:17408
    v_mfma_f32_32x32x16_bf16 v[80:95], v[64:67], v[68:71], v[80:95]
    s_add_u32 m0, s61, 43008
    ds_read_b128 v[40:43], v2 offset:18432
    ds_read_b128 v[44:47], v2 offset:19456
    buffer_load_dwordx4 v7, s[48:51], s55 offen offset:0 sc1 lds
    v_mfma_f32_32x32x16_bf16 v[96:111], v[64:67], v[72:75], v[96:111]
    s_mov_b32 exec_hi, 0
    buffer_load_dwordx4 v7, s[48:51], s55 offen offset:1024 sc1 lds
    s_mov_b32 exec_hi, -1
    s_add_u32 s55, s55, s63
    v_mfma_f32_32x32x16_bf16 v[112:127], v[64:67], v[76:79], v[112:127]
    s_sub_u32 s58, s58, 1
    s_cmp_lg_u32 s58, 0
    s_cbranch_scc1 L_mlp1_loop
    s_waitcnt vmcnt(12) lgkmcnt(0)
    s_barrier
    v_mfma_f32_32x32x16_bf16 v[80:95], v[16:19], v[20:23], v[80:95]
    s_add_u32 m0, s60, 57344
    ds_read_b64_tr_b16 v[48:49], v3 offset:0
    ds_read_b64_tr_b16 v[50:51], v3 offset:1024
    ds_read_b128 v[52:55], v1 offset:0
    buffer_load_dwordx4 v5, s[40:43], s54 offen lds
    v_mfma_f32_32x32x16_bf16 v[96:111], v[16:19], v[24:27], v[96:111]
    s_add_u32 m0, s60, 58368
    ds_read_b128 v[56:59], v1 offset:1024
    ds_read_b128 v[60:63], v1 offset:2048
    ds_read_b64_tr_b16 v[64:65], v3 offset:4096
    v_mfma_f32_32x32x16_bf16 v[112:127], v[16:19], v[28:31], v[112:127]
    buffer_load_dwordx4 v6, s[40:43], s54 offen lds
    s_add_u32 s54, s54, s62
    ds_read_b64_tr_b16 v[66:67], v3 offset:5120
    ds_read_b128 v[68:71], v1 offset:3072
    v_mfma_f32_32x32x16_bf16 v[80:95], v[32:35], v[36:39], v[80:95]
    s_add_u32 m0, s61, 57344
    ds_read_b128 v[72:75], v1 offset:4096
    ds_read_b128 v[76:79], v1 offset:5120
    buffer_load_dwordx4 v7, s[48:51], s55 offen offset:0 sc1 lds
    v_mfma_f32_32x32x16_bf16 v[96:111], v[32:35], v[40:43], v[96:111]
    s_mov_b32 exec_hi, 0
    buffer_load_dwordx4 v7, s[48:51], s55 offen offset:1024 sc1 lds
    s_mov_b32 exec_hi, -1
    s_add_u32 s55, s55, s63
    v_mfma_f32_32x32x16_bf16 v[112:127], v[32:35], v[44:47], v[112:127]
    s_waitcnt vmcnt(12) lgkmcnt(0)
    s_barrier
    v_mfma_f32_32x32x16_bf16 v[80:95], v[48:51], v[52:55], v[80:95]
    s_add_u32 m0, s60, 0
    ds_read_b64_tr_b16 v[16:17], v3 offset:14336
    ds_read_b64_tr_b16 v[18:19], v3 offset:15360
    ds_read_b128 v[20:23], v1 offset:14336
    buffer_load_dwordx4 v5, s[40:43], s54 offen lds
    v_mfma_f32_32x32x16_bf16 v[96:111], v[48:51], v[56:59], v[96:111]
    s_add_u32 m0, s60, 1024
    ds_read_b128 v[24:27], v1 offset:15360
    ds_read_b128 v[28:31], v1 offset:16384
    ds_read_b64_tr_b16 v[32:33], v3 offset:18432
    v_mfma_f32_32x32x16_bf16 v[112:127], v[48:51], v[60:63], v[112:127]
    buffer_load_dwordx4 v6, s[40:43], s54 offen lds
    s_add_u32 s54, s54, s62
    ds_read_b64_tr_b16 v[34:35], v3 offset:19456
    ds_read_b128 v[36:39], v1 offset:17408
    v_mfma_f32_32x32x16_bf16 v[80:95], v[64:67], v[68:71], v[80:95]
    s_add_u32 m0, s61, 0
    ds_read_b128 v[40:43], v1 offset:18432
    ds_read_b128 v[44:47], v1 offset:19456
    buffer_load_dwordx4 v7, s[48:51], s55 offen offset:0 sc1 lds
    v_mfma_f32_32x32x16_bf16 v[96:111], v[64:67], v[72:75], v[96:111]
    s_mov_b32 exec_hi, 0
    buffer_load_dwordx4 v7, s[48:51], s55 offen offset:1024 sc1 lds
    s_mov_b32 exec_hi, -1
    s_add_u32 s55, s55, s63
    v_mfma_f32_32x32x16_bf16 v[112:127], v[64:67], v[76:79], v[112:127]
    s_waitcnt vmcnt(12) lgkmcnt(0)
    s_barrier
    v_mfma_f32_32x32x16_bf16 v[80:95], v[16:19], v[20:23], v[80:95]
    s_add_u32 m0, s60, 14336
    ds_read_b64_tr_b16 v[48:49], v3 offset:28672
    ds_read_b64_tr_b16 v[50:51], v3 offset:29696
    ds_read_b128 v[52:55], v1 offset:28672
    buffer_load_dwordx4 v5, s[40:43], s54 offen lds
    v_mfma_f32_32x32x16_bf16 v[96:111], v[16:19], v[24:27], v[96:111]
    s_add_u32 m0, s60, 15360
    ds_read_b128 v[56:59], v1 offset:29696
    ds_read_b128 v[60:63], v1 offset:30720
    ds_read_b64_tr_b16 v[64:65], v3 offset:32768
    v_mfma_f32_32x32x16_bf16 v[112:127], v[16:19], v[28:31], v[112:127]
    buffer_load_dwordx4 v6, s[40:43], s54 offen lds
    s_add_u32 s54, s54, s62
    ds_read_b64_tr_b16 v[66:67], v3 offset:33792
    ds_read_b128 v[68:71], v1 offset:31744
    v_mfma_f32_32x32x16_bf16 v[80:95], v[32:35], v[36:39], v[80:95]
    s_add_u32 m0, s61, 14336
    ds_read_b128 v[72:75], v1 offset:32768
    ds_read_b128 v[76:79], v1 offset:33792
    buffer_load_dwordx4 v7, s[48:51], s55 offen offset:0 sc1 lds
    v_mfma_f32_32x32x16_bf16 v[96:111], v[32:35], v[40:43], v[96:111]
    s_mov_b32 exec_hi, 0
    buffer_load_dwordx4 v7, s[48:51], s55 offen offset:1024 sc1 lds
    s_mov_b32 exec_hi, -1
    s_add_u32 s55, s55, s63
    v_mfma_f32_32x32x16_bf16 v[112:127], v[32:35], v[44:47], v[112:127]
    s_waitcnt vmcnt(12) lgkmcnt(0)
    s_barrier
    v_mfma_f32_32x32x16_bf16 v[80:95], v[48:51], v[52:55], v[80:95]
    s_add_u32 m0, s60, 28672
    ds_read_b64_tr_b16 v[16:17], v4 offset:0
    ds_read_b64_tr_b16 v[18:19], v4 offset:1024
    ds_read_b128 v[20:23], v2 offset:0
    buffer_load_dwordx4 v5, s[40:43], s54 offen lds
    v_mfma_f32_32x32x16_bf16 v[96:111], v[48:51], v[56:59], v[96:111]
    s_add_u32 m0, s60, 29696
    ds_read_b128 v[24:27], v2 offset:1024
    ds_read_b128 v[28:31], v2 offset:2048
    ds_read_b64_tr_b16 v[32:33], v4 offset:4096
    v_mfma_f32_32x32x16_bf16 v[112:127], v[48:51], v[60:63], v[112:127]
    buffer_load_dwordx4 v6, s[40:43], s54 offen lds
    s_add_u32 s54, s54, s62
    ds_read_b64_tr_b16 v[34:35], v4 offset:5120
    ds_read_b128 v[36:39], v2 offset:3072
    v_mfma_f32_32x32x16_bf16 v[80:95], v[64:67], v[68:71], v[80:95]
    s_add_u32 m0, s61, 28672
    ds_read_b128 v[40:43], v2 offset:4096
    ds_read_b128 v[44:47], v2 offset:5120
    buffer_load_dwordx4 v7, s[48:51], s55 offen offset:0 sc1 lds
    v_mfma_f32_32x32x16_bf16 v[96:111], v[64:67], v[72:75], v[96:111]
    s_mov_b32 exec_hi, 0
    buffer_load_dwordx4 v7, s[48:51], s55 offen offset:1024 sc1 lds
    s_mov_b32 exec_hi, -1
    s_add_u32 s55, s55, s63
    v_mfma_f32_32x32x16_bf16 v[112:127], v[64:67], v[76:79], v[112:127]
    s_waitcnt vmcnt(12) lgkmcnt(0)
    s_barrier
    v_mfma_f32_32x32x16_bf16 v[80:95], v[16:19], v[20:23], v[80:95]
    s_add_u32 m0, s60, 43008
    ds_read_b64_tr_b16 v[48:49], v4 offset:14336
    ds_read_b64_tr_b16 v[50:51], v4 offset:15360
    ds_read_b128 v[52:55], v2 offset:14336
    buffer_load_dwordx4 v5, s[40:43], s54 offen lds
    v_mfma_f32_32x32x16_bf16 v[96:111], v[16:19], v[24:27], v[96:111]
    s_add_u32 m0, s60, 44032
    ds_read_b128 v[56:59], v2 offset:15360
    ds_read_b128 v[60:63], v2 offset:16384
    ds_read_b64_tr_b16 v[64:65], v4 offset:18432
    v_mfma_f32_32x32x16_bf16 v[112:127], v[16:19], v[28:31], v[112:127]
    buffer_load_dwordx4 v6, s[40:43], s54 offen lds
    s_add_u32 s54, s54, s62
    ds_read_b64_tr_b16 v[66:67], v4 offset:19456
    ds_read_b128 v[68:71], v2 offset:17408
    v_mfma_f32_32x32x16_bf16 v[80:95], v[32:35], v[36:39], v[80:95]
    s_add_u32 m0, s61, 43008
    ds_read_b128 v[72:75], v2 offset:18432
    ds_read_b128 v[76:79], v2 offset:19456
    buffer_load_dwordx4 v7, s[48:51], s55 offen offset:0 sc1 lds
    v_mfma_f32_32x32x16_bf16 v[96:111], v[32:35], v[40:43], v[96:111]
    s_mov_b32 exec_hi, 0
    buffer_load_dwordx4 v7, s[48:51], s55 offen offset:1024 sc1 lds
    s_mov_b32 exec_hi, -1
    s_add_u32 s55, s55, s63
    v_mfma_f32_32x32x16_bf16 v[112:127], v[32:35], v[44:47], v[112:127]
    s_waitcnt vmcnt(12) lgkmcnt(0)
    s_barrier
    v_mfma_f32_32x32x16_bf16 v[80:95], v[48:51], v[52:55], v[80:95]
    ds_read_b64_tr_b16 v[16:17], v3 offset:0
    ds_read_b64_tr_b16 v[18:19], v3 offset:1024
    ds_read_b128 v[20:23], v1 offset:0
    v_mfma_f32_32x32x16_bf16 v[96:111], v[48:51], v[56:59], v[96:111]
    ds_read_b128 v[24:27], v1 offset:1024
    ds_read_b128 v[28:31], v1 offset:2048
    ds_read_b64_tr_b16 v[32:33], v3 offset:4096
    v_mfma_f32_32x32x16_bf16 v[112:127], v[48:51], v[60:63], v[112:127]
    ds_read_b64_tr_b16 v[34:35], v3 offset:5120
    ds_read_b128 v[36:39], v1 offset:3072
    v_mfma_f32_32x32x16_bf16 v[80:95], v[64:67], v[68:71], v[80:95]
    ds_read_b128 v[40:43], v1 offset:4096
    ds_read_b128 v[44:47], v1 offset:5120
    v_mfma_f32_32x32x16_bf16 v[96:111], v[64:67], v[72:75], v[96:111]
    v_mfma_f32_32x32x16_bf16 v[112:127], v[64:67], v[76:79], v[112:127]
    s_waitcnt vmcnt(8) lgkmcnt(0)
    s_barrier
    v_mfma_f32_32x32x16_bf16 v[80:95], v[16:19], v[20:23], v[80:95]
    ds_read_b64_tr_b16 v[48:49], v3 offset:14336
    ds_read_b64_tr_b16 v[50:51], v3 offset:15360
    ds_read_b128 v[52:55], v1 offset:14336
    v_mfma_f32_32x32x16_bf16 v[96:111], v[16:19], v[24:27], v[96:111]
    ds_read_b128 v[56:59], v1 offset:15360
    ds_read_b128 v[60:63], v1 offset:16384
    ds_read_b64_tr_b16 v[64:65], v3 offset:18432
    v_mfma_f32_32x32x16_bf16 v[112:127], v[16:19], v[28:31], v[112:127]
    ds_read_b64_tr_b16 v[66:67], v3 offset:19456
    ds_read_b128 v[68:71], v1 offset:17408
    v_mfma_f32_32x32x16_bf16 v[80:95], v[32:35], v[36:39], v[80:95]
    ds_read_b128 v[72:75], v1 offset:18432
    ds_read_b128 v[76:79], v1 offset:19456
    v_mfma_f32_32x32x16_bf16 v[96:111], v[32:35], v[40:43], v[96:111]
    v_mfma_f32_32x32x16_bf16 v[112:127], v[32:35], v[44:47], v[112:127]
    s_waitcnt vmcnt(4) lgkmcnt(0)
    s_barrier
    v_mfma_f32_32x32x16_bf16 v[80:95], v[48:51], v[52:55], v[80:95]
    ds_read_b64_tr_b16 v[16:17], v3 offset:28672
    ds_read_b64_tr_b16 v[18:19], v3 offset:29696
    ds_read_b128 v[20:23], v1 offset:28672
    v_mfma_f32_32x32x16_bf16 v[96:111], v[48:51], v[56:59], v[96:111]
    ds_read_b128 v[24:27], v1 offset:29696
    ds_read_b128 v[28:31], v1 offset:30720
    ds_read_b64_tr_b16 v[32:33], v3 offset:32768
    v_mfma_f32_32x32x16_bf16 v[112:127], v[48:51], v[60:63], v[112:127]
    ds_read_b64_tr_b16 v[34:35], v3 offset:33792
    ds_read_b128 v[36:39], v1 offset:31744
    v_mfma_f32_32x32x16_bf16 v[80:95], v[64:67], v[68:71], v[80:95]
    ds_read_b128 v[40:43], v1 offset:32768
    ds_read_b128 v[44:47], v1 offset:33792
    v_mfma_f32_32x32x16_bf16 v[96:111], v[64:67], v[72:75], v[96:111]
    v_mfma_f32_32x32x16_bf16 v[112:127], v[64:67], v[76:79], v[112:127]
    s_waitcnt vmcnt(0) lgkmcnt(0)
    s_barrier
    v_mfma_f32_32x32x16_bf16 v[80:95], v[16:19], v[20:23], v[80:95]
    ds_read_b64_tr_b16 v[48:49], v4 offset:0
    ds_read_b64_tr_b16 v[50:51], v4 offset:1024
    ds_read_b128 v[52:55], v2 offset:0
    v_mfma_f32_32x32x16_bf16 v[96:111], v[16:19], v[24:27], v[96:111]
    ds_read_b128 v[56:59], v2 offset:1024
    ds_read_b128 v[60:63], v2 offset:2048
    ds_read_b64_tr_b16 v[64:65], v4 offset:4096
    v_mfma_f32_32x32x16_bf16 v[112:127], v[16:19], v[28:31], v[112:127]
    ds_read_b64_tr_b16 v[66:67], v4 offset:5120
    ds_read_b128 v[68:71], v2 offset:3072
    v_mfma_f32_32x32x16_bf16 v[80:95], v[32:35], v[36:39], v[80:95]
    ds_read_b128 v[72:75], v2 offset:4096
    ds_read_b128 v[76:79], v2 offset:5120
    v_mfma_f32_32x32x16_bf16 v[96:111], v[32:35], v[40:43], v[96:111]
    v_mfma_f32_32x32x16_bf16 v[112:127], v[32:35], v[44:47], v[112:127]
    s_waitcnt lgkmcnt(0)
    v_mfma_f32_32x32x16_bf16 v[80:95], v[48:51], v[52:55], v[80:95]
    v_mfma_f32_32x32x16_bf16 v[96:111], v[48:51], v[56:59], v[96:111]
    v_mfma_f32_32x32x16_bf16 v[112:127], v[48:51], v[60:63], v[112:127]
    v_mfma_f32_32x32x16_bf16 v[80:95], v[64:67], v[68:71], v[80:95]
    v_mfma_f32_32x32x16_bf16 v[96:111], v[64:67], v[72:75], v[96:111]
    v_mfma_f32_32x32x16_bf16 v[112:127], v[64:67], v[76:79], v[112:127]
    s_setprio 2
    v_mov_b32 v12, 3184710632
    v_mov_b32 v13, 3222493025
    s_mul_i32 s16, s69, 36864
    s_mul_i32 s17, s67, 3072
    s_add_u32 s16, s16, s17
    s_add_u32 s16, s16, 2359296
    s_add_u32 s17, s16, 18432
    s_mul_i32 s18, s66, 565
    s_lshr_b32 s18, s18, 12
    s_lshr_b32 s19, s67, 1
    s_mul_i32 s19, s19, 5
    s_add_u32 s18, s18, s19
    s_lshl_b32 s18, s18, 12
    s_add_u32 s18, s18, 29605888
    s_lshr_b32 s19, 0x204080, s66
    s_cmp_lt_u32 s66, 32
    s_cselect_b32 s19, s19, 0
    s_and_b32 s19, s19, 1
    s_cselect_b32 s19, -1, 0xffff
    s_barrier
    s_mov_b32 s40, s28
    s_mov_b32 s41, s29
    s_mov_b32 s42, 18874368
    s_mov_b32 s43, 0x00020000
    s_mov_b32 s44, s38
    s_mov_b32 s45, s39
    s_mov_b32 s46, 268435456
    s_mov_b32 s47, 0x00020000
    s_lshr_b32 s67, s3, 3
    s_and_b32 s68, s3, 7
    s_mul_i32 s68, s68, 30
    s_add_u32 s67, s67, s68
    s_mul_i32 s66, s67, 171
    s_lshr_b32 s66, s66, 9
    s_mul_i32 s68, s66, 3
    s_sub_u32 s67, s67, s68
    s_lshr_b32 s69, s66, 4
    s_and_b32 s66, s66, 15
    s_lshl_b32 s70, s69, 2
    s_lshr_b32 s53, 275268, s70
    s_and_b32 s53, s53, 15
    s_lshr_b32 s65, 964672, s70
    s_and_b32 s65, s65, 15
    s_and_b32 s71, s52, 1
    s_lshr_b32 s72, s52, 1
    s_lshl_b32 s56, s66, 8
    s_lshl_b32 s70, s52, 15
    s_add_u32 s56, s56, s70
    s_mul_i32 s57, s67, 6144
    s_mul_i32 s70, s72, 18432
    s_add_u32 s57, s57, s70
    s_mul_i32 s70, s71, 3072
    s_add_u32 s57, s57, s70
    s_mul_i32 s54, s69, 3801088
    s_add_u32 s54, s54, s56
    s_mul_i32 s55, s69, 1069056
    s_add_u32 s55, s55, s57
    s_add_u32 s55, s55, 2359296
    s_lshl_b32 s60, s52, 11
    s_mul_i32 s61, s52, 3072
    s_add_u32 s61, s61, 8192
    s_mov_b32 s62, 131072
    s_mov_b32 s63, 36864
    v_lshrrev_b32 v8, 4, v0
    v_and_b32 v9, 3, v0
    v_lshlrev_b32 v9, 4, v9
    v_lshl_add_u32 v8, v8, 6, v9
    v_bfe_u32 v9, v0, 2, 2
    v_lshl_add_u32 v5, v9, 12, v8
    v_add_u32 v6, 16384, v5
    v_lshlrev_b32 v7, 4, v0
    s_add_u32 m0, s60, 0
    s_nop 0
    buffer_load_dwordx4 v5, s[40:43], s54 offen sc1 lds
    s_add_u32 m0, s60, 1024
    s_nop 0
    buffer_load_dwordx4 v6, s[40:43], s54 offen sc1 lds
    s_add_u32 s54, s54, s62
    s_add_u32 m0, s60, 20480
    s_nop 0
    buffer_load_dwordx4 v5, s[40:43], s54 offen sc1 lds
    s_add_u32 m0, s60, 21504
    s_nop 0
    buffer_load_dwordx4 v6, s[40:43], s54 offen sc1 lds
    s_add_u32 s54, s54, s62
    s_add_u32 m0, s60, 40960
    s_nop 0
    buffer_load_dwordx4 v5, s[40:43], s54 offen sc1 lds
    s_add_u32 m0, s60, 41984
    s_nop 0
    buffer_load_dwordx4 v6, s[40:43], s54 offen sc1 lds
    s_add_u32 s54, s54, s62
    s_add_u32 m0, s60, 61440
    s_nop 0
    buffer_load_dwordx4 v5, s[40:43], s54 offen sc1 lds
    s_add_u32 m0, s60, 62464
    s_nop 0
    buffer_load_dwordx4 v6, s[40:43], s54 offen sc1 lds
    s_add_u32 s54, s54, s62
    v_lshrrev_b32 v8, 5, v0
    v_lshlrev_b32 v8, 10, v8
    v_lshl_add_u32 v8, v9, 6, v8
    v_bfe_u32 v9, v0, 4, 1
    v_lshl_add_u32 v8, v9, 5, v8
    v_and_b32 v9, 3, v0
    v_lshl_add_u32 v8, v9, 3, v8
    s_lshl_b32 s70, s72, 9
    v_add_u32 v3, s70, v8
    v_add_u32 v4, 40960, v3
    s_mul_i32 s70, s71, 3072
    s_add_u32 s70, s70, 8192
    v_add_u32 v1, s70, v7
    v_add_u32 v2, 40960, v1
    s_nop 3
    v_mul_f32 v16, v80, v80
    v_mul_f32 v17, v81, v81
    v_mul_f32 v18, v82, v82
    v_mul_f32 v19, v83, v83
    v_mul_f32 v20, v84, v84
    v_mul_f32 v21, v85, v85
    v_mul_f32 v22, v86, v86
    v_mul_f32 v23, v87, v87
    v_mul_f32 v24, v88, v88
    v_mul_f32 v25, v89, v89
    v_mul_f32 v26, v90, v90
    v_mul_f32 v27, v91, v91
    v_mul_f32 v28, v92, v92
    v_mul_f32 v29, v93, v93
    v_mul_f32 v30, v94, v94
    v_mul_f32 v31, v95, v95
    v_fma_f32 v16, v16, v12, v13
    v_fma_f32 v17, v17, v12, v13
    v_fma_f32 v18, v18, v12, v13
    v_fma_f32 v19, v19, v12, v13
    v_fma_f32 v20, v20, v12, v13
    v_fma_f32 v21, v21, v12, v13
    v_fma_f32 v22, v22, v12, v13
    v_fma_f32 v23, v23, v12, v13
    v_fma_f32 v24, v24, v12, v13
    v_fma_f32 v25, v25, v12, v13
    v_fma_f32 v26, v26, v12, v13
    v_fma_f32 v27, v27, v12, v13
    v_fma_f32 v28, v28, v12, v13
    v_fma_f32 v29, v29, v12, v13
    v_fma_f32 v30, v30, v12, v13
    v_fma_f32 v31, v31, v12, v13
    v_mul_f32 v16, v16, v80
    v_mul_f32 v17, v17, v81
    v_mul_f32 v18, v18, v82
    v_mul_f32 v19, v19, v83
    v_mul_f32 v20, v20, v84
    v_mul_f32 v21, v21, v85
    v_mul_f32 v22, v22, v86
    v_mul_f32 v23, v23, v87
    v_mul_f32 v24, v24, v88
    v_mul_f32 v25, v25, v89
    v_mul_f32 v26, v26, v90
    v_mul_f32 v27, v27, v91
    v_mul_f32 v28, v28, v92
    v_mul_f32 v29, v29, v93
    v_mul_f32 v30, v30, v94
    v_mul_f32 v31, v31, v95
    v_exp_f32 v16, v16
    v_exp_f32 v17, v17
    v_exp_f32 v18, v18
    v_exp_f32 v19, v19
    v_exp_f32 v20, v20
    v_exp_f32 v21, v21
    v_exp_f32 v22, v22
    v_exp_f32 v23, v23
    v_exp_f32 v24, v24
    v_exp_f32 v25, v25
    v_exp_f32 v26, v26
    v_exp_f32 v27, v27
    v_exp_f32 v28, v28
    v_exp_f32 v29, v29
    v_exp_f32 v30, v30
    v_exp_f32 v31, v31
    v_add_f32 v16, 1.0, v16
    v_add_f32 v17, 1.0, v17
    v_add_f32 v18, 1.0, v18
    v_add_f32 v19, 1.0, v19
    v_add_f32 v20, 1.0, v20
    v_add_f32 v21, 1.0, v21
    v_add_f32 v22, 1.0, v22
    v_add_f32 v23, 1.0, v23
    v_add_f32 v24, 1.0, v24
    v_add_f32 v25, 1.0, v25
    v_add_f32 v26, 1.0, v26
    v_add_f32 v27, 1.0, v27
    v_add_f32 v28, 1.0, v28
    v_add_f32 v29, 1.0, v29
    v_add_f32 v30, 1.0, v30
    v_add_f32 v31, 1.0, v31
    v_rcp_f32 v16, v16
    v_rcp_f32 v17, v17
    v_rcp_f32 v18, v18
    v_rcp_f32 v19, v19
    v_rcp_f32 v20, v20
    v_rcp_f32 v21, v21
    v_rcp_f32 v22, v22
    v_rcp_f32 v23, v23
    v_rcp_f32 v24, v24
    v_rcp_f32 v25, v25
    v_rcp_f32 v26, v26
    v_rcp_f32 v27, v27
    v_rcp_f32 v28, v28
    v_rcp_f32 v29, v29
    v_rcp_f32 v30, v30
    v_rcp_f32 v31, v31
    v_mul_f32 v80, v80, v16
    v_mul_f32 v81, v81, v17
    v_mul_f32 v82, v82, v18
    v_mul_f32 v83, v83, v19
    v_mul_f32 v84, v84, v20
    v_mul_f32 v85, v85, v21
    v_mul_f32 v86, v86, v22
    v_mul_f32 v87, v87, v23
    v_mul_f32 v88, v88, v24
    v_mul_f32 v89, v89, v25
    v_mul_f32 v90, v90, v26
    v_mul_f32 v91, v91, v27
    v_mul_f32 v92, v92, v28
    v_mul_f32 v93, v93, v29
    v_mul_f32 v94, v94, v30
    v_mul_f32 v95, v95, v31
    v_cvt_pk_bf16_f32 v80, v80, v81
    v_cvt_pk_bf16_f32 v81, v82, v83
    v_cvt_pk_bf16_f32 v82, v84, v85
    v_cvt_pk_bf16_f32 v83, v86, v87
    v_cvt_pk_bf16_f32 v84, v88, v89
    v_cvt_pk_bf16_f32 v85, v90, v91
    v_cvt_pk_bf16_f32 v86, v92, v93
    v_cvt_pk_bf16_f32 v87, v94, v95
    buffer_store_dwordx4 v[80:83], v7, s[48:51], s16 offen offset:0 sc1
    buffer_store_dwordx4 v[84:87], v7, s[48:51], s17 offen offset:0 sc1
    v_mul_f32 v16, v96, v96
    v_mul_f32 v17, v97, v97
    v_mul_f32 v18, v98, v98
    v_mul_f32 v19, v99, v99
    v_mul_f32 v20, v100, v100
    v_mul_f32 v21, v101, v101
    v_mul_f32 v22, v102, v102
    v_mul_f32 v23, v103, v103
    v_mul_f32 v24, v104, v104
    v_mul_f32 v25, v105, v105
    v_mul_f32 v26, v106, v106
    v_mul_f32 v27, v107, v107
    v_mul_f32 v28, v108, v108
    v_mul_f32 v29, v109, v109
    v_mul_f32 v30, v110, v110
    v_mul_f32 v31, v111, v111
    v_fma_f32 v16, v16, v12, v13
    v_fma_f32 v17, v17, v12, v13
    v_fma_f32 v18, v18, v12, v13
    v_fma_f32 v19, v19, v12, v13
    v_fma_f32 v20, v20, v12, v13
    v_fma_f32 v21, v21, v12, v13
    v_fma_f32 v22, v22, v12, v13
    v_fma_f32 v23, v23, v12, v13
    v_fma_f32 v24, v24, v12, v13
    v_fma_f32 v25, v25, v12, v13
    v_fma_f32 v26, v26, v12, v13
    v_fma_f32 v27, v27, v12, v13
    v_fma_f32 v28, v28, v12, v13
    v_fma_f32 v29, v29, v12, v13
    v_fma_f32 v30, v30, v12, v13
    v_fma_f32 v31, v31, v12, v13
    v_mul_f32 v16, v16, v96
    v_mul_f32 v17, v17, v97
    v_mul_f32 v18, v18, v98
    v_mul_f32 v19, v19, v99
    v_mul_f32 v20, v20, v100
    v_mul_f32 v21, v21, v101
    v_mul_f32 v22, v22, v102
    v_mul_f32 v23, v23, v103
    v_mul_f32 v24, v24, v104
    v_mul_f32 v25, v25, v105
    v_mul_f32 v26, v26, v106
    v_mul_f32 v27, v27, v107
    v_mul_f32 v28, v28, v108
    v_mul_f32 v29, v29, v109
    v_mul_f32 v30, v30, v110
    v_mul_f32 v31, v31, v111
    v_exp_f32 v16, v16
    v_exp_f32 v17, v17
    v_exp_f32 v18, v18
    v_exp_f32 v19, v19
    v_exp_f32 v20, v20
    v_exp_f32 v21, v21
    v_exp_f32 v22, v22
    v_exp_f32 v23, v23
    v_exp_f32 v24, v24
    v_exp_f32 v25, v25
    v_exp_f32 v26, v26
    v_exp_f32 v27, v27
    v_exp_f32 v28, v28
    v_exp_f32 v29, v29
    v_exp_f32 v30, v30
    v_exp_f32 v31, v31
    v_add_f32 v16, 1.0, v16
    v_add_f32 v17, 1.0, v17
    v_add_f32 v18, 1.0, v18
    v_add_f32 v19, 1.0, v19
    v_add_f32 v20, 1.0, v20
    v_add_f32 v21, 1.0, v21
    v_add_f32 v22, 1.0, v22
    v_add_f32 v23, 1.0, v23
    v_add_f32 v24, 1.0, v24
    v_add_f32 v25, 1.0, v25
    v_add_f32 v26, 1.0, v26
    v_add_f32 v27, 1.0, v27
    v_add_f32 v28, 1.0, v28
    v_add_f32 v29, 1.0, v29
    v_add_f32 v30, 1.0, v30
    v_add_f32 v31, 1.0, v31
    v_rcp_f32 v16, v16
    v_rcp_f32 v17, v17
    v_rcp_f32 v18, v18
    v_rcp_f32 v19, v19
    v_rcp_f32 v20, v20
    v_rcp_f32 v21, v21
    v_rcp_f32 v22, v22
    v_rcp_f32 v23, v23
    v_rcp_f32 v24, v24
    v_rcp_f32 v25, v25
    v_rcp_f32 v26, v26
    v_rcp_f32 v27, v27
    v_rcp_f32 v28, v28
    v_rcp_f32 v29, v29
    v_rcp_f32 v30, v30
    v_rcp_f32 v31, v31
    v_mul_f32 v96, v96, v16
    v_mul_f32 v97, v97, v17
    v_mul_f32 v98, v98, v18
    v_mul_f32 v99, v99, v19
    v_mul_f32 v100, v100, v20
    v_mul_f32 v101, v101, v21
    v_mul_f32 v102, v102, v22
    v_mul_f32 v103, v103, v23
    v_mul_f32 v104, v104, v24
    v_mul_f32 v105, v105, v25
    v_mul_f32 v106, v106, v26
    v_mul_f32 v107, v107, v27
    v_mul_f32 v108, v108, v28
    v_mul_f32 v109, v109, v29
    v_mul_f32 v110, v110, v30
    v_mul_f32 v111, v111, v31
    v_cvt_pk_bf16_f32 v96, v96, v97
    v_cvt_pk_bf16_f32 v97, v98, v99
    v_cvt_pk_bf16_f32 v98, v100, v101
    v_cvt_pk_bf16_f32 v99, v102, v103
    v_cvt_pk_bf16_f32 v100, v104, v105
    v_cvt_pk_bf16_f32 v101, v106, v107
    v_cvt_pk_bf16_f32 v102, v108, v109
    v_cvt_pk_bf16_f32 v103, v110, v111
    buffer_store_dwordx4 v[96:99], v7, s[48:51], s16 offen offset:1024 sc1
    buffer_store_dwordx4 v[100:103], v7, s[48:51], s17 offen offset:1024 sc1
    v_mul_f32 v16, v112, v112
    v_mul_f32 v17, v113, v113
    v_mul_f32 v18, v114, v114
    v_mul_f32 v19, v115, v115
    v_mul_f32 v20, v116, v116
    v_mul_f32 v21, v117, v117
    v_mul_f32 v22, v118, v118
    v_mul_f32 v23, v119, v119
    v_mul_f32 v24, v120, v120
    v_mul_f32 v25, v121, v121
    v_mul_f32 v26, v122, v122
    v_mul_f32 v27, v123, v123
    v_mul_f32 v28, v124, v124
    v_mul_f32 v29, v125, v125
    v_mul_f32 v30, v126, v126
    v_mul_f32 v31, v127, v127
    v_fma_f32 v16, v16, v12, v13
    v_fma_f32 v17, v17, v12, v13
    v_fma_f32 v18, v18, v12, v13
    v_fma_f32 v19, v19, v12, v13
    v_fma_f32 v20, v20, v12, v13
    v_fma_f32 v21, v21, v12, v13
    v_fma_f32 v22, v22, v12, v13
    v_fma_f32 v23, v23, v12, v13
    v_fma_f32 v24, v24, v12, v13
    v_fma_f32 v25, v25, v12, v13
    v_fma_f32 v26, v26, v12, v13
    v_fma_f32 v27, v27, v12, v13
    v_fma_f32 v28, v28, v12, v13
    v_fma_f32 v29, v29, v12, v13
    v_fma_f32 v30, v30, v12, v13
    v_fma_f32 v31, v31, v12, v13
    v_mul_f32 v16, v16, v112
    v_mul_f32 v17, v17, v113
    v_mul_f32 v18, v18, v114
    v_mul_f32 v19, v19, v115
    v_mul_f32 v20, v20, v116
    v_mul_f32 v21, v21, v117
    v_mul_f32 v22, v22, v118
    v_mul_f32 v23, v23, v119
    v_mul_f32 v24, v24, v120
    v_mul_f32 v25, v25, v121
    v_mul_f32 v26, v26, v122
    v_mul_f32 v27, v27, v123
    v_mul_f32 v28, v28, v124
    v_mul_f32 v29, v29, v125
    v_mul_f32 v30, v30, v126
    v_mul_f32 v31, v31, v127
    v_exp_f32 v16, v16
    v_exp_f32 v17, v17
    v_exp_f32 v18, v18
    v_exp_f32 v19, v19
    v_exp_f32 v20, v20
    v_exp_f32 v21, v21
    v_exp_f32 v22, v22
    v_exp_f32 v23, v23
    v_exp_f32 v24, v24
    v_exp_f32 v25, v25
    v_exp_f32 v26, v26
    v_exp_f32 v27, v27
    v_exp_f32 v28, v28
    v_exp_f32 v29, v29
    v_exp_f32 v30, v30
    v_exp_f32 v31, v31
    v_add_f32 v16, 1.0, v16
    v_add_f32 v17, 1.0, v17
    v_add_f32 v18, 1.0, v18
    v_add_f32 v19, 1.0, v19
    v_add_f32 v20, 1.0, v20
    v_add_f32 v21, 1.0, v21
    v_add_f32 v22, 1.0, v22
    v_add_f32 v23, 1.0, v23
    v_add_f32 v24, 1.0, v24
    v_add_f32 v25, 1.0, v25
    v_add_f32 v26, 1.0, v26
    v_add_f32 v27, 1.0, v27
    v_add_f32 v28, 1.0, v28
    v_add_f32 v29, 1.0, v29
    v_add_f32 v30, 1.0, v30
    v_add_f32 v31, 1.0, v31
    v_rcp_f32 v16, v16
    v_rcp_f32 v17, v17
    v_rcp_f32 v18, v18
    v_rcp_f32 v19, v19
    v_rcp_f32 v20, v20
    v_rcp_f32 v21, v21
    v_rcp_f32 v22, v22
    v_rcp_f32 v23, v23
    v_rcp_f32 v24, v24
    v_rcp_f32 v25, v25
    v_rcp_f32 v26, v26
    v_rcp_f32 v27, v27
    v_rcp_f32 v28, v28
    v_rcp_f32 v29, v29
    v_rcp_f32 v30, v30
    v_rcp_f32 v31, v31
    v_mul_f32 v112, v112, v16
    v_mul_f32 v113, v113, v17
    v_mul_f32 v114, v114, v18
    v_mul_f32 v115, v115, v19
    v_mul_f32 v116, v116, v20
    v_mul_f32 v117, v117, v21
    v_mul_f32 v118, v118, v22
    v_mul_f32 v119, v119, v23
    v_mul_f32 v120, v120, v24
    v_mul_f32 v121, v121, v25
    v_mul_f32 v122, v122, v26
    v_mul_f32 v123, v123, v27
    v_mul_f32 v124, v124, v28
    v_mul_f32 v125, v125, v29
    v_mul_f32 v126, v126, v30
    v_mul_f32 v127, v127, v31
    v_cvt_pk_bf16_f32 v112, v112, v113
    v_cvt_pk_bf16_f32 v113, v114, v115
    v_cvt_pk_bf16_f32 v114, v116, v117
    v_cvt_pk_bf16_f32 v115, v118, v119
    v_cvt_pk_bf16_f32 v116, v120, v121
    v_cvt_pk_bf16_f32 v117, v122, v123
    v_cvt_pk_bf16_f32 v118, v124, v125
    v_cvt_pk_bf16_f32 v119, v126, v127
    buffer_store_dwordx4 v[112:115], v7, s[48:51], s16 offen offset:2048 sc1
    buffer_store_dwordx4 v[116:119], v7, s[48:51], s17 offen offset:2048 sc1
    s_cmp_lg_u32 s52, 1
    s_cbranch_scc1 L_g_62
    s_buffer_load_dword s75, s[84:87], 128
    s_waitcnt lgkmcnt(0)
    s_cmp_ge_u32 s75, 24
    s_cbranch_scc1 L_ini_63
    v_mov_b32 v14, 0
    s_mov_b32 s74, 0
L_inir_64:
    s_sleep 6
    s_mov_b64 exec, 1
    buffer_load_dword v15, v14, s[84:87], 0 offen offset:128 sc1
    s_mov_b64 exec, -1
    s_waitcnt vmcnt(0)
    v_readfirstlane_b32 s75, v15
    s_add_u32 s74, s74, 1
    s_cmp_ge_u32 s75, 24
    s_cbranch_scc1 L_ini_63
    s_cmp_lt_u32 s74, 262144
    s_cbranch_scc1 L_inir_64
L_ini_63:
    s_bfe_u32 s73, s2, 0x50003
    s_lshl_b32 s73, s73, 8
    s_add_u32 s73, s73, 29786112
    s_mov_b32 s74, 0
L_poll_65:
    s_buffer_load_dword s75, s[48:51], s73 glc
    s_add_u32 s74, s74, 1
    s_waitcnt lgkmcnt(0)
    s_cmp_ge_u32 s75, 64
    s_cbranch_scc1 L_polld_66
    s_sleep 8
    s_cmp_lt_u32 s74, 262144
    s_cbranch_scc1 L_poll_65
L_polld_66:
L_g_62:
    s_waitcnt vmcnt(0)
    s_barrier
    s_cmp_lg_u32 s52, 0
    s_cbranch_scc1 L_pub_67
    v_lshlrev_b32 v14, 8, v0
    v_mov_b32 v15, 1
    s_mov_b32 exec_lo, s19
    s_mov_b32 exec_hi, 0
    buffer_atomic_add v15, v14, s[48:51], s18 offen sc1
    s_mov_b64 exec, -1
L_pub_67:
    s_branch L_mlp2
L_aux:
    s_and_b32 s66, s3, 7
    s_mul_i32 s66, s66, 9
    s_lshr_b32 s66, s66, 1
    s_lshr_b32 s67, s67, 3
    s_add_u32 s66, s66, s67
    s_lshl_b32 s66, s66, 8
    s_mul_i32 s69, s52, 294912
    s_add_u32 s66, s66, s69
    v_lshrrev_b32 v5, 1, v0
    v_mul_u32_u24 v5, 9216, v5
    v_and_b32 v6, 1, v0
    v_lshl_add_u32 v5, v6, 7, v5
    s_add_u32 s66, s66, 0
    buffer_load_dword v60, v5, s[40:43], s66 offen
    s_add_u32 s66, s66, 1179648
    s_waitcnt vmcnt(1)
    buffer_load_dword v61, v5, s[40:43], s66 offen
    s_add_u32 s66, s66, 1179648
    s_waitcnt vmcnt(1)
    buffer_load_dword v60, v5, s[40:43], s66 offen
    s_add_u32 s66, s66, 1179648
    s_waitcnt vmcnt(1)
    buffer_load_dword v61, v5, s[40:43], s66 offen
    s_add_u32 s66, s66, 1179648
    s_waitcnt vmcnt(1)
    buffer_load_dword v60, v5, s[40:43], s66 offen
    s_add_u32 s66, s66, 1179648
    s_waitcnt vmcnt(1)
    buffer_load_dword v61, v5, s[40:43], s66 offen
    s_add_u32 s66, s66, 1179648
    s_waitcnt vmcnt(1)
    buffer_load_dword v60, v5, s[40:43], s66 offen
    s_add_u32 s66, s66, 1179648
    s_waitcnt vmcnt(1)
    buffer_load_dword v61, v5, s[40:43], s66 offen
    s_add_u32 s66, s66, 1179648
    s_waitcnt vmcnt(1)
    buffer_load_dword v60, v5, s[40:43], s66 offen
    s_add_u32 s66, s66, 1179648
    s_waitcnt vmcnt(1)
    buffer_load_dword v61, v5, s[40:43], s66 offen
    s_add_u32 s66, s66, 1179648
    s_waitcnt vmcnt(1)
    buffer_load_dword v60, v5, s[40:43], s66 offen
    s_add_u32 s66, s66, 1179648
    s_waitcnt vmcnt(1)
    buffer_load_dword v61, v5, s[40:43], s66 offen
    s_add_u32 s66, s66, 1179648
    s_waitcnt vmcnt(1)
    buffer_load_dword v60, v5, s[40:43], s66 offen
    s_add_u32 s66, s66, 1179648
    s_waitcnt vmcnt(1)
    buffer_load_dword v61, v5, s[40:43], s66 offen
    s_add_u32 s66, s66, 1179648
    s_waitcnt vmcnt(1)
    buffer_load_dword v60, v5, s[40:43], s66 offen
    s_add_u32 s66, s66, 1179648
    s_waitcnt vmcnt(1)
    buffer_load_dword v61, v5, s[40:43], s66 offen
    s_add_u32 s66, s66, 1179648
    s_waitcnt vmcnt(1)
    s_mov_b32 s40, s28
    s_mov_b32 s41, s29
    s_mov_b32 s42, 18874368
    s_mov_b32 s43, 0x00020000
    s_lshl_b32 s68, s67, 2
    s_add_u32 s68, s68, s52
    s_and_b32 s66, s3, 7
    s_mul_i32 s66, s66, 10
    s_lshr_b32 s69, s68, 1
    s_add_u32 s66, s66, s69
    s_lshr_b32 s67, s66, 4
    s_and_b32 s66, s66, 15
    s_mul_i32 s67, s67, 3801088
    s_lshl_b32 s66, s66, 8
    s_add_u32 s67, s67, s66
    s_and_b32 s66, s52, 1
    s_lshl_b32 s66, s66, 17
    s_add_u32 s67, s67, s66
    v_lshrrev_b32 v5, 1, v0
    v_lshlrev_b32 v5, 12, v5
    v_and_b32 v6, 1, v0
    v_lshl_add_u32 v5, v6, 7, v5
    v_add_u32 v5, s67, v5
    buffer_load_dword v60, v5, s[40:43], 0 offen
    v_add_u32 v5, 262144, v5
    s_waitcnt vmcnt(1)
    buffer_load_dword v61, v5, s[40:43], 0 offen
    v_add_u32 v5, 262144, v5
    s_waitcnt vmcnt(1)
    buffer_load_dword v60, v5, s[40:43], 0 offen
    v_add_u32 v5, 262144, v5
    s_waitcnt vmcnt(1)
    buffer_load_dword v61, v5, s[40:43], 0 offen
    v_add_u32 v5, 262144, v5
    s_waitcnt vmcnt(1)
    buffer_load_dword v60, v5, s[40:43], 0 offen
    v_add_u32 v5, 262144, v5
    s_waitcnt vmcnt(1)
    buffer_load_dword v61, v5, s[40:43], 0 offen
    v_add_u32 v5, 262144, v5
    s_waitcnt vmcnt(1)
    buffer_load_dword v60, v5, s[40:43], 0 offen
    v_add_u32 v5, 262144, v5
    s_waitcnt vmcnt(1)
    s_waitcnt vmcnt(0)
    s_and_b32 s70, s3, 1
    s_mul_i32 s70, s70, 0
    s_add_u32 s70, s70, 240
    s_cmp_ge_u32 s3, s70
    s_cbranch_scc1 L_done
    s_mov_b32 s40, s28
    s_mov_b32 s41, s29
    s_mov_b32 s42, 18874368
    s_mov_b32 s43, 0x00020000
    s_mov_b32 s44, s38
    s_mov_b32 s45, s39
    s_mov_b32 s46, 268435456
    s_mov_b32 s47, 0x00020000
    s_lshr_b32 s67, s3, 3
    s_and_b32 s68, s3, 7
    s_mul_i32 s68, s68, 30
    s_add_u32 s67, s67, s68
    s_mul_i32 s66, s67, 171
    s_lshr_b32 s66, s66, 9
    s_mul_i32 s68, s66, 3
    s_sub_u32 s67, s67, s68
    s_lshr_b32 s69, s66, 4
    s_and_b32 s66, s66, 15
    s_lshl_b32 s70, s69, 2
    s_lshr_b32 s53, 275268, s70
    s_and_b32 s53, s53, 15
    s_lshr_b32 s65, 964672, s70
    s_and_b32 s65, s65, 15
    s_and_b32 s71, s52, 1
    s_lshr_b32 s72, s52, 1
    s_lshl_b32 s56, s66, 8
    s_lshl_b32 s70, s52, 15
    s_add_u32 s56, s56, s70
    s_mul_i32 s57, s67, 6144
    s_mul_i32 s70, s72, 18432
    s_add_u32 s57, s57, s70
    s_mul_i32 s70, s71, 3072
    s_add_u32 s57, s57, s70
    s_mul_i32 s54, s69, 3801088
    s_add_u32 s54, s54, s56
    s_mul_i32 s55, s69, 1069056
    s_add_u32 s55, s55, s57
    s_add_u32 s55, s55, 2359296
    s_lshl_b32 s60, s52, 11
    s_mul_i32 s61, s52, 3072
    s_add_u32 s61, s61, 8192
    s_mov_b32 s62, 131072
    s_mov_b32 s63, 36864
    v_lshrrev_b32 v8, 4, v0
    v_and_b32 v9, 3, v0
    v_lshlrev_b32 v9, 4, v9
    v_lshl_add_u32 v8, v8, 6, v9
    v_bfe_u32 v9, v0, 2, 2
    v_lshl_add_u32 v5, v9, 12, v8
    v_add_u32 v6, 16384, v5
    v_lshlrev_b32 v7, 4, v0
    s_add_u32 m0, s60, 0
    s_nop 0
    buffer_load_dwordx4 v5, s[40:43], s54 offen sc1 lds
    s_add_u32 m0, s60, 1024
    s_nop 0
    buffer_load_dwordx4 v6, s[40:43], s54 offen sc1 lds
    s_add_u32 s54, s54, s62
    s_add_u32 m0, s60, 20480
    s_nop 0
    buffer_load_dwordx4 v5, s[40:43], s54 offen sc1 lds
    s_add_u32 m0, s60, 21504
    s_nop 0
    buffer_load_dwordx4 v6, s[40:43], s54 offen sc1 lds
    s_add_u32 s54, s54, s62
    s_add_u32 m0, s60, 40960
    s_nop 0
    buffer_load_dwordx4 v5, s[40:43], s54 offen sc1 lds
    s_add_u32 m0, s60, 41984
    s_nop 0
    buffer_load_dwordx4 v6, s[40:43], s54 offen sc1 lds
    s_add_u32 s54, s54, s62
    s_add_u32 m0, s60, 61440
    s_nop 0
    buffer_load_dwordx4 v5, s[40:43], s54 offen sc1 lds
    s_add_u32 m0, s60, 62464
    s_nop 0
    buffer_load_dwordx4 v6, s[40:43], s54 offen sc1 lds
    s_add_u32 s54, s54, s62
    v_lshrrev_b32 v8, 5, v0
    v_lshlrev_b32 v8, 10, v8
    v_lshl_add_u32 v8, v9, 6, v8
    v_bfe_u32 v9, v0, 4, 1
    v_lshl_add_u32 v8, v9, 5, v8
    v_and_b32 v9, 3, v0
    v_lshl_add_u32 v8, v9, 3, v8
    s_lshl_b32 s70, s72, 9
    v_add_u32 v3, s70, v8
    v_add_u32 v4, 40960, v3
    s_mul_i32 s70, s71, 3072
    s_add_u32 s70, s70, 8192
    v_add_u32 v1, s70, v7
    v_add_u32 v2, 40960, v1
    s_cmp_lg_u32 s52, 0
    s_cbranch_scc1 L_g_68
    s_buffer_load_dword s75, s[84:87], 128
    s_waitcnt lgkmcnt(0)
    s_cmp_ge_u32 s75, 24
    s_cbranch_scc1 L_ini_69
    v_mov_b32 v14, 0
    s_mov_b32 s74, 0
L_inir_70:
    s_sleep 6
    s_mov_b64 exec, 1
    buffer_load_dword v15, v14, s[84:87], 0 offen offset:128 sc1
    s_mov_b64 exec, -1
    s_waitcnt vmcnt(0)
    v_readfirstlane_b32 s75, v15
    s_add_u32 s74, s74, 1
    s_cmp_ge_u32 s75, 24
    s_cbranch_scc1 L_ini_69
    s_cmp_lt_u32 s74, 262144
    s_cbranch_scc1 L_inir_70
L_ini_69:
    s_bfe_u32 s73, s2, 0x50003
    s_lshl_b32 s73, s73, 8
    s_add_u32 s73, s73, 29786112
    s_mov_b32 s74, 0
L_poll_71:
    s_buffer_load_dword s75, s[48:51], s73 glc
    s_add_u32 s74, s74, 1
    s_waitcnt lgkmcnt(0)
    s_cmp_ge_u32 s75, 64
    s_cbranch_scc1 L_polld_72
    s_sleep 8
    s_cmp_lt_u32 s74, 262144
    s_cbranch_scc1 L_poll_71
L_polld_72:
L_g_68:
    s_barrier
L_mlp2:
    s_mul_i32 s73, s67, 5
    s_add_u32 s73, s73, s69
    s_lshl_b32 s73, s73, 4
    s_add_u32 s73, s73, s66
    s_lshl_b32 s73, s73, 8
    s_add_u32 s73, s73, 29605888
    s_cmp_eq_u32 s69, 4
    s_cselect_b32 s76, 14, 16
    s_mov_b32 s74, 0
L_poll_73:
    s_buffer_load_dword s75, s[48:51], s73 glc
    s_add_u32 s74, s74, 1
    s_waitcnt lgkmcnt(0)
    s_cmp_ge_u32 s75, s76
    s_cbranch_scc1 L_polld_74
    s_sleep 1
    s_cmp_lt_u32 s74, 262144
    s_cbranch_scc1 L_poll_73
L_polld_74:
    s_add_u32 m0, s61, 0
    s_nop 0
    buffer_load_dwordx4 v7, s[44:47], s55 offen offset:0 sc1 lds
    buffer_load_dwordx4 v7, s[44:47], s55 offen offset:1024 sc1 lds
    buffer_load_dwordx4 v7, s[44:47], s55 offen offset:2048 sc1 lds
    s_add_u32 s55, s55, s63
    s_add_u32 m0, s61, 20480
    s_nop 0
    buffer_load_dwordx4 v7, s[44:47], s55 offen offset:0 sc1 lds
    buffer_load_dwordx4 v7, s[44:47], s55 offen offset:1024 sc1 lds
    buffer_load_dwordx4 v7, s[44:47], s55 offen offset:2048 sc1 lds
    s_add_u32 s55, s55, s63
    s_add_u32 m0, s61, 40960
    s_nop 0
    buffer_load_dwordx4 v7, s[44:47], s55 offen offset:0 sc1 lds
    buffer_load_dwordx4 v7, s[44:47], s55 offen offset:1024 sc1 lds
    buffer_load_dwordx4 v7, s[44:47], s55 offen offset:2048 sc1 lds
    s_add_u32 s55, s55, s63
    s_waitcnt vmcnt(6)
    s_barrier
    ds_read_b128 v[8:11], v1 offset:0
    ds_read_b64_tr_b16 v[20:21], v3 offset:0
    ds_read_b64_tr_b16 v[22:23], v3 offset:2048
    ds_read_b64_tr_b16 v[24:25], v3 offset:256
    ds_read_b64_tr_b16 v[26:27], v3 offset:2304
    ds_read_b128 v[12:15], v1 offset:1024
    ds_read_b128 v[16:19], v1 offset:2048
    s_setprio 0
    s_waitcnt lgkmcnt(0)
    v_mfma_f32_32x32x16_bf16 v[64:79], v[8:11], v[20:23], 0
    s_add_u32 m0, s61, 61440
    ds_read_b128 v[28:31], v1 offset:6144
    ds_read_b64_tr_b16 v[40:41], v3 offset:4096
    ds_read_b64_tr_b16 v[42:43], v3 offset:6144
    buffer_load_dwordx4 v7, s[44:47], s55 offen offset:0 sc1 lds
    v_mfma_f32_32x32x16_bf16 v[80:95], v[8:11], v[24:27], 0
    ds_read_b64_tr_b16 v[44:45], v3 offset:4352
    ds_read_b64_tr_b16 v[46:47], v3 offset:6400
    ds_read_b128 v[32:35], v1 offset:7168
    ds_read_b128 v[36:39], v1 offset:8192
    v_mfma_f32_32x32x16_bf16 v[96:111], v[12:15], v[20:23], 0
    buffer_load_dwordx4 v7, s[44:47], s55 offen offset:1024 sc1 lds
    v_mfma_f32_32x32x16_bf16 v[112:127], v[12:15], v[24:27], 0
    v_mfma_f32_32x32x16_bf16 v[128:143], v[16:19], v[20:23], 0
    buffer_load_dwordx4 v7, s[44:47], s55 offen offset:2048 sc1 lds
    s_add_u32 s55, s55, s63
    v_mfma_f32_32x32x16_bf16 v[144:159], v[16:19], v[24:27], 0
    s_waitcnt lgkmcnt(0)
    v_mfma_f32_32x32x16_bf16 v[64:79], v[28:31], v[40:43], v[64:79]
    s_waitcnt vmcnt(6)
    s_barrier
    s_add_u32 m0, s60, 0
    ds_read_b128 v[8:11], v1 offset:20480
    ds_read_b64_tr_b16 v[20:21], v3 offset:20480
    ds_read_b64_tr_b16 v[22:23], v3 offset:22528
    v_mfma_f32_32x32x16_bf16 v[80:95], v[28:31], v[44:47], v[80:95]
    ds_read_b64_tr_b16 v[24:25], v3 offset:20736
    ds_read_b64_tr_b16 v[26:27], v3 offset:22784
    ds_read_b128 v[12:15], v1 offset:21504
    ds_read_b128 v[16:19], v1 offset:22528
    v_mfma_f32_32x32x16_bf16 v[96:111], v[32:35], v[40:43], v[96:111]
    buffer_load_dwordx4 v5, s[40:43], s54 offen sc1 lds
    v_mfma_f32_32x32x16_bf16 v[112:127], v[32:35], v[44:47], v[112:127]
    s_add_u32 m0, s60, 1024
    v_mfma_f32_32x32x16_bf16 v[128:143], v[36:39], v[40:43], v[128:143]
    buffer_load_dwordx4 v6, s[40:43], s54 offen sc1 lds
    s_add_u32 s54, s54, s62
    v_mfma_f32_32x32x16_bf16 v[144:159], v[36:39], v[44:47], v[144:159]
    s_waitcnt lgkmcnt(0)
    v_mfma_f32_32x32x16_bf16 v[64:79], v[8:11], v[20:23], v[64:79]
    s_add_u32 m0, s61, 0
    ds_read_b128 v[28:31], v1 offset:26624
    ds_read_b64_tr_b16 v[40:41], v3 offset:24576
    ds_read_b64_tr_b16 v[42:43], v3 offset:26624
    buffer_load_dwordx4 v7, s[44:47], s55 offen offset:0 sc1 lds
    v_mfma_f32_32x32x16_bf16 v[80:95], v[8:11], v[24:27], v[80:95]
    ds_read_b64_tr_b16 v[44:45], v3 offset:24832
    ds_read_b64_tr_b16 v[46:47], v3 offset:26880
    ds_read_b128 v[32:35], v1 offset:27648
    ds_read_b128 v[36:39], v1 offset:28672
    v_mfma_f32_32x32x16_bf16 v[96:111], v[12:15], v[20:23], v[96:111]
    buffer_load_dwordx4 v7, s[44:47], s55 offen offset:1024 sc1 lds
    v_mfma_f32_32x32x16_bf16 v[112:127], v[12:15], v[24:27], v[112:127]
    v_mfma_f32_32x32x16_bf16 v[128:143], v[16:19], v[20:23], v[128:143]
    buffer_load_dwordx4 v7, s[44:47], s55 offen offset:2048 sc1 lds
    s_add_u32 s55, s55, s63
    v_mfma_f32_32x32x16_bf16 v[144:159], v[16:19], v[24:27], v[144:159]
    s_waitcnt lgkmcnt(0)
    v_mfma_f32_32x32x16_bf16 v[64:79], v[28:31], v[40:43], v[64:79]
    s_waitcnt vmcnt(8)
    s_barrier
    s_add_u32 m0, s60, 20480
    ds_read_b128 v[8:11], v2 offset:0
    ds_read_b64_tr_b16 v[20:21], v4 offset:0
    ds_read_b64_tr_b16 v[22:23], v4 offset:2048
    v_mfma_f32_32x32x16_bf16 v[80:95], v[28:31], v[44:47], v[80:95]
    ds_read_b64_tr_b16 v[24:25], v4 offset:256
    ds_read_b64_tr_b16 v[26:27], v4 offset:2304
    ds_read_b128 v[12:15], v2 offset:1024
    ds_read_b128 v[16:19], v2 offset:2048
    v_mfma_f32_32x32x16_bf16 v[96:111], v[32:35], v[40:43], v[96:111]
    buffer_load_dwordx4 v5, s[40:43], s54 offen sc1 lds
    v_mfma_f32_32x32x16_bf16 v[112:127], v[32:35], v[44:47], v[112:127]
    s_add_u32 m0, s60, 21504
    v_mfma_f32_32x32x16_bf16 v[128:143], v[36:39], v[40:43], v[128:143]
    buffer_load_dwordx4 v6, s[40:43], s54 offen sc1 lds
    s_add_u32 s54, s54, s62
    v_mfma_f32_32x32x16_bf16 v[144:159], v[36:39], v[44:47], v[144:159]
    s_mov_b32 s58, 5
.p2align 6
L_mlp2_75:
    s_waitcnt lgkmcnt(0)
    v_mfma_f32_32x32x16_bf16 v[64:79], v[8:11], v[20:23], v[64:79]
    s_add_u32 m0, s61, 20480
    ds_read_b128 v[28:31], v2 offset:6144
    ds_read_b64_tr_b16 v[40:41], v4 offset:4096
    ds_read_b64_tr_b16 v[42:43], v4 offset:6144
    buffer_load_dwordx4 v7, s[44:47], s55 offen offset:0 sc1 lds
    v_mfma_f32_32x32x16_bf16 v[80:95], v[8:11], v[24:27], v[80:95]
    ds_read_b64_tr_b16 v[44:45], v4 offset:4352
    ds_read_b64_tr_b16 v[46:47], v4 offset:6400
    ds_read_b128 v[32:35], v2 offset:7168
    ds_read_b128 v[36:39], v2 offset:8192
    v_mfma_f32_32x32x16_bf16 v[96:111], v[12:15], v[20:23], v[96:111]
    buffer_load_dwordx4 v7, s[44:47], s55 offen offset:1024 sc1 lds
    v_mfma_f32_32x32x16_bf16 v[112:127], v[12:15], v[24:27], v[112:127]
    v_mfma_f32_32x32x16_bf16 v[128:143], v[16:19], v[20:23], v[128:143]
    buffer_load_dwordx4 v7, s[44:47], s55 offen offset:2048 sc1 lds
    s_add_u32 s55, s55, s63
    v_mfma_f32_32x32x16_bf16 v[144:159], v[16:19], v[24:27], v[144:159]
    s_waitcnt lgkmcnt(0)
    v_mfma_f32_32x32x16_bf16 v[64:79], v[28:31], v[40:43], v[64:79]
    s_waitcnt vmcnt(10)
    s_barrier
    s_add_u32 m0, s60, 40960
    ds_read_b128 v[8:11], v2 offset:20480
    ds_read_b64_tr_b16 v[20:21], v4 offset:20480
    ds_read_b64_tr_b16 v[22:23], v4 offset:22528
    v_mfma_f32_32x32x16_bf16 v[80:95], v[28:31], v[44:47], v[80:95]
    ds_read_b64_tr_b16 v[24:25], v4 offset:20736
    ds_read_b64_tr_b16 v[26:27], v4 offset:22784
    ds_read_b128 v[12:15], v2 offset:21504
    ds_read_b128 v[16:19], v2 offset:22528
    v_mfma_f32_32x32x16_bf16 v[96:111], v[32:35], v[40:43], v[96:111]
    buffer_load_dwordx4 v5, s[40:43], s54 offen sc1 lds
    v_mfma_f32_32x32x16_bf16 v[112:127], v[32:35], v[44:47], v[112:127]
    s_add_u32 m0, s60, 41984
    v_mfma_f32_32x32x16_bf16 v[128:143], v[36:39], v[40:43], v[128:143]
    buffer_load_dwordx4 v6, s[40:43], s54 offen sc1 lds
    s_add_u32 s54, s54, s62
    v_mfma_f32_32x32x16_bf16 v[144:159], v[36:39], v[44:47], v[144:159]
    s_waitcnt lgkmcnt(0)
    v_mfma_f32_32x32x16_bf16 v[64:79], v[8:11], v[20:23], v[64:79]
    s_add_u32 m0, s61, 40960
    ds_read_b128 v[28:31], v2 offset:26624
    ds_read_b64_tr_b16 v[40:41], v4 offset:24576
    ds_read_b64_tr_b16 v[42:43], v4 offset:26624
    buffer_load_dwordx4 v7, s[44:47], s55 offen offset:0 sc1 lds
    v_mfma_f32_32x32x16_bf16 v[80:95], v[8:11], v[24:27], v[80:95]
    ds_read_b64_tr_b16 v[44:45], v4 offset:24832
    ds_read_b64_tr_b16 v[46:47], v4 offset:26880
    ds_read_b128 v[32:35], v2 offset:27648
    ds_read_b128 v[36:39], v2 offset:28672
    v_mfma_f32_32x32x16_bf16 v[96:111], v[12:15], v[20:23], v[96:111]
    buffer_load_dwordx4 v7, s[44:47], s55 offen offset:1024 sc1 lds
    v_mfma_f32_32x32x16_bf16 v[112:127], v[12:15], v[24:27], v[112:127]
    v_mfma_f32_32x32x16_bf16 v[128:143], v[16:19], v[20:23], v[128:143]
    buffer_load_dwordx4 v7, s[44:47], s55 offen offset:2048 sc1 lds
    s_add_u32 s55, s55, s63
    v_mfma_f32_32x32x16_bf16 v[144:159], v[16:19], v[24:27], v[144:159]
    s_waitcnt lgkmcnt(0)
    v_mfma_f32_32x32x16_bf16 v[64:79], v[28:31], v[40:43], v[64:79]
    s_waitcnt vmcnt(10)
    s_barrier
    s_add_u32 m0, s60, 61440
    ds_read_b128 v[8:11], v1 offset:0
    ds_read_b64_tr_b16 v[20:21], v3 offset:0
    ds_read_b64_tr_b16 v[22:23], v3 offset:2048
    v_mfma_f32_32x32x16_bf16 v[80:95], v[28:31], v[44:47], v[80:95]
    ds_read_b64_tr_b16 v[24:25], v3 offset:256
    ds_read_b64_tr_b16 v[26:27], v3 offset:2304
    ds_read_b128 v[12:15], v1 offset:1024
    ds_read_b128 v[16:19], v1 offset:2048
    v_mfma_f32_32x32x16_bf16 v[96:111], v[32:35], v[40:43], v[96:111]
    buffer_load_dwordx4 v5, s[40:43], s54 offen sc1 lds
    v_mfma_f32_32x32x16_bf16 v[112:127], v[32:35], v[44:47], v[112:127]
    s_add_u32 m0, s60, 62464
    v_mfma_f32_32x32x16_bf16 v[128:143], v[36:39], v[40:43], v[128:143]
    buffer_load_dwordx4 v6, s[40:43], s54 offen sc1 lds
    s_add_u32 s54, s54, s62
    v_mfma_f32_32x32x16_bf16 v[144:159], v[36:39], v[44:47], v[144:159]
    s_waitcnt lgkmcnt(0)
    v_mfma_f32_32x32x16_bf16 v[64:79], v[8:11], v[20:23], v[64:79]
    s_add_u32 m0, s61, 61440
    ds_read_b128 v[28:31], v1 offset:6144
    ds_read_b64_tr_b16 v[40:41], v3 offset:4096
    ds_read_b64_tr_b16 v[42:43], v3 offset:6144
    buffer_load_dwordx4 v7, s[44:47], s55 offen offset:0 sc1 lds
    v_mfma_f32_32x32x16_bf16 v[80:95], v[8:11], v[24:27], v[80:95]
    ds_read_b64_tr_b16 v[44:45], v3 offset:4352
    ds_read_b64_tr_b16 v[46:47], v3 offset:6400
    ds_read_b128 v[32:35], v1 offset:7168
    ds_read_b128 v[36:39], v1 offset:8192
    v_mfma_f32_32x32x16_bf16 v[96:111], v[12:15], v[20:23], v[96:111]
    buffer_load_dwordx4 v7, s[44:47], s55 offen offset:1024 sc1 lds
    v_mfma_f32_32x32x16_bf16 v[112:127], v[12:15], v[24:27], v[112:127]
    v_mfma_f32_32x32x16_bf16 v[128:143], v[16:19], v[20:23], v[128:143]
    buffer_load_dwordx4 v7, s[44:47], s55 offen offset:2048 sc1 lds
    s_add_u32 s55, s55, s63
    v_mfma_f32_32x32x16_bf16 v[144:159], v[16:19], v[24:27], v[144:159]
    s_waitcnt lgkmcnt(0)
    v_mfma_f32_32x32x16_bf16 v[64:79], v[28:31], v[40:43], v[64:79]
    s_waitcnt vmcnt(10)
    s_barrier
    s_add_u32 m0, s60, 0
    ds_read_b128 v[8:11], v1 offset:20480
    ds_read_b64_tr_b16 v[20:21], v3 offset:20480
    ds_read_b64_tr_b16 v[22:23], v3 offset:22528
    v_mfma_f32_32x32x16_bf16 v[80:95], v[28:31], v[44:47], v[80:95]
    ds_read_b64_tr_b16 v[24:25], v3 offset:20736
    ds_read_b64_tr_b16 v[26:27], v3 offset:22784
    ds_read_b128 v[12:15], v1 offset:21504
    ds_read_b128 v[16:19], v1 offset:22528
    v_mfma_f32_32x32x16_bf16 v[96:111], v[32:35], v[40:43], v[96:111]
    buffer_load_dwordx4 v5, s[40:43], s54 offen sc1 lds
    v_mfma_f32_32x32x16_bf16 v[112:127], v[32:35], v[44:47], v[112:127]
    s_add_u32 m0, s60, 1024
    v_mfma_f32_32x32x16_bf16 v[128:143], v[36:39], v[40:43], v[128:143]
    buffer_load_dwordx4 v6, s[40:43], s54 offen sc1 lds
    s_add_u32 s54, s54, s62
    v_mfma_f32_32x32x16_bf16 v[144:159], v[36:39], v[44:47], v[144:159]
    s_waitcnt lgkmcnt(0)
    v_mfma_f32_32x32x16_bf16 v[64:79], v[8:11], v[20:23], v[64:79]
    s_add_u32 m0, s61, 0
    ds_read_b128 v[28:31], v1 offset:26624
    ds_read_b64_tr_b16 v[40:41], v3 offset:24576
    ds_read_b64_tr_b16 v[42:43], v3 offset:26624
    buffer_load_dwordx4 v7, s[44:47], s55 offen offset:0 sc1 lds
    v_mfma_f32_32x32x16_bf16 v[80:95], v[8:11], v[24:27], v[80:95]
    ds_read_b64_tr_b16 v[44:45], v3 offset:24832
    ds_read_b64_tr_b16 v[46:47], v3 offset:26880
    ds_read_b128 v[32:35], v1 offset:27648
    ds_read_b128 v[36:39], v1 offset:28672
    v_mfma_f32_32x32x16_bf16 v[96:111], v[12:15], v[20:23], v[96:111]
    buffer_load_dwordx4 v7, s[44:47], s55 offen offset:1024 sc1 lds
    v_mfma_f32_32x32x16_bf16 v[112:127], v[12:15], v[24:27], v[112:127]
    v_mfma_f32_32x32x16_bf16 v[128:143], v[16:19], v[20:23], v[128:143]
    buffer_load_dwordx4 v7, s[44:47], s55 offen offset:2048 sc1 lds
    s_add_u32 s55, s55, s63
    v_mfma_f32_32x32x16_bf16 v[144:159], v[16:19], v[24:27], v[144:159]
    s_waitcnt lgkmcnt(0)
    v_mfma_f32_32x32x16_bf16 v[64:79], v[28:31], v[40:43], v[64:79]
    s_waitcnt vmcnt(10)
    s_barrier
    s_add_u32 m0, s60, 20480
    ds_read_b128 v[8:11], v2 offset:0
    ds_read_b64_tr_b16 v[20:21], v4 offset:0
    ds_read_b64_tr_b16 v[22:23], v4 offset:2048
    v_mfma_f32_32x32x16_bf16 v[80:95], v[28:31], v[44:47], v[80:95]
    ds_read_b64_tr_b16 v[24:25], v4 offset:256
    ds_read_b64_tr_b16 v[26:27], v4 offset:2304
    ds_read_b128 v[12:15], v2 offset:1024
    ds_read_b128 v[16:19], v2 offset:2048
    v_mfma_f32_32x32x16_bf16 v[96:111], v[32:35], v[40:43], v[96:111]
    buffer_load_dwordx4 v5, s[40:43], s54 offen sc1 lds
    v_mfma_f32_32x32x16_bf16 v[112:127], v[32:35], v[44:47], v[112:127]
    s_add_u32 m0, s60, 21504
    v_mfma_f32_32x32x16_bf16 v[128:143], v[36:39], v[40:43], v[128:143]
    buffer_load_dwordx4 v6, s[40:43], s54 offen sc1 lds
    s_add_u32 s54, s54, s62
    v_mfma_f32_32x32x16_bf16 v[144:159], v[36:39], v[44:47], v[144:159]
    s_sub_u32 s58, s58, 1
    s_cmp_lg_u32 s58, 0
    s_cbranch_scc1 L_mlp2_75
    s_waitcnt lgkmcnt(0)
    v_mfma_f32_32x32x16_bf16 v[64:79], v[8:11], v[20:23], v[64:79]
    s_add_u32 m0, s61, 20480
    ds_read_b128 v[28:31], v2 offset:6144
    ds_read_b64_tr_b16 v[40:41], v4 offset:4096
    ds_read_b64_tr_b16 v[42:43], v4 offset:6144
    buffer_load_dwordx4 v7, s[44:47], s55 offen offset:0 sc1 lds
    v_mfma_f32_32x32x16_bf16 v[80:95], v[8:11], v[24:27], v[80:95]
    ds_read_b64_tr_b16 v[44:45], v4 offset:4352
    ds_read_b64_tr_b16 v[46:47], v4 offset:6400
    ds_read_b128 v[32:35], v2 offset:7168
    ds_read_b128 v[36:39], v2 offset:8192
    v_mfma_f32_32x32x16_bf16 v[96:111], v[12:15], v[20:23], v[96:111]
    buffer_load_dwordx4 v7, s[44:47], s55 offen offset:1024 sc1 lds
    v_mfma_f32_32x32x16_bf16 v[112:127], v[12:15], v[24:27], v[112:127]
    v_mfma_f32_32x32x16_bf16 v[128:143], v[16:19], v[20:23], v[128:143]
    buffer_load_dwordx4 v7, s[44:47], s55 offen offset:2048 sc1 lds
    s_add_u32 s55, s55, s63
    v_mfma_f32_32x32x16_bf16 v[144:159], v[16:19], v[24:27], v[144:159]
    s_waitcnt lgkmcnt(0)
    v_mfma_f32_32x32x16_bf16 v[64:79], v[28:31], v[40:43], v[64:79]
    s_waitcnt vmcnt(10)
    s_barrier
    s_add_u32 m0, s60, 40960
    ds_read_b128 v[8:11], v2 offset:20480
    ds_read_b64_tr_b16 v[20:21], v4 offset:20480
    ds_read_b64_tr_b16 v[22:23], v4 offset:22528
    v_mfma_f32_32x32x16_bf16 v[80:95], v[28:31], v[44:47], v[80:95]
    ds_read_b64_tr_b16 v[24:25], v4 offset:20736
    ds_read_b64_tr_b16 v[26:27], v4 offset:22784
    ds_read_b128 v[12:15], v2 offset:21504
    ds_read_b128 v[16:19], v2 offset:22528
    v_mfma_f32_32x32x16_bf16 v[96:111], v[32:35], v[40:43], v[96:111]
    buffer_load_dwordx4 v5, s[40:43], s54 offen sc1 lds
    v_mfma_f32_32x32x16_bf16 v[112:127], v[32:35], v[44:47], v[112:127]
    s_add_u32 m0, s60, 41984
    v_mfma_f32_32x32x16_bf16 v[128:143], v[36:39], v[40:43], v[128:143]
    buffer_load_dwordx4 v6, s[40:43], s54 offen sc1 lds
    s_add_u32 s54, s54, s62
    v_mfma_f32_32x32x16_bf16 v[144:159], v[36:39], v[44:47], v[144:159]
    s_waitcnt lgkmcnt(0)
    v_mfma_f32_32x32x16_bf16 v[64:79], v[8:11], v[20:23], v[64:79]
    s_add_u32 m0, s61, 40960
    ds_read_b128 v[28:31], v2 offset:26624
    ds_read_b64_tr_b16 v[40:41], v4 offset:24576
    ds_read_b64_tr_b16 v[42:43], v4 offset:26624
    buffer_load_dwordx4 v7, s[44:47], s55 offen offset:0 sc1 lds
    v_mfma_f32_32x32x16_bf16 v[80:95], v[8:11], v[24:27], v[80:95]
    ds_read_b64_tr_b16 v[44:45], v4 offset:24832
    ds_read_b64_tr_b16 v[46:47], v4 offset:26880
    ds_read_b128 v[32:35], v2 offset:27648
    ds_read_b128 v[36:39], v2 offset:28672
    v_mfma_f32_32x32x16_bf16 v[96:111], v[12:15], v[20:23], v[96:111]
    buffer_load_dwordx4 v7, s[44:47], s55 offen offset:1024 sc1 lds
    v_mfma_f32_32x32x16_bf16 v[112:127], v[12:15], v[24:27], v[112:127]
    v_mfma_f32_32x32x16_bf16 v[128:143], v[16:19], v[20:23], v[128:143]
    buffer_load_dwordx4 v7, s[44:47], s55 offen offset:2048 sc1 lds
    s_add_u32 s55, s55, s63
    v_mfma_f32_32x32x16_bf16 v[144:159], v[16:19], v[24:27], v[144:159]
    s_lshr_b32 s59, s66, 1
    s_mul_i32 s59, s59, 5
    s_add_u32 s59, s59, s69
    s_mul_i32 s59, s59, 6
    s_lshl_b32 s70, s67, 1
    s_add_u32 s59, s59, s70
    s_and_b32 s70, s66, 1
    s_add_u32 s59, s59, s70
    s_lshl_b32 s59, s59, 8
    s_add_u32 s59, s59, 29671424
    s_lshl_b32 s64, s53, 1
    s_waitcnt lgkmcnt(0)
    v_mfma_f32_32x32x16_bf16 v[64:79], v[28:31], v[40:43], v[64:79]
    s_waitcnt vmcnt(10)
    s_barrier
    s_add_u32 m0, s60, 61440
    ds_read_b128 v[8:11], v1 offset:0
    ds_read_b64_tr_b16 v[20:21], v3 offset:0
    ds_read_b64_tr_b16 v[22:23], v3 offset:2048
    v_mfma_f32_32x32x16_bf16 v[80:95], v[28:31], v[44:47], v[80:95]
    ds_read_b64_tr_b16 v[24:25], v3 offset:256
    ds_read_b64_tr_b16 v[26:27], v3 offset:2304
    ds_read_b128 v[12:15], v1 offset:1024
    ds_read_b128 v[16:19], v1 offset:2048
    v_mfma_f32_32x32x16_bf16 v[96:111], v[32:35], v[40:43], v[96:111]
    buffer_load_dwordx4 v5, s[40:43], s54 offen sc1 lds
    v_mfma_f32_32x32x16_bf16 v[112:127], v[32:35], v[44:47], v[112:127]
    s_add_u32 m0, s60, 62464
    v_mfma_f32_32x32x16_bf16 v[128:143], v[36:39], v[40:43], v[128:143]
    buffer_load_dwordx4 v6, s[40:43], s54 offen sc1 lds
    s_add_u32 s54, s54, s62
    v_mfma_f32_32x32x16_bf16 v[144:159], v[36:39], v[44:47], v[144:159]
    s_waitcnt lgkmcnt(0)
    v_mfma_f32_32x32x16_bf16 v[64:79], v[8:11], v[20:23], v[64:79]
    s_add_u32 m0, s61, 61440
    ds_read_b128 v[28:31], v1 offset:6144
    ds_read_b64_tr_b16 v[40:41], v3 offset:4096
    ds_read_b64_tr_b16 v[42:43], v3 offset:6144
    buffer_load_dwordx4 v7, s[44:47], s55 offen offset:0 sc1 lds
    v_mfma_f32_32x32x16_bf16 v[80:95], v[8:11], v[24:27], v[80:95]
    ds_read_b64_tr_b16 v[44:45], v3 offset:4352
    ds_read_b64_tr_b16 v[46:47], v3 offset:6400
    ds_read_b128 v[32:35], v1 offset:7168
    ds_read_b128 v[36:39], v1 offset:8192
    v_mfma_f32_32x32x16_bf16 v[96:111], v[12:15], v[20:23], v[96:111]
    buffer_load_dwordx4 v7, s[44:47], s55 offen offset:1024 sc1 lds
    v_mfma_f32_32x32x16_bf16 v[112:127], v[12:15], v[24:27], v[112:127]
    v_mfma_f32_32x32x16_bf16 v[128:143], v[16:19], v[20:23], v[128:143]
    buffer_load_dwordx4 v7, s[44:47], s55 offen offset:2048 sc1 lds
    s_add_u32 s55, s55, s63
    v_mfma_f32_32x32x16_bf16 v[144:159], v[16:19], v[24:27], v[144:159]
    s_cmp_eq_u32 s69, 4
    s_cselect_b32 s42, 0, s42
    s_cselect_b32 s46, 0, s46
    s_waitcnt lgkmcnt(0)
    v_mfma_f32_32x32x16_bf16 v[64:79], v[28:31], v[40:43], v[64:79]
    s_waitcnt vmcnt(10)
    s_barrier
    s_add_u32 m0, s60, 0
    ds_read_b128 v[8:11], v1 offset:20480
    ds_read_b64_tr_b16 v[20:21], v3 offset:20480
    ds_read_b64_tr_b16 v[22:23], v3 offset:22528
    v_mfma_f32_32x32x16_bf16 v[80:95], v[28:31], v[44:47], v[80:95]
    ds_read_b64_tr_b16 v[24:25], v3 offset:20736
    ds_read_b64_tr_b16 v[26:27], v3 offset:22784
    ds_read_b128 v[12:15], v1 offset:21504
    ds_read_b128 v[16:19], v1 offset:22528
    v_mfma_f32_32x32x16_bf16 v[96:111], v[32:35], v[40:43], v[96:111]
    buffer_load_dwordx4 v5, s[40:43], s54 offen sc1 lds
    v_mfma_f32_32x32x16_bf16 v[112:127], v[32:35], v[44:47], v[112:127]
    s_add_u32 m0, s60, 1024
    v_mfma_f32_32x32x16_bf16 v[128:143], v[36:39], v[40:43], v[128:143]
    buffer_load_dwordx4 v6, s[40:43], s54 offen sc1 lds
    s_add_u32 s54, s54, s62
    v_mfma_f32_32x32x16_bf16 v[144:159], v[36:39], v[44:47], v[144:159]
    s_waitcnt lgkmcnt(0)
    s_buffer_load_dword s75, s[48:51], s59 glc
    v_mfma_f32_32x32x16_bf16 v[64:79], v[8:11], v[20:23], v[64:79]
    s_add_u32 m0, s61, 0
    ds_read_b128 v[28:31], v1 offset:26624
    ds_read_b64_tr_b16 v[40:41], v3 offset:24576
    ds_read_b64_tr_b16 v[42:43], v3 offset:26624
    buffer_load_dwordx4 v7, s[44:47], s55 offen offset:0 sc1 lds
    v_mfma_f32_32x32x16_bf16 v[80:95], v[8:11], v[24:27], v[80:95]
    ds_read_b64_tr_b16 v[44:45], v3 offset:24832
    ds_read_b64_tr_b16 v[46:47], v3 offset:26880
    ds_read_b128 v[32:35], v1 offset:27648
    ds_read_b128 v[36:39], v1 offset:28672
    v_mfma_f32_32x32x16_bf16 v[96:111], v[12:15], v[20:23], v[96:111]
    buffer_load_dwordx4 v7, s[44:47], s55 offen offset:1024 sc1 lds
    v_mfma_f32_32x32x16_bf16 v[112:127], v[12:15], v[24:27], v[112:127]
    v_mfma_f32_32x32x16_bf16 v[128:143], v[16:19], v[20:23], v[128:143]
    buffer_load_dwordx4 v7, s[44:47], s55 offen offset:2048 sc1 lds
    s_add_u32 s55, s55, s63
    v_mfma_f32_32x32x16_bf16 v[144:159], v[16:19], v[24:27], v[144:159]
    s_mov_b32 s40, s38
    s_mov_b32 s41, s39
    s_mov_b32 s42, 0
    s_mov_b32 s43, 0x00020000
    s_mov_b32 s46, 268435456
    s_mov_b32 s79, 0
    s_lshl_b32 s54, s65, 17
    s_add_u32 s54, s54, s56
    s_add_u32 s54, s54, 14745600
    s_mov_b32 s78, s54
    s_mul_i32 s55, s65, s63
    s_add_u32 s55, s55, s57
    s_add_u32 s55, s55, 17104896
    s_lshl_b32 s70, s66, 1
    s_add_u32 s70, s70, s72
    s_lshl_b32 s70, s70, 6
    v_and_b32 v48, 31, v0
    v_add_u32 v48, s70, v48
    v_lshlrev_b32 v49, 2, v48
    v_lshlrev_b32 v48, 1, v48
    s_mov_b32 s70, 17768448
    s_mov_b32 s80, s30
    s_mov_b32 s81, s31
    s_mov_b32 s82, 4096
    s_mov_b32 s83, 0x00020000
    s_cmp_eq_u32 s69, 0
    s_cselect_b32 s82, s82, 0
    buffer_load_dword v50, v49, s[48:51], s70 offen sc1
    buffer_load_dword v51, v49, s[48:51], s70 offen offset:128 sc1
    buffer_load_ushort v52, v48, s[80:83], 0 offen
    buffer_load_ushort v53, v48, s[80:83], 0 offen offset:64
    s_waitcnt lgkmcnt(0)
    v_mfma_f32_32x32x16_bf16 v[64:79], v[28:31], v[40:43], v[64:79]
    s_cmp_ge_u32 s75, s64
    s_cselect_b32 s75, 1, 0
    s_cmp_gt_u32 s75, s79
    s_cbranch_scc0 L_lk_76
    s_mov_b32 s79, 1
    s_mov_b32 s42, 268435456
L_lk_76:
    s_waitcnt vmcnt(10)
    s_barrier
    s_add_u32 m0, s60, 20480
    ds_read_b128 v[8:11], v2 offset:0
    ds_read_b64_tr_b16 v[20:21], v4 offset:0
    ds_read_b64_tr_b16 v[22:23], v4 offset:2048
    v_mfma_f32_32x32x16_bf16 v[80:95], v[28:31], v[44:47], v[80:95]
    ds_read_b64_tr_b16 v[24:25], v4 offset:256
    ds_read_b64_tr_b16 v[26:27], v4 offset:2304
    ds_read_b128 v[12:15], v2 offset:1024
    ds_read_b128 v[16:19], v2 offset:2048
    v_mfma_f32_32x32x16_bf16 v[96:111], v[32:35], v[40:43], v[96:111]
    buffer_load_dwordx4 v5, s[40:43], s54 offen sc1 lds
    v_mfma_f32_32x32x16_bf16 v[112:127], v[32:35], v[44:47], v[112:127]
    s_add_u32 m0, s60, 21504
    v_mfma_f32_32x32x16_bf16 v[128:143], v[36:39], v[40:43], v[128:143]
    buffer_load_dwordx4 v6, s[40:43], s54 offen sc1 lds
    s_add_u32 s54, s54, s62
    v_mfma_f32_32x32x16_bf16 v[144:159], v[36:39], v[44:47], v[144:159]
    s_waitcnt lgkmcnt(0)
    v_mfma_f32_32x32x16_bf16 v[64:79], v[8:11], v[20:23], v[64:79]
    s_add_u32 m0, s61, 20480
    ds_read_b128 v[28:31], v2 offset:6144
    ds_read_b64_tr_b16 v[40:41], v4 offset:4096
    ds_read_b64_tr_b16 v[42:43], v4 offset:6144
    buffer_load_dwordx4 v7, s[44:47], s55 offen offset:0 sc1 lds
    v_mfma_f32_32x32x16_bf16 v[80:95], v[8:11], v[24:27], v[80:95]
    ds_read_b64_tr_b16 v[44:45], v4 offset:4352
    ds_read_b64_tr_b16 v[46:47], v4 offset:6400
    ds_read_b128 v[32:35], v2 offset:7168
    ds_read_b128 v[36:39], v2 offset:8192
    v_mfma_f32_32x32x16_bf16 v[96:111], v[12:15], v[20:23], v[96:111]
    buffer_load_dwordx4 v7, s[44:47], s55 offen offset:1024 sc1 lds
    v_mfma_f32_32x32x16_bf16 v[112:127], v[12:15], v[24:27], v[112:127]
    v_mfma_f32_32x32x16_bf16 v[128:143], v[16:19], v[20:23], v[128:143]
    buffer_load_dwordx4 v7, s[44:47], s55 offen offset:2048 sc1 lds
    s_add_u32 s55, s55, s63
    v_mfma_f32_32x32x16_bf16 v[144:159], v[16:19], v[24:27], v[144:159]
    s_waitcnt lgkmcnt(0)
    v_mfma_f32_32x32x16_bf16 v[64:79], v[28:31], v[40:43], v[64:79]
    s_waitcnt vmcnt(10)
    s_barrier
    s_add_u32 m0, s60, 40960
    ds_read_b128 v[8:11], v2 offset:20480
    ds_read_b64_tr_b16 v[20:21], v4 offset:20480
    ds_read_b64_tr_b16 v[22:23], v4 offset:22528
    v_mfma_f32_32x32x16_bf16 v[80:95], v[28:31], v[44:47], v[80:95]
    ds_read_b64_tr_b16 v[24:25], v4 offset:20736
    ds_read_b64_tr_b16 v[26:27], v4 offset:22784
    ds_read_b128 v[12:15], v2 offset:21504
    ds_read_b128 v[16:19], v2 offset:22528
    v_mfma_f32_32x32x16_bf16 v[96:111], v[32:35], v[40:43], v[96:111]
    buffer_load_dwordx4 v5, s[40:43], s54 offen sc1 lds
    v_mfma_f32_32x32x16_bf16 v[112:127], v[32:35], v[44:47], v[112:127]
    s_add_u32 m0, s60, 41984
    v_mfma_f32_32x32x16_bf16 v[128:143], v[36:39], v[40:43], v[128:143]
    buffer_load_dwordx4 v6, s[40:43], s54 offen sc1 lds
    s_add_u32 s54, s54, s62
    v_mfma_f32_32x32x16_bf16 v[144:159], v[36:39], v[44:47], v[144:159]
    s_waitcnt lgkmcnt(0)
    s_buffer_load_dword s75, s[48:51], s59 glc
    v_mfma_f32_32x32x16_bf16 v[64:79], v[8:11], v[20:23], v[64:79]
    s_add_u32 m0, s61, 40960
    ds_read_b128 v[28:31], v2 offset:26624
    ds_read_b64_tr_b16 v[40:41], v4 offset:24576
    ds_read_b64_tr_b16 v[42:43], v4 offset:26624
    buffer_load_dwordx4 v7, s[44:47], s55 offen offset:0 sc1 lds
    v_mfma_f32_32x32x16_bf16 v[80:95], v[8:11], v[24:27], v[80:95]
    ds_read_b64_tr_b16 v[44:45], v4 offset:24832
    ds_read_b64_tr_b16 v[46:47], v4 offset:26880
    ds_read_b128 v[32:35], v2 offset:27648
    ds_read_b128 v[36:39], v2 offset:28672
    v_mfma_f32_32x32x16_bf16 v[96:111], v[12:15], v[20:23], v[96:111]
    buffer_load_dwordx4 v7, s[44:47], s55 offen offset:1024 sc1 lds
    v_mfma_f32_32x32x16_bf16 v[112:127], v[12:15], v[24:27], v[112:127]
    v_mfma_f32_32x32x16_bf16 v[128:143], v[16:19], v[20:23], v[128:143]
    buffer_load_dwordx4 v7, s[44:47], s55 offen offset:2048 sc1 lds
    s_add_u32 s55, s55, s63
    v_mfma_f32_32x32x16_bf16 v[144:159], v[16:19], v[24:27], v[144:159]
    s_waitcnt lgkmcnt(0)
    v_mfma_f32_32x32x16_bf16 v[64:79], v[28:31], v[40:43], v[64:79]
    s_cmp_ge_u32 s75, s64
    s_cselect_b32 s75, 1, 0
    s_cmp_gt_u32 s75, s79
    s_cbranch_scc0 L_lk_77
    s_mov_b32 s79, 1
    s_mov_b32 s42, 268435456
    s_add_u32 m0, s60, 20480
    s_nop 0
    buffer_load_dwordx4 v5, s[40:43], s78 offen sc1 lds
    s_add_u32 m0, s60, 21504
    s_nop 0
    buffer_load_dwordx4 v6, s[40:43], s78 offen sc1 lds
    s_add_u32 s78, s78, s62
    s_add_u32 m0, s60, 40960
    s_nop 0
    buffer_load_dwordx4 v5, s[40:43], s78 offen sc1 lds
    s_add_u32 m0, s60, 41984
    s_nop 0
    buffer_load_dwordx4 v6, s[40:43], s78 offen sc1 lds
    s_add_u32 s78, s78, s62
L_lk_77:
    s_waitcnt vmcnt(10)
    s_barrier
    s_add_u32 m0, s60, 61440
    ds_read_b128 v[8:11], v1 offset:0
    ds_read_b64_tr_b16 v[20:21], v3 offset:0
    ds_read_b64_tr_b16 v[22:23], v3 offset:2048
    v_mfma_f32_32x32x16_bf16 v[80:95], v[28:31], v[44:47], v[80:95]
    ds_read_b64_tr_b16 v[24:25], v3 offset:256
    ds_read_b64_tr_b16 v[26:27], v3 offset:2304
    ds_read_b128 v[12:15], v1 offset:1024
    ds_read_b128 v[16:19], v1 offset:2048
    v_mfma_f32_32x32x16_bf16 v[96:111], v[32:35], v[40:43], v[96:111]
    buffer_load_dwordx4 v5, s[40:43], s54 offen sc1 lds
    v_mfma_f32_32x32x16_bf16 v[112:127], v[32:35], v[44:47], v[112:127]
    s_add_u32 m0, s60, 62464
    v_mfma_f32_32x32x16_bf16 v[128:143], v[36:39], v[40:43], v[128:143]
    buffer_load_dwordx4 v6, s[40:43], s54 offen sc1 lds
    s_add_u32 s54, s54, s62
    v_mfma_f32_32x32x16_bf16 v[144:159], v[36:39], v[44:47], v[144:159]
    s_waitcnt lgkmcnt(0)
    s_buffer_load_dword s75, s[48:51], s59 glc
    v_mfma_f32_32x32x16_bf16 v[64:79], v[8:11], v[20:23], v[64:79]
    s_add_u32 m0, s61, 61440
    ds_read_b128 v[28:31], v1 offset:6144
    ds_read_b64_tr_b16 v[40:41], v3 offset:4096
    ds_read_b64_tr_b16 v[42:43], v3 offset:6144
    buffer_load_dwordx4 v7, s[44:47], s55 offen offset:0 sc1 lds
    v_mfma_f32_32x32x16_bf16 v[80:95], v[8:11], v[24:27], v[80:95]
    ds_read_b64_tr_b16 v[44:45], v3 offset:4352
    ds_read_b64_tr_b16 v[46:47], v3 offset:6400
    ds_read_b128 v[32:35], v1 offset:7168
    ds_read_b128 v[36:39], v1 offset:8192
    v_mfma_f32_32x32x16_bf16 v[96:111], v[12:15], v[20:23], v[96:111]
    buffer_load_dwordx4 v7, s[44:47], s55 offen offset:1024 sc1 lds
    v_mfma_f32_32x32x16_bf16 v[112:127], v[12:15], v[24:27], v[112:127]
    v_mfma_f32_32x32x16_bf16 v[128:143], v[16:19], v[20:23], v[128:143]
    buffer_load_dwordx4 v7, s[44:47], s55 offen offset:2048 sc1 lds
    s_add_u32 s55, s55, s63
    v_mfma_f32_32x32x16_bf16 v[144:159], v[16:19], v[24:27], v[144:159]
    s_waitcnt lgkmcnt(0)
    v_mfma_f32_32x32x16_bf16 v[64:79], v[28:31], v[40:43], v[64:79]
    s_cmp_ge_u32 s75, s64
    s_cselect_b32 s75, 1, 0
    s_cmp_gt_u32 s75, s79
    s_cbranch_scc0 L_lk_78
    s_mov_b32 s79, 1
    s_mov_b32 s42, 268435456
    s_add_u32 m0, s60, 20480
    s_nop 0
    buffer_load_dwordx4 v5, s[40:43], s78 offen sc1 lds
    s_add_u32 m0, s60, 21504
    s_nop 0
    buffer_load_dwordx4 v6, s[40:43], s78 offen sc1 lds
    s_add_u32 s78, s78, s62
    s_add_u32 m0, s60, 40960
    s_nop 0
    buffer_load_dwordx4 v5, s[40:43], s78 offen sc1 lds
    s_add_u32 m0, s60, 41984
    s_nop 0
    buffer_load_dwordx4 v6, s[40:43], s78 offen sc1 lds
    s_add_u32 s78, s78, s62
    s_add_u32 m0, s60, 61440
    s_nop 0
    buffer_load_dwordx4 v5, s[40:43], s78 offen sc1 lds
    s_add_u32 m0, s60, 62464
    s_nop 0
    buffer_load_dwordx4 v6, s[40:43], s78 offen sc1 lds
    s_add_u32 s78, s78, s62
L_lk_78:
    s_cmp_lt_u32 s53, 4
    s_cselect_b32 s42, 0, s42
    s_cselect_b32 s46, 0, s46
    s_waitcnt vmcnt(10)
    s_barrier
    s_add_u32 m0, s60, 0
    v_mfma_f32_32x32x16_bf16 v[80:95], v[28:31], v[44:47], v[80:95]
    v_mfma_f32_32x32x16_bf16 v[96:111], v[32:35], v[40:43], v[96:111]
    buffer_load_dwordx4 v5, s[40:43], s54 offen sc1 lds
    v_mfma_f32_32x32x16_bf16 v[112:127], v[32:35], v[44:47], v[112:127]
    s_add_u32 m0, s60, 1024
    v_mfma_f32_32x32x16_bf16 v[128:143], v[36:39], v[40:43], v[128:143]
    buffer_load_dwordx4 v6, s[40:43], s54 offen sc1 lds
    s_add_u32 s54, s54, s62
    s_add_u32 m0, s61, 0
    v_mfma_f32_32x32x16_bf16 v[144:159], v[36:39], v[44:47], v[144:159]
    buffer_load_dwordx4 v7, s[44:47], s55 offen offset:0 sc1 lds
    buffer_load_dwordx4 v7, s[44:47], s55 offen offset:1024 sc1 lds
    buffer_load_dwordx4 v7, s[44:47], s55 offen offset:2048 sc1 lds
    s_add_u32 s55, s55, s63
    s_setprio 2
    s_cmp_lg_u32 s79, 0
    s_cbranch_scc1 L_go_79
    s_mov_b32 s74, 0
L_poll_80:
    s_buffer_load_dword s75, s[48:51], s59 glc
    s_add_u32 s74, s74, 1
    s_waitcnt lgkmcnt(0)
    s_cmp_ge_u32 s75, s64
    s_cbranch_scc1 L_polld_81
    s_sleep 1
    s_cmp_lt_u32 s74, 262144
    s_cbranch_scc1 L_poll_80
L_polld_81:
    s_mov_b32 s42, 268435456
    s_add_u32 m0, s60, 20480
    s_nop 0
    buffer_load_dwordx4 v5, s[40:43], s78 offen sc1 lds
    s_add_u32 m0, s60, 21504
    s_nop 0
    buffer_load_dwordx4 v6, s[40:43], s78 offen sc1 lds
    s_add_u32 s78, s78, s62
    s_add_u32 m0, s60, 40960
    s_nop 0
    buffer_load_dwordx4 v5, s[40:43], s78 offen sc1 lds
    s_add_u32 m0, s60, 41984
    s_nop 0
    buffer_load_dwordx4 v6, s[40:43], s78 offen sc1 lds
    s_add_u32 s78, s78, s62
    s_add_u32 m0, s60, 61440
    s_nop 0
    buffer_load_dwordx4 v5, s[40:43], s78 offen sc1 lds
    s_add_u32 m0, s60, 62464
    s_nop 0
    buffer_load_dwordx4 v6, s[40:43], s78 offen sc1 lds
    s_add_u32 s78, s78, s62
    s_cmp_lt_u32 s53, 4
    s_cselect_b32 s42, 0, s42
    s_add_u32 m0, s60, 0
    s_nop 0
    buffer_load_dwordx4 v5, s[40:43], s78 offen sc1 lds
    s_add_u32 m0, s60, 1024
    s_nop 0
    buffer_load_dwordx4 v6, s[40:43], s78 offen sc1 lds
    s_add_u32 s78, s78, s62
L_go_79:
    v_sub_f32 v50, 1.0, v50
    v_lshlrev_b32 v52, 16, v52
    v_mul_f32 v52, v52, v50
    v_sub_f32 v51, 1.0, v51
    v_lshlrev_b32 v53, 16, v53
    v_mul_f32 v53, v53, v51
    s_mul_i32 s73, s69, 2359296
    s_lshl_b32 s70, s67, 1
    s_add_u32 s70, s70, s71
    s_mul_i32 s70, s70, 393216
    s_add_u32 s73, s73, s70
    s_lshl_b32 s70, s66, 1
    s_add_u32 s70, s70, s72
    s_lshl_b32 s70, s70, 12
    s_add_u32 s73, s73, s70
    s_add_u32 s73, s73, 17776640
    s_lshl_b32 s76, s67, 1
    s_add_u32 s76, s76, s71
    s_lshl_b32 s76, s76, 5
    s_lshl_b32 s70, s66, 1
    s_add_u32 s76, s76, s70
    s_add_u32 s76, s76, s72
    s_lshl_b32 s76, s76, 8
    s_add_u32 s76, s76, 29736960
    v_mov_b32 v54, 0
    v_mov_b32 v55, 1
    v_fma_f32 v64, v64, v50, v52
    v_fma_f32 v65, v65, v50, v52
    v_fma_f32 v66, v66, v50, v52
    v_fma_f32 v67, v67, v50, v52
    v_fma_f32 v68, v68, v50, v52
    v_fma_f32 v69, v69, v50, v52
    v_fma_f32 v70, v70, v50, v52
    v_fma_f32 v71, v71, v50, v52
    v_fma_f32 v72, v72, v50, v52
    v_fma_f32 v73, v73, v50, v52
    v_fma_f32 v74, v74, v50, v52
    v_fma_f32 v75, v75, v50, v52
    v_fma_f32 v76, v76, v50, v52
    v_fma_f32 v77, v77, v50, v52
    v_fma_f32 v78, v78, v50, v52
    v_fma_f32 v79, v79, v50, v52
    v_fma_f32 v80, v80, v51, v53
    v_fma_f32 v81, v81, v51, v53
    v_fma_f32 v82, v82, v51, v53
    v_fma_f32 v83, v83, v51, v53
    v_fma_f32 v84, v84, v51, v53
    v_fma_f32 v85, v85, v51, v53
    v_fma_f32 v86, v86, v51, v53
    v_fma_f32 v87, v87, v51, v53
    v_fma_f32 v88, v88, v51, v53
    v_fma_f32 v89, v89, v51, v53
    v_fma_f32 v90, v90, v51, v53
    v_fma_f32 v91, v91, v51, v53
    v_fma_f32 v92, v92, v51, v53
    v_fma_f32 v93, v93, v51, v53
    v_fma_f32 v94, v94, v51, v53
    v_fma_f32 v95, v95, v51, v53
    v_fma_f32 v96, v96, v50, v52
    v_fma_f32 v97, v97, v50, v52
    v_fma_f32 v98, v98, v50, v52
    v_fma_f32 v99, v99, v50, v52
    v_fma_f32 v100, v100, v50, v52
    v_fma_f32 v101, v101, v50, v52
    v_fma_f32 v102, v102, v50, v52
    v_fma_f32 v103, v103, v50, v52
    v_fma_f32 v104, v104, v50, v52
    v_fma_f32 v105, v105, v50, v52
    v_fma_f32 v106, v106, v50, v52
    v_fma_f32 v107, v107, v50, v52
    v_fma_f32 v108, v108, v50, v52
    v_fma_f32 v109, v109, v50, v52
    v_fma_f32 v110, v110, v50, v52
    v_fma_f32 v111, v111, v50, v52
    v_fma_f32 v112, v112, v51, v53
    v_fma_f32 v113, v113, v51, v53
    v_fma_f32 v114, v114, v51, v53
    v_fma_f32 v115, v115, v51, v53
    v_fma_f32 v116, v116, v51, v53
    v_fma_f32 v117, v117, v51, v53
    v_fma_f32 v118, v118, v51, v53
    v_fma_f32 v119, v119, v51, v53
    v_fma_f32 v120, v120, v51, v53
    v_fma_f32 v121, v121, v51, v53
    v_fma_f32 v122, v122, v51, v53
    v_fma_f32 v123, v123, v51, v53
    v_fma_f32 v124, v124, v51, v53
    v_fma_f32 v125, v125, v51, v53
    v_fma_f32 v126, v126, v51, v53
    v_fma_f32 v127, v127, v51, v53
    v_fma_f32 v128, v128, v50, v52
    v_fma_f32 v129, v129, v50, v52
    v_fma_f32 v130, v130, v50, v52
    v_fma_f32 v131, v131, v50, v52
    v_fma_f32 v132, v132, v50, v52
    v_fma_f32 v133, v133, v50, v52
    v_fma_f32 v134, v134, v50, v52
    v_fma_f32 v135, v135, v50, v52
    v_fma_f32 v136, v136, v50, v52
    v_fma_f32 v137, v137, v50, v52
    v_fma_f32 v138, v138, v50, v52
    v_fma_f32 v139, v139, v50, v52
    v_fma_f32 v140, v140, v50, v52
    v_fma_f32 v141, v141, v50, v52
    v_fma_f32 v142, v142, v50, v52
    v_fma_f32 v143, v143, v50, v52
    v_fma_f32 v144, v144, v51, v53
    v_fma_f32 v145, v145, v51, v53
    v_fma_f32 v146, v146, v51, v53
    v_fma_f32 v147, v147, v51, v53
    v_fma_f32 v148, v148, v51, v53
    v_fma_f32 v149, v149, v51, v53
    v_fma_f32 v150, v150, v51, v53
    v_fma_f32 v151, v151, v51, v53
    v_fma_f32 v152, v152, v51, v53
    v_fma_f32 v153, v153, v51, v53
    v_fma_f32 v154, v154, v51, v53
    v_fma_f32 v155, v155, v51, v53
    v_fma_f32 v156, v156, v51, v53
    v_fma_f32 v157, v157, v51, v53
    v_fma_f32 v158, v158, v51, v53
    v_fma_f32 v159, v159, v51, v53
    s_waitcnt vmcnt(0)
    s_barrier
    ds_read_b128 v[8:11], v1 offset:20480
    ds_read_b64_tr_b16 v[160:161], v3 offset:20480
    ds_read_b64_tr_b16 v[162:163], v3 offset:22528
    ds_read_b64_tr_b16 v[164:165], v3 offset:20736
    ds_read_b64_tr_b16 v[166:167], v3 offset:22784
    ds_read_b128 v[12:15], v1 offset:26624
    ds_read_b64_tr_b16 v[168:169], v3 offset:24576
    ds_read_b64_tr_b16 v[170:171], v3 offset:26624
    ds_read_b64_tr_b16 v[172:173], v3 offset:24832
    ds_read_b64_tr_b16 v[174:175], v3 offset:26880
    s_waitcnt lgkmcnt(5)
    v_mfma_f32_32x32x16_bf16 v[64:79], v[8:11], v[160:163], v[64:79]
    v_mfma_f32_32x32x16_bf16 v[80:95], v[8:11], v[164:167], v[80:95]
    ds_read_b128 v[16:19], v2 offset:0
    ds_read_b64_tr_b16 v[176:177], v4 offset:0
    ds_read_b64_tr_b16 v[178:179], v4 offset:2048
    ds_read_b64_tr_b16 v[180:181], v4 offset:256
    ds_read_b64_tr_b16 v[182:183], v4 offset:2304
    s_waitcnt lgkmcnt(5)
    v_mfma_f32_32x32x16_bf16 v[64:79], v[12:15], v[168:171], v[64:79]
    v_mfma_f32_32x32x16_bf16 v[80:95], v[12:15], v[172:175], v[80:95]
    ds_read_b128 v[20:23], v2 offset:6144
    ds_read_b64_tr_b16 v[184:185], v4 offset:4096
    ds_read_b64_tr_b16 v[186:187], v4 offset:6144
    ds_read_b64_tr_b16 v[188:189], v4 offset:4352
    ds_read_b64_tr_b16 v[190:191], v4 offset:6400
    s_waitcnt lgkmcnt(5)
    v_mfma_f32_32x32x16_bf16 v[64:79], v[16:19], v[176:179], v[64:79]
    v_mfma_f32_32x32x16_bf16 v[80:95], v[16:19], v[180:183], v[80:95]
    ds_read_b128 v[24:27], v2 offset:20480
    ds_read_b64_tr_b16 v[192:193], v4 offset:20480
    ds_read_b64_tr_b16 v[194:195], v4 offset:22528
    ds_read_b64_tr_b16 v[196:197], v4 offset:20736
    ds_read_b64_tr_b16 v[198:199], v4 offset:22784
    ds_read_b128 v[8:11], v1 offset:21504
    s_waitcnt lgkmcnt(6)
    v_mfma_f32_32x32x16_bf16 v[64:79], v[20:23], v[184:187], v[64:79]
    v_mfma_f32_32x32x16_bf16 v[80:95], v[20:23], v[188:191], v[80:95]
    ds_read_b128 v[28:31], v2 offset:26624
    ds_read_b64_tr_b16 v[200:201], v4 offset:24576
    ds_read_b64_tr_b16 v[202:203], v4 offset:26624
    ds_read_b64_tr_b16 v[204:205], v4 offset:24832
    ds_read_b64_tr_b16 v[206:207], v4 offset:26880
    ds_read_b128 v[12:15], v1 offset:27648
    s_waitcnt lgkmcnt(7)
    v_mfma_f32_32x32x16_bf16 v[64:79], v[24:27], v[192:195], v[64:79]
    v_mfma_f32_32x32x16_bf16 v[80:95], v[24:27], v[196:199], v[80:95]
    ds_read_b128 v[32:35], v1 offset:0
    ds_read_b64_tr_b16 v[208:209], v3 offset:0
    ds_read_b64_tr_b16 v[210:211], v3 offset:2048
    ds_read_b64_tr_b16 v[212:213], v3 offset:256
    ds_read_b64_tr_b16 v[214:215], v3 offset:2304
    ds_read_b128 v[16:19], v2 offset:1024
    s_waitcnt lgkmcnt(7)
    v_mfma_f32_32x32x16_bf16 v[64:79], v[28:31], v[200:203], v[64:79]
    v_mfma_f32_32x32x16_bf16 v[80:95], v[28:31], v[204:207], v[80:95]
    ds_read_b128 v[36:39], v1 offset:6144
    ds_read_b64_tr_b16 v[216:217], v3 offset:4096
    ds_read_b64_tr_b16 v[218:219], v3 offset:6144
    ds_read_b64_tr_b16 v[220:221], v3 offset:4352
    ds_read_b64_tr_b16 v[222:223], v3 offset:6400
    ds_read_b128 v[20:23], v2 offset:7168
    s_waitcnt lgkmcnt(7)
    v_mfma_f32_32x32x16_bf16 v[64:79], v[32:35], v[208:211], v[64:79]
    v_mfma_f32_32x32x16_bf16 v[80:95], v[32:35], v[212:215], v[80:95]
    ds_read_b128 v[24:27], v2 offset:21504
    s_waitcnt lgkmcnt(2)
    v_mfma_f32_32x32x16_bf16 v[64:79], v[36:39], v[216:219], v[64:79]
    v_mfma_f32_32x32x16_bf16 v[80:95], v[36:39], v[220:223], v[80:95]
    ds_read_b128 v[28:31], v2 offset:27648
    v_mfma_f32_32x32x16_bf16 v[96:111], v[8:11], v[160:163], v[96:111]
    v_mfma_f32_32x32x16_bf16 v[112:127], v[8:11], v[164:167], v[112:127]
    ds_read_b128 v[32:35], v1 offset:1024
    ds_read_b128 v[36:39], v1 offset:7168
    v_mfma_f32_32x32x16_bf16 v[96:111], v[12:15], v[168:171], v[96:111]
    v_mfma_f32_32x32x16_bf16 v[112:127], v[12:15], v[172:175], v[112:127]
    v_mfma_f32_32x32x16_bf16 v[96:111], v[16:19], v[176:179], v[96:111]
    v_mfma_f32_32x32x16_bf16 v[112:127], v[16:19], v[180:183], v[112:127]
    ds_read_b128 v[8:11], v1 offset:22528
    s_waitcnt lgkmcnt(5)
    v_mfma_f32_32x32x16_bf16 v[96:111], v[20:23], v[184:187], v[96:111]
    s_nop 3
    v_mfma_f32_32x32x16_bf16 v[112:127], v[20:23], v[188:191], v[112:127]
    v_cvt_pk_bf16_f32 v64, v64, v65
    v_cvt_pk_bf16_f32 v65, v66, v67
    v_cvt_pk_bf16_f32 v66, v68, v69
    ds_read_b128 v[12:15], v1 offset:28672
    s_waitcnt lgkmcnt(5)
    v_mfma_f32_32x32x16_bf16 v[96:111], v[24:27], v[192:195], v[96:111]
    v_cvt_pk_bf16_f32 v67, v70, v71
    buffer_store_dwordx4 v[64:67], v7, s[48:51], s73 offen offset:0 sc1
    v_cvt_pk_bf16_f32 v68, v72, v73
    v_mfma_f32_32x32x16_bf16 v[112:127], v[24:27], v[196:199], v[112:127]
    v_cvt_pk_bf16_f32 v69, v74, v75
    v_cvt_pk_bf16_f32 v70, v76, v77
    v_cvt_pk_bf16_f32 v71, v78, v79
    ds_read_b128 v[16:19], v2 offset:2048
    s_waitcnt lgkmcnt(5)
    v_mfma_f32_32x32x16_bf16 v[96:111], v[28:31], v[200:203], v[96:111]
    buffer_store_dwordx4 v[68:71], v7, s[48:51], s73 offen offset:1024 sc1
    v_cvt_pk_bf16_f32 v80, v80, v81
    v_cvt_pk_bf16_f32 v81, v82, v83
    v_mfma_f32_32x32x16_bf16 v[112:127], v[28:31], v[204:207], v[112:127]
    v_cvt_pk_bf16_f32 v82, v84, v85
    v_cvt_pk_bf16_f32 v83, v86, v87
    buffer_store_dwordx4 v[80:83], v7, s[48:51], s73 offen offset:2048 sc1
    ds_read_b128 v[20:23], v2 offset:8192
    s_waitcnt lgkmcnt(5)
    v_mfma_f32_32x32x16_bf16 v[96:111], v[32:35], v[208:211], v[96:111]
    v_cvt_pk_bf16_f32 v84, v88, v89
    v_cvt_pk_bf16_f32 v85, v90, v91
    v_cvt_pk_bf16_f32 v86, v92, v93
    v_mfma_f32_32x32x16_bf16 v[112:127], v[32:35], v[212:215], v[112:127]
    v_cvt_pk_bf16_f32 v87, v94, v95
    buffer_store_dwordx4 v[84:87], v7, s[48:51], s73 offen offset:3072 sc1
    s_add_u32 s73, s73, 131072
    ds_read_b128 v[24:27], v2 offset:22528
    s_waitcnt lgkmcnt(5)
    v_mfma_f32_32x32x16_bf16 v[96:111], v[36:39], v[216:219], v[96:111]
    v_mfma_f32_32x32x16_bf16 v[112:127], v[36:39], v[220:223], v[112:127]
    ds_read_b128 v[28:31], v2 offset:28672
    s_waitcnt lgkmcnt(5)
    v_mfma_f32_32x32x16_bf16 v[128:143], v[8:11], v[160:163], v[128:143]
    v_mfma_f32_32x32x16_bf16 v[144:159], v[8:11], v[164:167], v[144:159]
    ds_read_b128 v[32:35], v1 offset:2048
    ds_read_b128 v[36:39], v1 offset:8192
    s_waitcnt lgkmcnt(6)
    v_mfma_f32_32x32x16_bf16 v[128:143], v[12:15], v[168:171], v[128:143]
    v_mfma_f32_32x32x16_bf16 v[144:159], v[12:15], v[172:175], v[144:159]
    s_waitcnt lgkmcnt(5)
    v_mfma_f32_32x32x16_bf16 v[128:143], v[16:19], v[176:179], v[128:143]
    v_mfma_f32_32x32x16_bf16 v[144:159], v[16:19], v[180:183], v[144:159]
    s_waitcnt lgkmcnt(4)
    v_mfma_f32_32x32x16_bf16 v[128:143], v[20:23], v[184:187], v[128:143]
    s_nop 3
    v_mfma_f32_32x32x16_bf16 v[144:159], v[20:23], v[188:191], v[144:159]
    v_cvt_pk_bf16_f32 v96, v96, v97
    v_cvt_pk_bf16_f32 v97, v98, v99
    v_cvt_pk_bf16_f32 v98, v100, v101
    s_waitcnt lgkmcnt(3)
    v_mfma_f32_32x32x16_bf16 v[128:143], v[24:27], v[192:195], v[128:143]
    v_cvt_pk_bf16_f32 v99, v102, v103
    buffer_store_dwordx4 v[96:99], v7, s[48:51], s73 offen offset:0 sc1
    v_cvt_pk_bf16_f32 v100, v104, v105
    v_mfma_f32_32x32x16_bf16 v[144:159], v[24:27], v[196:199], v[144:159]
    v_cvt_pk_bf16_f32 v101, v106, v107
    v_cvt_pk_bf16_f32 v102, v108, v109
    v_cvt_pk_bf16_f32 v103, v110, v111
    s_waitcnt lgkmcnt(2)
    v_mfma_f32_32x32x16_bf16 v[128:143], v[28:31], v[200:203], v[128:143]
    buffer_store_dwordx4 v[100:103], v7, s[48:51], s73 offen offset:1024 sc1
    v_cvt_pk_bf16_f32 v112, v112, v113
    v_cvt_pk_bf16_f32 v113, v114, v115
    v_mfma_f32_32x32x16_bf16 v[144:159], v[28:31], v[204:207], v[144:159]
    v_cvt_pk_bf16_f32 v114, v116, v117
    v_cvt_pk_bf16_f32 v115, v118, v119
    buffer_store_dwordx4 v[112:115], v7, s[48:51], s73 offen offset:2048 sc1
    s_waitcnt lgkmcnt(1)
    v_mfma_f32_32x32x16_bf16 v[128:143], v[32:35], v[208:211], v[128:143]
    v_cvt_pk_bf16_f32 v116, v120, v121
    v_cvt_pk_bf16_f32 v117, v122, v123
    v_cvt_pk_bf16_f32 v118, v124, v125
    v_mfma_f32_32x32x16_bf16 v[144:159], v[32:35], v[212:215], v[144:159]
    v_cvt_pk_bf16_f32 v119, v126, v127
    buffer_store_dwordx4 v[116:119], v7, s[48:51], s73 offen offset:3072 sc1
    s_add_u32 s73, s73, 131072
    s_waitcnt lgkmcnt(0)
    v_mfma_f32_32x32x16_bf16 v[128:143], v[36:39], v[216:219], v[128:143]
    v_mfma_f32_32x32x16_bf16 v[144:159], v[36:39], v[220:223], v[144:159]
    s_nop 15
    v_cvt_pk_bf16_f32 v128, v128, v129
    v_cvt_pk_bf16_f32 v129, v130, v131
    v_cvt_pk_bf16_f32 v130, v132, v133
    v_cvt_pk_bf16_f32 v131, v134, v135
    buffer_store_dwordx4 v[128:131], v7, s[48:51], s73 offen offset:0 sc1
    v_cvt_pk_bf16_f32 v132, v136, v137
    v_cvt_pk_bf16_f32 v133, v138, v139
    v_cvt_pk_bf16_f32 v134, v140, v141
    v_cvt_pk_bf16_f32 v135, v142, v143
    buffer_store_dwordx4 v[132:135], v7, s[48:51], s73 offen offset:1024 sc1
    v_cvt_pk_bf16_f32 v144, v144, v145
    v_cvt_pk_bf16_f32 v145, v146, v147
    v_cvt_pk_bf16_f32 v146, v148, v149
    v_cvt_pk_bf16_f32 v147, v150, v151
    buffer_store_dwordx4 v[144:147], v7, s[48:51], s73 offen offset:2048 sc1
    v_cvt_pk_bf16_f32 v148, v152, v153
    v_cvt_pk_bf16_f32 v149, v154, v155
    v_cvt_pk_bf16_f32 v150, v156, v157
    v_cvt_pk_bf16_f32 v151, v158, v159
    buffer_store_dwordx4 v[148:151], v7, s[48:51], s73 offen offset:3072 sc1
    s_waitcnt vmcnt(8)
    s_mov_b64 exec, 1
    buffer_atomic_add v55, v54, s[48:51], s76 offen offset:0 sc1
    s_mov_b64 exec, -1
    s_waitcnt vmcnt(4)
    s_mov_b64 exec, 1
    buffer_atomic_add v55, v54, s[48:51], s76 offen offset:4 sc1
    s_mov_b64 exec, -1
    s_waitcnt vmcnt(0)
    s_mov_b64 exec, 1
    buffer_atomic_add v55, v54, s[48:51], s76 offen offset:8 sc1
    s_mov_b64 exec, -1
L_done:
    s_endpgm
L_end:
    s_endpgm
L_code_end:
.section .rodata,"a"
.p2align 6
.amdhsa_kernel gated_mix__softmax_full_mha__mixer_token_mlp__prompt_kernel
  .amdhsa_next_free_vgpr 256
  .amdhsa_next_free_sgpr 102
  .amdhsa_accum_offset 256
  .amdhsa_group_segment_fixed_size 0
  .amdhsa_kernarg_size 96
  .amdhsa_user_sgpr_count 2
  .amdhsa_user_sgpr_kernarg_segment_ptr 1
  .amdhsa_system_sgpr_workgroup_id_x 1
.end_amdhsa_kernel
```
